```python
import torch

def _softmax(x, axis=-1):
    return torch.softmax(x, dim=axis)
def _gelu(x):
    return torch.nn.functional.gelu(x, approximate="tanh")
def _silu(x):
    return torch.nn.functional.silu(x)
def _sigmoid(x):
    return torch.sigmoid(x)
def _layernorm(x, axis=-1, eps=1e-5):
    m = x.mean(dim=axis, keepdim=True)
    v = x.var(dim=axis, keepdim=True, unbiased=False)
    return (x - m) / torch.sqrt(v + eps)
def _scatter_add(tgt, idx, src, axis=0):
    return tgt.clone().index_add_(axis, idx, src)
def _segment_sum(src, seg, n):
    out = torch.zeros((n,) + src.shape[1:], dtype=src.dtype)
    return out.index_add_(0, seg, src)
def _pad(x, pw):
    flat = tuple(v for pair in reversed(pw) for v in pair)
    return torch.nn.functional.pad(x, flat)

kernel_name = 'interleave_layers__sliding_block__geglu_ffn__prompt'

def setup_inputs():

    _w = (lambda a: (lambda t: t.to(torch.bfloat16) if t.is_floating_point() else t)(torch.as_tensor(a)))
    def _A_setup():
        B, S, D = 1, 2048, 448
        return {
            "x": _w((lambda *s: torch.randn(*s, dtype=torch.bfloat16) * 0.05)(B, S, D)),
            "wqkv": _w((lambda *s: torch.randn(*s, dtype=torch.bfloat16) * 0.05)(D, 3 * D)),
            "wo": _w((lambda *s: torch.randn(*s, dtype=torch.bfloat16) * 0.05)(D, D)),
        }
    _A_in = _A_setup()

    def _B_setup():
        B, S, D, F = 1, 2048, 448, 1792
        return {
            "x": _w((lambda *s: torch.randn(*s, dtype=torch.bfloat16) * 0.05)(B, S, D)),
            "w_gate": _w((lambda *s: torch.randn(*s, dtype=torch.bfloat16) * 0.05)(D, F)),
            "w_up": _w((lambda *s: torch.randn(*s, dtype=torch.bfloat16) * 0.05)(D, F)),
            "w_down": _w((lambda *s: torch.randn(*s, dtype=torch.bfloat16) * 0.05)(F, D)),
        }
    _B_in = _B_setup()

    return {
        "A_x": _A_in["x"],
        "A_wqkv": _A_in["wqkv"],
        "A_wo": _A_in["wo"],
        "B_x": _B_in["x"],
        "B_w_gate": _B_in["w_gate"],
        "B_w_up": _B_in["w_up"],
        "B_w_down": _B_in["w_down"],
    }

def reference(A_x, A_wqkv, A_wo, B_x, B_w_gate, B_w_up, B_w_down):
    def _A_ref(x, wqkv, wo):
        B, S, D = x.shape
        H = 16; Dh = D // H; W = 256
        qkv = (lambda x, *d: x.permute(*d))((x @ wqkv).reshape(B, S, 3, H, Dh), 2, 0, 3, 1, 4)
        q, k, v = qkv[0], qkv[1], qkv[2]
        scores = torch.einsum("bhqd,bhkd->bhqk", q, k) * (Dh ** -0.5)
        idx = torch.arange(S)
        mask = (idx[:, None] - idx[None, :] >= 0) & (idx[:, None] - idx[None, :] < W)
        scores = torch.where(mask[None, None], scores, -1e9)
        p = _softmax(scores, axis=-1)
        o = torch.einsum("bhqk,bhkd->bhqd", p, v)
        return (lambda x, *d: x.permute(*d))(o, 0, 2, 1, 3).reshape(B, S, D) @ wo

    def _B_ref(x, w_gate, w_up, w_down):
        return (_gelu(x @ w_gate) * (x @ w_up)) @ w_down

    x = A_x
    x = x + _A_ref(_layernorm(x, axis=-1), A_wqkv, A_wo)
    x = x + _B_ref(_layernorm(x, axis=-1), B_w_gate, B_w_up, B_w_down)
    x = x + _A_ref(_layernorm(x, axis=-1), A_wqkv, A_wo)
    x = x + _B_ref(_layernorm(x, axis=-1), B_w_gate, B_w_up, B_w_down)
    return x
```

```asm
; @launch kernel=prep_kernel grid=(680,1,1) block=(64,1,1) lds=15360
; @launch kernel=mega_kernel grid=(256,1,1) block=(512,1,1) lds=163840
.amdgcn_target "amdgcn-amd-amdhsa--gfx950"
.text
.globl prep_kernel
.p2align 8
.type prep_kernel,@function
prep_kernel:
    s_cmp_ge_u32 s2, 680
    s_cbranch_scc1 prep_kernel_end1
    s_load_dwordx16 s[4:19], s[0:1], 0
    s_load_dwordx2 s[20:21], s[0:1], 72
    v_lshrrev_b32 v1, 5, v0
    v_lshlrev_b32 v2, 2, v1
    v_bfe_u32 v3, v0, 2, 2
    v_add_u32 v2, v2, v3
    v_lshlrev_b32 v2, 7, v2
    v_bfe_u32 v3, v0, 4, 1
    v_lshlrev_b32 v4, 5, v3
    v_add_u32 v2, v2, v4
    v_and_b32 v4, 3, v0
    v_lshlrev_b32 v4, 3, v4
    v_add_u32 v2, v2, v4
    v_lshrrev_b32 v5, 3, v0
    v_and_b32 v6, 7, v0
    v_lshlrev_b32 v6, 4, v6
    v_lshlrev_b32 v7, 4, v0
    v_mov_b32 v8, 0x3f803f80
    s_waitcnt lgkmcnt(0)
    s_mov_b32 s24, s20
    s_mov_b32 s25, s21
    s_mov_b32 s26, 268435456
    s_mov_b32 s27, 0x00020000
    s_cmp_ge_u32 s2, 680
    s_cbranch_scc1 prep_kernel_t10
    s_cmp_ge_u32 s2, 648
    s_cbranch_scc1 prep_kernel_c9
    s_cmp_ge_u32 s2, 588
    s_cbranch_scc1 prep_kernel_z8
    s_cmp_ge_u32 s2, 460
    s_cbranch_scc1 prep_kernel_x7
    s_cmp_ge_u32 s2, 348
    s_cbranch_scc1 prep_kernel_wd6
    s_cmp_ge_u32 s2, 320
    s_cbranch_scc1 prep_kernel_wo5
    s_cmp_ge_u32 s2, 224
    s_cbranch_scc1 prep_kernel_qkv4
    s_cmp_ge_u32 s2, 112
    s_cbranch_scc1 prep_kernel_up3
    s_branch prep_kernel_gate2
prep_kernel_gate2:
    s_mov_b32 s28, s12
    s_mov_b32 s29, s13
    s_mov_b32 s30, 1605632
    s_mov_b32 s31, 0x00020000
    s_sub_u32 s32, s2, 0
    s_lshr_b32 s35, s32, 2
    s_and_b32 s36, s32, 3
    s_mul_i32 s33, s36, 401408
    s_lshl_b32 s37, s35, 7
    s_add_u32 s33, s33, s37
    s_mov_b32 s34, 3584
    v_mul_lo_u32 v9, v5, s34
    v_add_u32 v9, v9, v6
    s_mov_b32 m0, 0
    s_nop 0
    buffer_load_dwordx4 v9, s[28:31], s33 offen lds
    s_add_u32 s33, s33, 28672
    s_mov_b32 m0, 1024
    s_nop 0
    buffer_load_dwordx4 v9, s[28:31], s33 offen lds
    s_add_u32 s33, s33, 28672
    s_mov_b32 m0, 2048
    s_nop 0
    buffer_load_dwordx4 v9, s[28:31], s33 offen lds
    s_add_u32 s33, s33, 28672
    s_mov_b32 m0, 3072
    s_nop 0
    buffer_load_dwordx4 v9, s[28:31], s33 offen lds
    s_add_u32 s33, s33, 28672
    s_mov_b32 m0, 4096
    s_nop 0
    buffer_load_dwordx4 v9, s[28:31], s33 offen lds
    s_add_u32 s33, s33, 28672
    s_mov_b32 m0, 5120
    s_nop 0
    buffer_load_dwordx4 v9, s[28:31], s33 offen lds
    s_add_u32 s33, s33, 28672
    s_mov_b32 m0, 6144
    s_nop 0
    buffer_load_dwordx4 v9, s[28:31], s33 offen lds
    s_add_u32 s33, s33, 28672
    s_mov_b32 m0, 7168
    s_nop 0
    buffer_load_dwordx4 v9, s[28:31], s33 offen lds
    s_add_u32 s33, s33, 28672
    s_mov_b32 m0, 8192
    s_nop 0
    buffer_load_dwordx4 v9, s[28:31], s33 offen lds
    s_add_u32 s33, s33, 28672
    s_mov_b32 m0, 9216
    s_nop 0
    buffer_load_dwordx4 v9, s[28:31], s33 offen lds
    s_add_u32 s33, s33, 28672
    s_mov_b32 m0, 10240
    s_nop 0
    buffer_load_dwordx4 v9, s[28:31], s33 offen lds
    s_add_u32 s33, s33, 28672
    s_mov_b32 m0, 11264
    s_nop 0
    buffer_load_dwordx4 v9, s[28:31], s33 offen lds
    s_add_u32 s33, s33, 28672
    s_mov_b32 m0, 12288
    s_nop 0
    buffer_load_dwordx4 v9, s[28:31], s33 offen lds
    s_add_u32 s33, s33, 28672
    s_mov_b32 m0, 13312
    s_nop 0
    buffer_load_dwordx4 v9, s[28:31], s33 offen lds
    s_waitcnt vmcnt(0)
    ds_read_b64_tr_b16 v[16:17], v2 offset:0
    ds_read_b64_tr_b16 v[18:19], v2 offset:1024
    ds_read_b64_tr_b16 v[20:21], v2 offset:64
    ds_read_b64_tr_b16 v[22:23], v2 offset:1088
    ds_read_b64_tr_b16 v[24:25], v2 offset:2048
    ds_read_b64_tr_b16 v[26:27], v2 offset:3072
    ds_read_b64_tr_b16 v[28:29], v2 offset:2112
    ds_read_b64_tr_b16 v[30:31], v2 offset:3136
    ds_read_b64_tr_b16 v[32:33], v2 offset:4096
    ds_read_b64_tr_b16 v[34:35], v2 offset:5120
    ds_read_b64_tr_b16 v[36:37], v2 offset:4160
    ds_read_b64_tr_b16 v[38:39], v2 offset:5184
    ds_read_b64_tr_b16 v[40:41], v2 offset:6144
    ds_read_b64_tr_b16 v[42:43], v2 offset:7168
    ds_read_b64_tr_b16 v[44:45], v2 offset:6208
    ds_read_b64_tr_b16 v[46:47], v2 offset:7232
    ds_read_b64_tr_b16 v[48:49], v2 offset:8192
    ds_read_b64_tr_b16 v[50:51], v2 offset:9216
    ds_read_b64_tr_b16 v[52:53], v2 offset:8256
    ds_read_b64_tr_b16 v[54:55], v2 offset:9280
    ds_read_b64_tr_b16 v[56:57], v2 offset:10240
    ds_read_b64_tr_b16 v[58:59], v2 offset:11264
    ds_read_b64_tr_b16 v[60:61], v2 offset:10304
    ds_read_b64_tr_b16 v[62:63], v2 offset:11328
    ds_read_b64_tr_b16 v[64:65], v2 offset:12288
    ds_read_b64_tr_b16 v[66:67], v2 offset:13312
    ds_read_b64_tr_b16 v[68:69], v2 offset:12352
    ds_read_b64_tr_b16 v[70:71], v2 offset:13376
    s_mov_b32 s34, 29696
    v_mul_lo_u32 v3, v3, s34
    v_and_b32 v4, 15, v0
    v_add_u32 v4, 0, v4
    v_lshlrev_b32 v4, 4, v4
    v_add_u32 v4, v4, v3
    v_lshlrev_b32 v3, 9, v1
    v_add_u32 v3, v3, v4
    s_mul_i32 s38, s35, 118784
    s_add_u32 s38, s38, 2097152
    s_add_u32 s39, s38, 59392
    s_mul_i32 s37, s36, 7168
    s_add_u32 s40, s38, s37
    s_add_u32 s41, s39, s37
    s_lshr_b32 s37, s36, 1
    s_lshl_b32 s37, s37, 9
    s_and_b32 s42, s36, 1
    s_lshl_b32 s42, s42, 3
    s_add_u32 s37, s37, s42
    s_add_u32 s37, s37, 28672
    s_add_u32 s42, s38, s37
    s_add_u32 s43, s39, s37
    s_waitcnt lgkmcnt(0)
    buffer_store_dwordx4 v[16:19], v3, s[24:27], s40 offen offset:0
    buffer_store_dwordx4 v[20:23], v3, s[24:27], s41 offen offset:0
    buffer_store_dwordx4 v[24:27], v3, s[24:27], s40 offen offset:1024
    buffer_store_dwordx4 v[28:31], v3, s[24:27], s41 offen offset:1024
    buffer_store_dwordx4 v[32:35], v3, s[24:27], s40 offen offset:2048
    buffer_store_dwordx4 v[36:39], v3, s[24:27], s41 offen offset:2048
    buffer_store_dwordx4 v[40:43], v3, s[24:27], s40 offen offset:3072
    buffer_store_dwordx4 v[44:47], v3, s[24:27], s41 offen offset:3072
    s_add_u32 s40, s40, 4096
    s_add_u32 s41, s41, 4096
    buffer_store_dwordx4 v[48:51], v3, s[24:27], s40 offen offset:0
    buffer_store_dwordx4 v[52:55], v3, s[24:27], s41 offen offset:0
    buffer_store_dwordx4 v[56:59], v3, s[24:27], s40 offen offset:1024
    buffer_store_dwordx4 v[60:63], v3, s[24:27], s41 offen offset:1024
    buffer_store_dwordx4 v[64:67], v3, s[24:27], s40 offen offset:2048
    buffer_store_dwordx4 v[68:71], v3, s[24:27], s41 offen offset:2048
    v_mov_b32 v10, 0
    v_dot2c_f32_bf16 v10, v16, v8
    v_dot2c_f32_bf16 v10, v17, v8
    v_dot2c_f32_bf16 v10, v18, v8
    v_dot2c_f32_bf16 v10, v19, v8
    v_dot2c_f32_bf16 v10, v24, v8
    v_dot2c_f32_bf16 v10, v25, v8
    v_dot2c_f32_bf16 v10, v26, v8
    v_dot2c_f32_bf16 v10, v27, v8
    v_dot2c_f32_bf16 v10, v32, v8
    v_dot2c_f32_bf16 v10, v33, v8
    v_dot2c_f32_bf16 v10, v34, v8
    v_dot2c_f32_bf16 v10, v35, v8
    v_dot2c_f32_bf16 v10, v40, v8
    v_dot2c_f32_bf16 v10, v41, v8
    v_dot2c_f32_bf16 v10, v42, v8
    v_dot2c_f32_bf16 v10, v43, v8
    v_dot2c_f32_bf16 v10, v48, v8
    v_dot2c_f32_bf16 v10, v49, v8
    v_dot2c_f32_bf16 v10, v50, v8
    v_dot2c_f32_bf16 v10, v51, v8
    v_dot2c_f32_bf16 v10, v56, v8
    v_dot2c_f32_bf16 v10, v57, v8
    v_dot2c_f32_bf16 v10, v58, v8
    v_dot2c_f32_bf16 v10, v59, v8
    v_dot2c_f32_bf16 v10, v64, v8
    v_dot2c_f32_bf16 v10, v65, v8
    v_dot2c_f32_bf16 v10, v66, v8
    v_dot2c_f32_bf16 v10, v67, v8
    v_mov_b32 v11, 0
    v_dot2c_f32_bf16 v11, v20, v8
    v_dot2c_f32_bf16 v11, v21, v8
    v_dot2c_f32_bf16 v11, v22, v8
    v_dot2c_f32_bf16 v11, v23, v8
    v_dot2c_f32_bf16 v11, v28, v8
    v_dot2c_f32_bf16 v11, v29, v8
    v_dot2c_f32_bf16 v11, v30, v8
    v_dot2c_f32_bf16 v11, v31, v8
    v_dot2c_f32_bf16 v11, v36, v8
    v_dot2c_f32_bf16 v11, v37, v8
    v_dot2c_f32_bf16 v11, v38, v8
    v_dot2c_f32_bf16 v11, v39, v8
    v_dot2c_f32_bf16 v11, v44, v8
    v_dot2c_f32_bf16 v11, v45, v8
    v_dot2c_f32_bf16 v11, v46, v8
    v_dot2c_f32_bf16 v11, v47, v8
    v_dot2c_f32_bf16 v11, v52, v8
    v_dot2c_f32_bf16 v11, v53, v8
    v_dot2c_f32_bf16 v11, v54, v8
    v_dot2c_f32_bf16 v11, v55, v8
    v_dot2c_f32_bf16 v11, v60, v8
    v_dot2c_f32_bf16 v11, v61, v8
    v_dot2c_f32_bf16 v11, v62, v8
    v_dot2c_f32_bf16 v11, v63, v8
    v_dot2c_f32_bf16 v11, v68, v8
    v_dot2c_f32_bf16 v11, v69, v8
    v_dot2c_f32_bf16 v11, v70, v8
    v_dot2c_f32_bf16 v11, v71, v8
    v_mov_b32 v12, v10
    s_nop 1
    v_permlane32_swap_b32 v12, v10
    v_add_f32 v10, v12, v10
    v_cvt_pk_bf16_f32 v12, v10, v10
    v_lshlrev_b32 v12, 16, v12
    v_sub_f32 v13, v10, v12
    v_cvt_pk_bf16_f32 v14, v10, v13
    v_mov_b32 v15, v14
    buffer_store_dwordx2 v[14:15], v4, s[24:27], s42 offen
    s_nop 1
    v_mov_b32 v12, v11
    s_nop 1
    v_permlane32_swap_b32 v12, v11
    v_add_f32 v11, v12, v11
    v_cvt_pk_bf16_f32 v12, v11, v11
    v_lshlrev_b32 v12, 16, v12
    v_sub_f32 v13, v11, v12
    v_cvt_pk_bf16_f32 v14, v11, v13
    v_mov_b32 v15, v14
    buffer_store_dwordx2 v[14:15], v4, s[24:27], s43 offen
    s_nop 1
    s_branch prep_kernel_end1
prep_kernel_up3:
    s_mov_b32 s28, s14
    s_mov_b32 s29, s15
    s_mov_b32 s30, 1605632
    s_mov_b32 s31, 0x00020000
    s_sub_u32 s32, s2, 112
    s_lshr_b32 s35, s32, 2
    s_and_b32 s36, s32, 3
    s_mul_i32 s33, s36, 401408
    s_lshl_b32 s37, s35, 7
    s_add_u32 s33, s33, s37
    s_mov_b32 s34, 3584
    v_mul_lo_u32 v9, v5, s34
    v_add_u32 v9, v9, v6
    s_mov_b32 m0, 0
    s_nop 0
    buffer_load_dwordx4 v9, s[28:31], s33 offen lds
    s_add_u32 s33, s33, 28672
    s_mov_b32 m0, 1024
    s_nop 0
    buffer_load_dwordx4 v9, s[28:31], s33 offen lds
    s_add_u32 s33, s33, 28672
    s_mov_b32 m0, 2048
    s_nop 0
    buffer_load_dwordx4 v9, s[28:31], s33 offen lds
    s_add_u32 s33, s33, 28672
    s_mov_b32 m0, 3072
    s_nop 0
    buffer_load_dwordx4 v9, s[28:31], s33 offen lds
    s_add_u32 s33, s33, 28672
    s_mov_b32 m0, 4096
    s_nop 0
    buffer_load_dwordx4 v9, s[28:31], s33 offen lds
    s_add_u32 s33, s33, 28672
    s_mov_b32 m0, 5120
    s_nop 0
    buffer_load_dwordx4 v9, s[28:31], s33 offen lds
    s_add_u32 s33, s33, 28672
    s_mov_b32 m0, 6144
    s_nop 0
    buffer_load_dwordx4 v9, s[28:31], s33 offen lds
    s_add_u32 s33, s33, 28672
    s_mov_b32 m0, 7168
    s_nop 0
    buffer_load_dwordx4 v9, s[28:31], s33 offen lds
    s_add_u32 s33, s33, 28672
    s_mov_b32 m0, 8192
    s_nop 0
    buffer_load_dwordx4 v9, s[28:31], s33 offen lds
    s_add_u32 s33, s33, 28672
    s_mov_b32 m0, 9216
    s_nop 0
    buffer_load_dwordx4 v9, s[28:31], s33 offen lds
    s_add_u32 s33, s33, 28672
    s_mov_b32 m0, 10240
    s_nop 0
    buffer_load_dwordx4 v9, s[28:31], s33 offen lds
    s_add_u32 s33, s33, 28672
    s_mov_b32 m0, 11264
    s_nop 0
    buffer_load_dwordx4 v9, s[28:31], s33 offen lds
    s_add_u32 s33, s33, 28672
    s_mov_b32 m0, 12288
    s_nop 0
    buffer_load_dwordx4 v9, s[28:31], s33 offen lds
    s_add_u32 s33, s33, 28672
    s_mov_b32 m0, 13312
    s_nop 0
    buffer_load_dwordx4 v9, s[28:31], s33 offen lds
    s_waitcnt vmcnt(0)
    ds_read_b64_tr_b16 v[16:17], v2 offset:0
    ds_read_b64_tr_b16 v[18:19], v2 offset:1024
    ds_read_b64_tr_b16 v[20:21], v2 offset:64
    ds_read_b64_tr_b16 v[22:23], v2 offset:1088
    ds_read_b64_tr_b16 v[24:25], v2 offset:2048
    ds_read_b64_tr_b16 v[26:27], v2 offset:3072
    ds_read_b64_tr_b16 v[28:29], v2 offset:2112
    ds_read_b64_tr_b16 v[30:31], v2 offset:3136
    ds_read_b64_tr_b16 v[32:33], v2 offset:4096
    ds_read_b64_tr_b16 v[34:35], v2 offset:5120
    ds_read_b64_tr_b16 v[36:37], v2 offset:4160
    ds_read_b64_tr_b16 v[38:39], v2 offset:5184
    ds_read_b64_tr_b16 v[40:41], v2 offset:6144
    ds_read_b64_tr_b16 v[42:43], v2 offset:7168
    ds_read_b64_tr_b16 v[44:45], v2 offset:6208
    ds_read_b64_tr_b16 v[46:47], v2 offset:7232
    ds_read_b64_tr_b16 v[48:49], v2 offset:8192
    ds_read_b64_tr_b16 v[50:51], v2 offset:9216
    ds_read_b64_tr_b16 v[52:53], v2 offset:8256
    ds_read_b64_tr_b16 v[54:55], v2 offset:9280
    ds_read_b64_tr_b16 v[56:57], v2 offset:10240
    ds_read_b64_tr_b16 v[58:59], v2 offset:11264
    ds_read_b64_tr_b16 v[60:61], v2 offset:10304
    ds_read_b64_tr_b16 v[62:63], v2 offset:11328
    ds_read_b64_tr_b16 v[64:65], v2 offset:12288
    ds_read_b64_tr_b16 v[66:67], v2 offset:13312
    ds_read_b64_tr_b16 v[68:69], v2 offset:12352
    ds_read_b64_tr_b16 v[70:71], v2 offset:13376
    s_mov_b32 s34, 29696
    v_mul_lo_u32 v3, v3, s34
    v_and_b32 v4, 15, v0
    v_add_u32 v4, 16, v4
    v_lshlrev_b32 v4, 4, v4
    v_add_u32 v4, v4, v3
    v_lshlrev_b32 v3, 9, v1
    v_add_u32 v3, v3, v4
    s_mul_i32 s38, s35, 118784
    s_add_u32 s38, s38, 2097152
    s_add_u32 s39, s38, 59392
    s_mul_i32 s37, s36, 7168
    s_add_u32 s40, s38, s37
    s_add_u32 s41, s39, s37
    s_lshr_b32 s37, s36, 1
    s_lshl_b32 s37, s37, 9
    s_and_b32 s42, s36, 1
    s_lshl_b32 s42, s42, 3
    s_add_u32 s37, s37, s42
    s_add_u32 s37, s37, 28672
    s_add_u32 s42, s38, s37
    s_add_u32 s43, s39, s37
    s_waitcnt lgkmcnt(0)
    buffer_store_dwordx4 v[16:19], v3, s[24:27], s40 offen offset:0
    buffer_store_dwordx4 v[20:23], v3, s[24:27], s41 offen offset:0
    buffer_store_dwordx4 v[24:27], v3, s[24:27], s40 offen offset:1024
    buffer_store_dwordx4 v[28:31], v3, s[24:27], s41 offen offset:1024
    buffer_store_dwordx4 v[32:35], v3, s[24:27], s40 offen offset:2048
    buffer_store_dwordx4 v[36:39], v3, s[24:27], s41 offen offset:2048
    buffer_store_dwordx4 v[40:43], v3, s[24:27], s40 offen offset:3072
    buffer_store_dwordx4 v[44:47], v3, s[24:27], s41 offen offset:3072
    s_add_u32 s40, s40, 4096
    s_add_u32 s41, s41, 4096
    buffer_store_dwordx4 v[48:51], v3, s[24:27], s40 offen offset:0
    buffer_store_dwordx4 v[52:55], v3, s[24:27], s41 offen offset:0
    buffer_store_dwordx4 v[56:59], v3, s[24:27], s40 offen offset:1024
    buffer_store_dwordx4 v[60:63], v3, s[24:27], s41 offen offset:1024
    buffer_store_dwordx4 v[64:67], v3, s[24:27], s40 offen offset:2048
    buffer_store_dwordx4 v[68:71], v3, s[24:27], s41 offen offset:2048
    v_mov_b32 v10, 0
    v_dot2c_f32_bf16 v10, v16, v8
    v_dot2c_f32_bf16 v10, v17, v8
    v_dot2c_f32_bf16 v10, v18, v8
    v_dot2c_f32_bf16 v10, v19, v8
    v_dot2c_f32_bf16 v10, v24, v8
    v_dot2c_f32_bf16 v10, v25, v8
    v_dot2c_f32_bf16 v10, v26, v8
    v_dot2c_f32_bf16 v10, v27, v8
    v_dot2c_f32_bf16 v10, v32, v8
    v_dot2c_f32_bf16 v10, v33, v8
    v_dot2c_f32_bf16 v10, v34, v8
    v_dot2c_f32_bf16 v10, v35, v8
    v_dot2c_f32_bf16 v10, v40, v8
    v_dot2c_f32_bf16 v10, v41, v8
    v_dot2c_f32_bf16 v10, v42, v8
    v_dot2c_f32_bf16 v10, v43, v8
    v_dot2c_f32_bf16 v10, v48, v8
    v_dot2c_f32_bf16 v10, v49, v8
    v_dot2c_f32_bf16 v10, v50, v8
    v_dot2c_f32_bf16 v10, v51, v8
    v_dot2c_f32_bf16 v10, v56, v8
    v_dot2c_f32_bf16 v10, v57, v8
    v_dot2c_f32_bf16 v10, v58, v8
    v_dot2c_f32_bf16 v10, v59, v8
    v_dot2c_f32_bf16 v10, v64, v8
    v_dot2c_f32_bf16 v10, v65, v8
    v_dot2c_f32_bf16 v10, v66, v8
    v_dot2c_f32_bf16 v10, v67, v8
    v_mov_b32 v11, 0
    v_dot2c_f32_bf16 v11, v20, v8
    v_dot2c_f32_bf16 v11, v21, v8
    v_dot2c_f32_bf16 v11, v22, v8
    v_dot2c_f32_bf16 v11, v23, v8
    v_dot2c_f32_bf16 v11, v28, v8
    v_dot2c_f32_bf16 v11, v29, v8
    v_dot2c_f32_bf16 v11, v30, v8
    v_dot2c_f32_bf16 v11, v31, v8
    v_dot2c_f32_bf16 v11, v36, v8
    v_dot2c_f32_bf16 v11, v37, v8
    v_dot2c_f32_bf16 v11, v38, v8
    v_dot2c_f32_bf16 v11, v39, v8
    v_dot2c_f32_bf16 v11, v44, v8
    v_dot2c_f32_bf16 v11, v45, v8
    v_dot2c_f32_bf16 v11, v46, v8
    v_dot2c_f32_bf16 v11, v47, v8
    v_dot2c_f32_bf16 v11, v52, v8
    v_dot2c_f32_bf16 v11, v53, v8
    v_dot2c_f32_bf16 v11, v54, v8
    v_dot2c_f32_bf16 v11, v55, v8
    v_dot2c_f32_bf16 v11, v60, v8
    v_dot2c_f32_bf16 v11, v61, v8
    v_dot2c_f32_bf16 v11, v62, v8
    v_dot2c_f32_bf16 v11, v63, v8
    v_dot2c_f32_bf16 v11, v68, v8
    v_dot2c_f32_bf16 v11, v69, v8
    v_dot2c_f32_bf16 v11, v70, v8
    v_dot2c_f32_bf16 v11, v71, v8
    v_mov_b32 v12, v10
    s_nop 1
    v_permlane32_swap_b32 v12, v10
    v_add_f32 v10, v12, v10
    v_cvt_pk_bf16_f32 v12, v10, v10
    v_lshlrev_b32 v12, 16, v12
    v_sub_f32 v13, v10, v12
    v_cvt_pk_bf16_f32 v14, v10, v13
    v_mov_b32 v15, v14
    buffer_store_dwordx2 v[14:15], v4, s[24:27], s42 offen
    s_nop 1
    v_mov_b32 v12, v11
    s_nop 1
    v_permlane32_swap_b32 v12, v11
    v_add_f32 v11, v12, v11
    v_cvt_pk_bf16_f32 v12, v11, v11
    v_lshlrev_b32 v12, 16, v12
    v_sub_f32 v13, v11, v12
    v_cvt_pk_bf16_f32 v14, v11, v13
    v_mov_b32 v15, v14
    buffer_store_dwordx2 v[14:15], v4, s[24:27], s43 offen
    s_nop 1
    s_branch prep_kernel_end1
prep_kernel_qkv4:
    s_mov_b32 s28, s6
    s_mov_b32 s29, s7
    s_mov_b32 s30, 1204224
    s_mov_b32 s31, 0x00020000
    s_sub_u32 s32, s2, 224
    s_lshr_b32 s35, s32, 5
    s_bfe_u32 s44, s32, 0x30002
    s_and_b32 s36, s32, 3
    s_mul_i32 s33, s36, 301056
    s_mul_i32 s37, s35, 896
    s_add_u32 s33, s33, s37
    s_mul_i32 s37, s44, 112
    s_add_u32 s33, s33, s37
    s_mov_b32 s34, 2688
    v_mul_lo_u32 v9, v5, s34
    v_add_u32 v9, v9, v6
    s_mov_b32 m0, 0
    s_nop 0
    buffer_load_dwordx4 v9, s[28:31], s33 offen lds
    s_add_u32 s33, s33, 21504
    s_mov_b32 m0, 1024
    s_nop 0
    buffer_load_dwordx4 v9, s[28:31], s33 offen lds
    s_add_u32 s33, s33, 21504
    s_mov_b32 m0, 2048
    s_nop 0
    buffer_load_dwordx4 v9, s[28:31], s33 offen lds
    s_add_u32 s33, s33, 21504
    s_mov_b32 m0, 3072
    s_nop 0
    buffer_load_dwordx4 v9, s[28:31], s33 offen lds
    s_add_u32 s33, s33, 21504
    s_mov_b32 m0, 4096
    s_nop 0
    buffer_load_dwordx4 v9, s[28:31], s33 offen lds
    s_add_u32 s33, s33, 21504
    s_mov_b32 m0, 5120
    s_nop 0
    buffer_load_dwordx4 v9, s[28:31], s33 offen lds
    s_add_u32 s33, s33, 21504
    s_mov_b32 m0, 6144
    s_nop 0
    buffer_load_dwordx4 v9, s[28:31], s33 offen lds
    s_add_u32 s33, s33, 21504
    s_mov_b32 m0, 7168
    s_nop 0
    buffer_load_dwordx4 v9, s[28:31], s33 offen lds
    s_add_u32 s33, s33, 21504
    s_mov_b32 m0, 8192
    s_nop 0
    buffer_load_dwordx4 v9, s[28:31], s33 offen lds
    s_add_u32 s33, s33, 21504
    s_mov_b32 m0, 9216
    s_nop 0
    buffer_load_dwordx4 v9, s[28:31], s33 offen lds
    s_add_u32 s33, s33, 21504
    s_mov_b32 m0, 10240
    s_nop 0
    buffer_load_dwordx4 v9, s[28:31], s33 offen lds
    s_add_u32 s33, s33, 21504
    s_mov_b32 m0, 11264
    s_nop 0
    buffer_load_dwordx4 v9, s[28:31], s33 offen lds
    s_add_u32 s33, s33, 21504
    s_mov_b32 m0, 12288
    s_nop 0
    buffer_load_dwordx4 v9, s[28:31], s33 offen lds
    s_add_u32 s33, s33, 21504
    s_mov_b32 m0, 13312
    s_nop 0
    buffer_load_dwordx4 v9, s[28:31], s33 offen lds
    s_waitcnt vmcnt(0)
    ds_read_b64_tr_b16 v[16:17], v2 offset:0
    ds_read_b64_tr_b16 v[18:19], v2 offset:1024
    ds_read_b64_tr_b16 v[20:21], v2 offset:56
    ds_read_b64_tr_b16 v[22:23], v2 offset:1080
    ds_read_b64_tr_b16 v[24:25], v2 offset:2048
    ds_read_b64_tr_b16 v[26:27], v2 offset:3072
    ds_read_b64_tr_b16 v[28:29], v2 offset:2104
    ds_read_b64_tr_b16 v[30:31], v2 offset:3128
    ds_read_b64_tr_b16 v[32:33], v2 offset:4096
    ds_read_b64_tr_b16 v[34:35], v2 offset:5120
    ds_read_b64_tr_b16 v[36:37], v2 offset:4152
    ds_read_b64_tr_b16 v[38:39], v2 offset:5176
    ds_read_b64_tr_b16 v[40:41], v2 offset:6144
    ds_read_b64_tr_b16 v[42:43], v2 offset:7168
    ds_read_b64_tr_b16 v[44:45], v2 offset:6200
    ds_read_b64_tr_b16 v[46:47], v2 offset:7224
    ds_read_b64_tr_b16 v[48:49], v2 offset:8192
    ds_read_b64_tr_b16 v[50:51], v2 offset:9216
    ds_read_b64_tr_b16 v[52:53], v2 offset:8248
    ds_read_b64_tr_b16 v[54:55], v2 offset:9272
    ds_read_b64_tr_b16 v[56:57], v2 offset:10240
    ds_read_b64_tr_b16 v[58:59], v2 offset:11264
    ds_read_b64_tr_b16 v[60:61], v2 offset:10296
    ds_read_b64_tr_b16 v[62:63], v2 offset:11320
    ds_read_b64_tr_b16 v[64:65], v2 offset:12288
    ds_read_b64_tr_b16 v[66:67], v2 offset:13312
    ds_read_b64_tr_b16 v[68:69], v2 offset:12344
    ds_read_b64_tr_b16 v[70:71], v2 offset:13368
    s_mul_i32 s38, s44, 178176
    s_mul_i32 s37, s35, 29696
    s_add_u32 s38, s38, s37
    s_add_u32 s38, s38, 0
    s_add_u32 s39, s38, 89088
    s_mul_i32 s37, s36, 7168
    s_add_u32 s40, s38, s37
    s_add_u32 s41, s39, s37
    s_lshr_b32 s37, s36, 1
    s_lshl_b32 s37, s37, 9
    s_and_b32 s42, s36, 1
    s_lshl_b32 s42, s42, 3
    s_add_u32 s37, s37, s42
    s_add_u32 s37, s37, 28672
    s_add_u32 s42, s38, s37
    s_add_u32 s43, s39, s37
    v_and_b32 v4, 31, v0
    v_cmp_gt_u32 vcc, 28, v4
    v_lshlrev_b32 v4, 4, v4
    s_waitcnt lgkmcnt(0)
    v_cndmask_b32 v16, 0, v16, vcc
    v_cndmask_b32 v17, 0, v17, vcc
    v_cndmask_b32 v18, 0, v18, vcc
    v_cndmask_b32 v19, 0, v19, vcc
    v_cndmask_b32 v20, 0, v20, vcc
    v_cndmask_b32 v21, 0, v21, vcc
    v_cndmask_b32 v22, 0, v22, vcc
    v_cndmask_b32 v23, 0, v23, vcc
    v_cndmask_b32 v24, 0, v24, vcc
    v_cndmask_b32 v25, 0, v25, vcc
    v_cndmask_b32 v26, 0, v26, vcc
    v_cndmask_b32 v27, 0, v27, vcc
    v_cndmask_b32 v28, 0, v28, vcc
    v_cndmask_b32 v29, 0, v29, vcc
    v_cndmask_b32 v30, 0, v30, vcc
    v_cndmask_b32 v31, 0, v31, vcc
    v_cndmask_b32 v32, 0, v32, vcc
    v_cndmask_b32 v33, 0, v33, vcc
    v_cndmask_b32 v34, 0, v34, vcc
    v_cndmask_b32 v35, 0, v35, vcc
    v_cndmask_b32 v36, 0, v36, vcc
    v_cndmask_b32 v37, 0, v37, vcc
    v_cndmask_b32 v38, 0, v38, vcc
    v_cndmask_b32 v39, 0, v39, vcc
    v_cndmask_b32 v40, 0, v40, vcc
    v_cndmask_b32 v41, 0, v41, vcc
    v_cndmask_b32 v42, 0, v42, vcc
    v_cndmask_b32 v43, 0, v43, vcc
    v_cndmask_b32 v44, 0, v44, vcc
    v_cndmask_b32 v45, 0, v45, vcc
    v_cndmask_b32 v46, 0, v46, vcc
    v_cndmask_b32 v47, 0, v47, vcc
    v_cndmask_b32 v48, 0, v48, vcc
    v_cndmask_b32 v49, 0, v49, vcc
    v_cndmask_b32 v50, 0, v50, vcc
    v_cndmask_b32 v51, 0, v51, vcc
    v_cndmask_b32 v52, 0, v52, vcc
    v_cndmask_b32 v53, 0, v53, vcc
    v_cndmask_b32 v54, 0, v54, vcc
    v_cndmask_b32 v55, 0, v55, vcc
    v_cndmask_b32 v56, 0, v56, vcc
    v_cndmask_b32 v57, 0, v57, vcc
    v_cndmask_b32 v58, 0, v58, vcc
    v_cndmask_b32 v59, 0, v59, vcc
    v_cndmask_b32 v60, 0, v60, vcc
    v_cndmask_b32 v61, 0, v61, vcc
    v_cndmask_b32 v62, 0, v62, vcc
    v_cndmask_b32 v63, 0, v63, vcc
    v_cndmask_b32 v64, 0, v64, vcc
    v_cndmask_b32 v65, 0, v65, vcc
    v_cndmask_b32 v66, 0, v66, vcc
    v_cndmask_b32 v67, 0, v67, vcc
    v_cndmask_b32 v68, 0, v68, vcc
    v_cndmask_b32 v69, 0, v69, vcc
    v_cndmask_b32 v70, 0, v70, vcc
    v_cndmask_b32 v71, 0, v71, vcc
    buffer_store_dwordx4 v[16:19], v7, s[24:27], s40 offen offset:0
    buffer_store_dwordx4 v[20:23], v7, s[24:27], s41 offen offset:0
    buffer_store_dwordx4 v[24:27], v7, s[24:27], s40 offen offset:1024
    buffer_store_dwordx4 v[28:31], v7, s[24:27], s41 offen offset:1024
    buffer_store_dwordx4 v[32:35], v7, s[24:27], s40 offen offset:2048
    buffer_store_dwordx4 v[36:39], v7, s[24:27], s41 offen offset:2048
    buffer_store_dwordx4 v[40:43], v7, s[24:27], s40 offen offset:3072
    buffer_store_dwordx4 v[44:47], v7, s[24:27], s41 offen offset:3072
    s_add_u32 s40, s40, 4096
    s_add_u32 s41, s41, 4096
    buffer_store_dwordx4 v[48:51], v7, s[24:27], s40 offen offset:0
    buffer_store_dwordx4 v[52:55], v7, s[24:27], s41 offen offset:0
    buffer_store_dwordx4 v[56:59], v7, s[24:27], s40 offen offset:1024
    buffer_store_dwordx4 v[60:63], v7, s[24:27], s41 offen offset:1024
    buffer_store_dwordx4 v[64:67], v7, s[24:27], s40 offen offset:2048
    buffer_store_dwordx4 v[68:71], v7, s[24:27], s41 offen offset:2048
    v_mov_b32 v10, 0
    v_dot2c_f32_bf16 v10, v16, v8
    v_dot2c_f32_bf16 v10, v17, v8
    v_dot2c_f32_bf16 v10, v18, v8
    v_dot2c_f32_bf16 v10, v19, v8
    v_dot2c_f32_bf16 v10, v24, v8
    v_dot2c_f32_bf16 v10, v25, v8
    v_dot2c_f32_bf16 v10, v26, v8
    v_dot2c_f32_bf16 v10, v27, v8
    v_dot2c_f32_bf16 v10, v32, v8
    v_dot2c_f32_bf16 v10, v33, v8
    v_dot2c_f32_bf16 v10, v34, v8
    v_dot2c_f32_bf16 v10, v35, v8
    v_dot2c_f32_bf16 v10, v40, v8
    v_dot2c_f32_bf16 v10, v41, v8
    v_dot2c_f32_bf16 v10, v42, v8
    v_dot2c_f32_bf16 v10, v43, v8
    v_dot2c_f32_bf16 v10, v48, v8
    v_dot2c_f32_bf16 v10, v49, v8
    v_dot2c_f32_bf16 v10, v50, v8
    v_dot2c_f32_bf16 v10, v51, v8
    v_dot2c_f32_bf16 v10, v56, v8
    v_dot2c_f32_bf16 v10, v57, v8
    v_dot2c_f32_bf16 v10, v58, v8
    v_dot2c_f32_bf16 v10, v59, v8
    v_dot2c_f32_bf16 v10, v64, v8
    v_dot2c_f32_bf16 v10, v65, v8
    v_dot2c_f32_bf16 v10, v66, v8
    v_dot2c_f32_bf16 v10, v67, v8
    v_mov_b32 v11, 0
    v_dot2c_f32_bf16 v11, v20, v8
    v_dot2c_f32_bf16 v11, v21, v8
    v_dot2c_f32_bf16 v11, v22, v8
    v_dot2c_f32_bf16 v11, v23, v8
    v_dot2c_f32_bf16 v11, v28, v8
    v_dot2c_f32_bf16 v11, v29, v8
    v_dot2c_f32_bf16 v11, v30, v8
    v_dot2c_f32_bf16 v11, v31, v8
    v_dot2c_f32_bf16 v11, v36, v8
    v_dot2c_f32_bf16 v11, v37, v8
    v_dot2c_f32_bf16 v11, v38, v8
    v_dot2c_f32_bf16 v11, v39, v8
    v_dot2c_f32_bf16 v11, v44, v8
    v_dot2c_f32_bf16 v11, v45, v8
    v_dot2c_f32_bf16 v11, v46, v8
    v_dot2c_f32_bf16 v11, v47, v8
    v_dot2c_f32_bf16 v11, v52, v8
    v_dot2c_f32_bf16 v11, v53, v8
    v_dot2c_f32_bf16 v11, v54, v8
    v_dot2c_f32_bf16 v11, v55, v8
    v_dot2c_f32_bf16 v11, v60, v8
    v_dot2c_f32_bf16 v11, v61, v8
    v_dot2c_f32_bf16 v11, v62, v8
    v_dot2c_f32_bf16 v11, v63, v8
    v_dot2c_f32_bf16 v11, v68, v8
    v_dot2c_f32_bf16 v11, v69, v8
    v_dot2c_f32_bf16 v11, v70, v8
    v_dot2c_f32_bf16 v11, v71, v8
    v_mov_b32 v12, v10
    s_nop 1
    v_permlane32_swap_b32 v12, v10
    v_add_f32 v10, v12, v10
    v_cvt_pk_bf16_f32 v12, v10, v10
    v_lshlrev_b32 v12, 16, v12
    v_sub_f32 v13, v10, v12
    v_cvt_pk_bf16_f32 v14, v10, v13
    v_mov_b32 v15, v14
    buffer_store_dwordx2 v[14:15], v4, s[24:27], s42 offen
    s_nop 1
    v_mov_b32 v12, v11
    s_nop 1
    v_permlane32_swap_b32 v12, v11
    v_add_f32 v11, v12, v11
    v_cvt_pk_bf16_f32 v12, v11, v11
    v_lshlrev_b32 v12, 16, v12
    v_sub_f32 v13, v11, v12
    v_cvt_pk_bf16_f32 v14, v11, v13
    v_mov_b32 v15, v14
    buffer_store_dwordx2 v[14:15], v4, s[24:27], s43 offen
    s_nop 1
    s_branch prep_kernel_end1
prep_kernel_wo5:
    s_mov_b32 s28, s8
    s_mov_b32 s29, s9
    s_mov_b32 s30, 401408
    s_mov_b32 s31, 0x00020000
    s_sub_u32 s32, s2, 320
    s_lshr_b32 s35, s32, 2
    s_and_b32 s36, s32, 3
    s_mul_i32 s33, s36, 100352
    s_lshl_b32 s37, s35, 7
    s_add_u32 s33, s33, s37
    s_mov_b32 s34, 896
    v_mul_lo_u32 v9, v5, s34
    v_add_u32 v9, v9, v6
    s_mov_b32 m0, 0
    s_nop 0
    buffer_load_dwordx4 v9, s[28:31], s33 offen lds
    s_add_u32 s33, s33, 7168
    s_mov_b32 m0, 1024
    s_nop 0
    buffer_load_dwordx4 v9, s[28:31], s33 offen lds
    s_add_u32 s33, s33, 7168
    s_mov_b32 m0, 2048
    s_nop 0
    buffer_load_dwordx4 v9, s[28:31], s33 offen lds
    s_add_u32 s33, s33, 7168
    s_mov_b32 m0, 3072
    s_nop 0
    buffer_load_dwordx4 v9, s[28:31], s33 offen lds
    s_add_u32 s33, s33, 7168
    s_mov_b32 m0, 4096
    s_nop 0
    buffer_load_dwordx4 v9, s[28:31], s33 offen lds
    s_add_u32 s33, s33, 7168
    s_mov_b32 m0, 5120
    s_nop 0
    buffer_load_dwordx4 v9, s[28:31], s33 offen lds
    s_add_u32 s33, s33, 7168
    s_mov_b32 m0, 6144
    s_nop 0
    buffer_load_dwordx4 v9, s[28:31], s33 offen lds
    s_add_u32 s33, s33, 7168
    s_mov_b32 m0, 7168
    s_nop 0
    buffer_load_dwordx4 v9, s[28:31], s33 offen lds
    s_add_u32 s33, s33, 7168
    s_mov_b32 m0, 8192
    s_nop 0
    buffer_load_dwordx4 v9, s[28:31], s33 offen lds
    s_add_u32 s33, s33, 7168
    s_mov_b32 m0, 9216
    s_nop 0
    buffer_load_dwordx4 v9, s[28:31], s33 offen lds
    s_add_u32 s33, s33, 7168
    s_mov_b32 m0, 10240
    s_nop 0
    buffer_load_dwordx4 v9, s[28:31], s33 offen lds
    s_add_u32 s33, s33, 7168
    s_mov_b32 m0, 11264
    s_nop 0
    buffer_load_dwordx4 v9, s[28:31], s33 offen lds
    s_add_u32 s33, s33, 7168
    s_mov_b32 m0, 12288
    s_nop 0
    buffer_load_dwordx4 v9, s[28:31], s33 offen lds
    s_add_u32 s33, s33, 7168
    s_mov_b32 m0, 13312
    s_nop 0
    buffer_load_dwordx4 v9, s[28:31], s33 offen lds
    s_waitcnt vmcnt(0)
    ds_read_b64_tr_b16 v[16:17], v2 offset:0
    ds_read_b64_tr_b16 v[18:19], v2 offset:1024
    ds_read_b64_tr_b16 v[20:21], v2 offset:64
    ds_read_b64_tr_b16 v[22:23], v2 offset:1088
    ds_read_b64_tr_b16 v[24:25], v2 offset:2048
    ds_read_b64_tr_b16 v[26:27], v2 offset:3072
    ds_read_b64_tr_b16 v[28:29], v2 offset:2112
    ds_read_b64_tr_b16 v[30:31], v2 offset:3136
    ds_read_b64_tr_b16 v[32:33], v2 offset:3584
    ds_read_b64_tr_b16 v[34:35], v2 offset:4608
    ds_read_b64_tr_b16 v[36:37], v2 offset:3648
    ds_read_b64_tr_b16 v[38:39], v2 offset:4672
    ds_read_b64_tr_b16 v[40:41], v2 offset:5632
    ds_read_b64_tr_b16 v[42:43], v2 offset:6656
    ds_read_b64_tr_b16 v[44:45], v2 offset:5696
    ds_read_b64_tr_b16 v[46:47], v2 offset:6720
    ds_read_b64_tr_b16 v[48:49], v2 offset:7168
    ds_read_b64_tr_b16 v[50:51], v2 offset:8192
    ds_read_b64_tr_b16 v[52:53], v2 offset:7232
    ds_read_b64_tr_b16 v[54:55], v2 offset:8256
    ds_read_b64_tr_b16 v[56:57], v2 offset:9216
    ds_read_b64_tr_b16 v[58:59], v2 offset:10240
    ds_read_b64_tr_b16 v[60:61], v2 offset:9280
    ds_read_b64_tr_b16 v[62:63], v2 offset:10304
    ds_read_b64_tr_b16 v[64:65], v2 offset:10752
    ds_read_b64_tr_b16 v[66:67], v2 offset:11776
    ds_read_b64_tr_b16 v[68:69], v2 offset:10816
    ds_read_b64_tr_b16 v[70:71], v2 offset:11840
    ds_read_b64_tr_b16 v[72:73], v2 offset:12800
    ds_read_b64_tr_b16 v[74:75], v2 offset:13824
    ds_read_b64_tr_b16 v[76:77], v2 offset:12864
    ds_read_b64_tr_b16 v[78:79], v2 offset:13888
    s_lshl_b32 s38, s35, 16
    s_add_u32 s38, s38, 6291456
    s_lshl_b32 s37, s36, 13
    s_add_u32 s40, s38, s37
    s_add_u32 s41, s40, 32768
    v_cmp_gt_u32 vcc, 32, v0
    s_waitcnt lgkmcnt(0)
    s_nop 0
    v_cndmask_b32 v26, 0, v26, vcc
    v_cndmask_b32 v27, 0, v27, vcc
    v_cndmask_b32 v30, 0, v30, vcc
    v_cndmask_b32 v31, 0, v31, vcc
    v_cndmask_b32 v42, 0, v42, vcc
    v_cndmask_b32 v43, 0, v43, vcc
    v_cndmask_b32 v46, 0, v46, vcc
    v_cndmask_b32 v47, 0, v47, vcc
    v_cndmask_b32 v58, 0, v58, vcc
    v_cndmask_b32 v59, 0, v59, vcc
    v_cndmask_b32 v62, 0, v62, vcc
    v_cndmask_b32 v63, 0, v63, vcc
    v_cndmask_b32 v74, 0, v74, vcc
    v_cndmask_b32 v75, 0, v75, vcc
    v_cndmask_b32 v78, 0, v78, vcc
    v_cndmask_b32 v79, 0, v79, vcc
    buffer_store_dwordx4 v[16:19], v7, s[24:27], s40 offen offset:0
    buffer_store_dwordx4 v[20:23], v7, s[24:27], s41 offen offset:0
    buffer_store_dwordx4 v[24:27], v7, s[24:27], s40 offen offset:1024
    buffer_store_dwordx4 v[28:31], v7, s[24:27], s41 offen offset:1024
    buffer_store_dwordx4 v[32:35], v7, s[24:27], s40 offen offset:2048
    buffer_store_dwordx4 v[36:39], v7, s[24:27], s41 offen offset:2048
    buffer_store_dwordx4 v[40:43], v7, s[24:27], s40 offen offset:3072
    buffer_store_dwordx4 v[44:47], v7, s[24:27], s41 offen offset:3072
    s_add_u32 s40, s40, 4096
    s_add_u32 s41, s41, 4096
    buffer_store_dwordx4 v[48:51], v7, s[24:27], s40 offen offset:0
    buffer_store_dwordx4 v[52:55], v7, s[24:27], s41 offen offset:0
    buffer_store_dwordx4 v[56:59], v7, s[24:27], s40 offen offset:1024
    buffer_store_dwordx4 v[60:63], v7, s[24:27], s41 offen offset:1024
    buffer_store_dwordx4 v[64:67], v7, s[24:27], s40 offen offset:2048
    buffer_store_dwordx4 v[68:71], v7, s[24:27], s41 offen offset:2048
    buffer_store_dwordx4 v[72:75], v7, s[24:27], s40 offen offset:3072
    buffer_store_dwordx4 v[76:79], v7, s[24:27], s41 offen offset:3072
    s_branch prep_kernel_end1
prep_kernel_wd6:
    s_mov_b32 s28, s16
    s_mov_b32 s29, s17
    s_mov_b32 s30, 1605632
    s_mov_b32 s31, 0x00020000
    s_sub_u32 s32, s2, 348
    s_lshr_b32 s35, s32, 4
    s_and_b32 s36, s32, 15
    s_mul_i32 s33, s36, 100352
    s_lshl_b32 s37, s35, 7
    s_add_u32 s33, s33, s37
    s_mov_b32 s34, 896
    v_mul_lo_u32 v9, v5, s34
    v_add_u32 v9, v9, v6
    s_mov_b32 m0, 0
    s_nop 0
    buffer_load_dwordx4 v9, s[28:31], s33 offen lds
    s_add_u32 s33, s33, 7168
    s_mov_b32 m0, 1024
    s_nop 0
    buffer_load_dwordx4 v9, s[28:31], s33 offen lds
    s_add_u32 s33, s33, 7168
    s_mov_b32 m0, 2048
    s_nop 0
    buffer_load_dwordx4 v9, s[28:31], s33 offen lds
    s_add_u32 s33, s33, 7168
    s_mov_b32 m0, 3072
    s_nop 0
    buffer_load_dwordx4 v9, s[28:31], s33 offen lds
    s_add_u32 s33, s33, 7168
    s_mov_b32 m0, 4096
    s_nop 0
    buffer_load_dwordx4 v9, s[28:31], s33 offen lds
    s_add_u32 s33, s33, 7168
    s_mov_b32 m0, 5120
    s_nop 0
    buffer_load_dwordx4 v9, s[28:31], s33 offen lds
    s_add_u32 s33, s33, 7168
    s_mov_b32 m0, 6144
    s_nop 0
    buffer_load_dwordx4 v9, s[28:31], s33 offen lds
    s_add_u32 s33, s33, 7168
    s_mov_b32 m0, 7168
    s_nop 0
    buffer_load_dwordx4 v9, s[28:31], s33 offen lds
    s_add_u32 s33, s33, 7168
    s_mov_b32 m0, 8192
    s_nop 0
    buffer_load_dwordx4 v9, s[28:31], s33 offen lds
    s_add_u32 s33, s33, 7168
    s_mov_b32 m0, 9216
    s_nop 0
    buffer_load_dwordx4 v9, s[28:31], s33 offen lds
    s_add_u32 s33, s33, 7168
    s_mov_b32 m0, 10240
    s_nop 0
    buffer_load_dwordx4 v9, s[28:31], s33 offen lds
    s_add_u32 s33, s33, 7168
    s_mov_b32 m0, 11264
    s_nop 0
    buffer_load_dwordx4 v9, s[28:31], s33 offen lds
    s_add_u32 s33, s33, 7168
    s_mov_b32 m0, 12288
    s_nop 0
    buffer_load_dwordx4 v9, s[28:31], s33 offen lds
    s_add_u32 s33, s33, 7168
    s_mov_b32 m0, 13312
    s_nop 0
    buffer_load_dwordx4 v9, s[28:31], s33 offen lds
    s_waitcnt vmcnt(0)
    ds_read_b64_tr_b16 v[16:17], v2 offset:0
    ds_read_b64_tr_b16 v[18:19], v2 offset:1024
    ds_read_b64_tr_b16 v[20:21], v2 offset:64
    ds_read_b64_tr_b16 v[22:23], v2 offset:1088
    ds_read_b64_tr_b16 v[24:25], v2 offset:2048
    ds_read_b64_tr_b16 v[26:27], v2 offset:3072
    ds_read_b64_tr_b16 v[28:29], v2 offset:2112
    ds_read_b64_tr_b16 v[30:31], v2 offset:3136
    ds_read_b64_tr_b16 v[32:33], v2 offset:4096
    ds_read_b64_tr_b16 v[34:35], v2 offset:5120
    ds_read_b64_tr_b16 v[36:37], v2 offset:4160
    ds_read_b64_tr_b16 v[38:39], v2 offset:5184
    ds_read_b64_tr_b16 v[40:41], v2 offset:6144
    ds_read_b64_tr_b16 v[42:43], v2 offset:7168
    ds_read_b64_tr_b16 v[44:45], v2 offset:6208
    ds_read_b64_tr_b16 v[46:47], v2 offset:7232
    ds_read_b64_tr_b16 v[48:49], v2 offset:8192
    ds_read_b64_tr_b16 v[50:51], v2 offset:9216
    ds_read_b64_tr_b16 v[52:53], v2 offset:8256
    ds_read_b64_tr_b16 v[54:55], v2 offset:9280
    ds_read_b64_tr_b16 v[56:57], v2 offset:10240
    ds_read_b64_tr_b16 v[58:59], v2 offset:11264
    ds_read_b64_tr_b16 v[60:61], v2 offset:10304
    ds_read_b64_tr_b16 v[62:63], v2 offset:11328
    ds_read_b64_tr_b16 v[64:65], v2 offset:12288
    ds_read_b64_tr_b16 v[66:67], v2 offset:13312
    ds_read_b64_tr_b16 v[68:69], v2 offset:12352
    ds_read_b64_tr_b16 v[70:71], v2 offset:13376
    s_mul_i32 s38, s35, 229376
    s_add_u32 s38, s38, 7340032
    s_lshl_b32 s37, s36, 12
    s_add_u32 s40, s38, s37
    s_add_u32 s41, s40, 114688
    s_mul_i32 s37, s36, 3072
    s_add_u32 s42, s38, s37
    s_add_u32 s42, s42, 65536
    s_add_u32 s43, s42, 114688
    s_waitcnt lgkmcnt(0)
    buffer_store_dwordx4 v[16:19], v7, s[24:27], s40 offen offset:0
    buffer_store_dwordx4 v[20:23], v7, s[24:27], s41 offen offset:0
    buffer_store_dwordx4 v[24:27], v7, s[24:27], s40 offen offset:1024
    buffer_store_dwordx4 v[28:31], v7, s[24:27], s41 offen offset:1024
    buffer_store_dwordx4 v[32:35], v7, s[24:27], s40 offen offset:2048
    buffer_store_dwordx4 v[36:39], v7, s[24:27], s41 offen offset:2048
    buffer_store_dwordx4 v[40:43], v7, s[24:27], s40 offen offset:3072
    buffer_store_dwordx4 v[44:47], v7, s[24:27], s41 offen offset:3072
    buffer_store_dwordx4 v[48:51], v7, s[24:27], s42 offen offset:0
    buffer_store_dwordx4 v[52:55], v7, s[24:27], s43 offen offset:0
    buffer_store_dwordx4 v[56:59], v7, s[24:27], s42 offen offset:1024
    buffer_store_dwordx4 v[60:63], v7, s[24:27], s43 offen offset:1024
    buffer_store_dwordx4 v[64:67], v7, s[24:27], s42 offen offset:2048
    buffer_store_dwordx4 v[68:71], v7, s[24:27], s43 offen offset:2048
    s_branch prep_kernel_end1
prep_kernel_t10:
    s_sub_u32 s32, s2, 680
    s_cmp_ge_u32 s32, 25
    s_cselect_b32 s28, s14, s12
    s_cselect_b32 s29, s15, s13
    s_cselect_b32 s33, 25, 0
    s_cmp_ge_u32 s32, 50
    s_cselect_b32 s28, s16, s28
    s_cselect_b32 s29, s17, s29
    s_cselect_b32 s33, 50, s33
    s_mov_b32 s30, 1605632
    s_mov_b32 s31, 0x00020000
    s_sub_u32 s32, s32, s33
    s_lshl_b32 s33, s32, 16
    v_lshlrev_b32 v4, 7, v0
    buffer_load_dword v16, v4, s[28:31], s33 offen
    s_add_u32 s33, s33, 8192
    buffer_load_dword v17, v4, s[28:31], s33 offen
    s_add_u32 s33, s33, 8192
    buffer_load_dword v18, v4, s[28:31], s33 offen
    s_add_u32 s33, s33, 8192
    buffer_load_dword v19, v4, s[28:31], s33 offen
    s_add_u32 s33, s33, 8192
    buffer_load_dword v20, v4, s[28:31], s33 offen
    s_add_u32 s33, s33, 8192
    buffer_load_dword v21, v4, s[28:31], s33 offen
    s_add_u32 s33, s33, 8192
    buffer_load_dword v22, v4, s[28:31], s33 offen
    s_add_u32 s33, s33, 8192
    buffer_load_dword v23, v4, s[28:31], s33 offen
    s_add_u32 s33, s33, 8192
    s_branch prep_kernel_end1
prep_kernel_c9:
    s_getpc_b64 s[32:33]
prep_pc_anchor:
    s_add_u32 s32, s32, mega_kernel-prep_pc_anchor
    s_addc_u32 s33, s33, 0
    v_lshlrev_b32 v4, 6, v0
    v_min_u32 v5, mega_code_end-mega_kernel-4, v4
    global_load_dword v16, v5, s[32:33]
    v_add_u32 v4, 4096, v4
    v_min_u32 v5, mega_code_end-mega_kernel-4, v4
    global_load_dword v17, v5, s[32:33]
    v_add_u32 v4, 4096, v4
    v_min_u32 v5, mega_code_end-mega_kernel-4, v4
    global_load_dword v18, v5, s[32:33]
    v_add_u32 v4, 4096, v4
    v_min_u32 v5, mega_code_end-mega_kernel-4, v4
    global_load_dword v19, v5, s[32:33]
    v_add_u32 v4, 4096, v4
    v_min_u32 v5, mega_code_end-mega_kernel-4, v4
    global_load_dword v20, v5, s[32:33]
    v_add_u32 v4, 4096, v4
    v_min_u32 v5, mega_code_end-mega_kernel-4, v4
    global_load_dword v21, v5, s[32:33]
    v_add_u32 v4, 4096, v4
    v_min_u32 v5, mega_code_end-mega_kernel-4, v4
    global_load_dword v22, v5, s[32:33]
    v_add_u32 v4, 4096, v4
    v_min_u32 v5, mega_code_end-mega_kernel-4, v4
    global_load_dword v23, v5, s[32:33]
    v_add_u32 v4, 4096, v4
    v_min_u32 v5, mega_code_end-mega_kernel-4, v4
    global_load_dword v24, v5, s[32:33]
    v_add_u32 v4, 4096, v4
    v_min_u32 v5, mega_code_end-mega_kernel-4, v4
    global_load_dword v25, v5, s[32:33]
    v_add_u32 v4, 4096, v4
    v_min_u32 v5, mega_code_end-mega_kernel-4, v4
    global_load_dword v26, v5, s[32:33]
    v_add_u32 v4, 4096, v4
    v_min_u32 v5, mega_code_end-mega_kernel-4, v4
    global_load_dword v27, v5, s[32:33]
    v_add_u32 v4, 4096, v4
    v_min_u32 v5, mega_code_end-mega_kernel-4, v4
    global_load_dword v28, v5, s[32:33]
    v_add_u32 v4, 4096, v4
    v_min_u32 v5, mega_code_end-mega_kernel-4, v4
    global_load_dword v29, v5, s[32:33]
    v_add_u32 v4, 4096, v4
    v_min_u32 v5, mega_code_end-mega_kernel-4, v4
    global_load_dword v30, v5, s[32:33]
    v_add_u32 v4, 4096, v4
    v_min_u32 v5, mega_code_end-mega_kernel-4, v4
    global_load_dword v31, v5, s[32:33]
    v_add_u32 v4, 4096, v4
    v_min_u32 v5, mega_code_end-mega_kernel-4, v4
    global_load_dword v32, v5, s[32:33]
    v_add_u32 v4, 4096, v4
    s_branch prep_kernel_end1
prep_kernel_z8:
    s_sub_u32 s32, s2, 588
    s_lshl_b32 s33, s32, 14
    s_add_u32 s33, s33, 70254592
    v_mov_b32 v12, 0
    v_mov_b32 v13, 0
    v_mov_b32 v14, 0
    v_mov_b32 v15, 0
    buffer_store_dwordx4 v[12:15], v7, s[24:27], s33 offen offset:0
    buffer_store_dwordx4 v[12:15], v7, s[24:27], s33 offen offset:1024
    buffer_store_dwordx4 v[12:15], v7, s[24:27], s33 offen offset:2048
    buffer_store_dwordx4 v[12:15], v7, s[24:27], s33 offen offset:3072
    s_add_u32 s33, s33, 4096
    buffer_store_dwordx4 v[12:15], v7, s[24:27], s33 offen offset:0
    buffer_store_dwordx4 v[12:15], v7, s[24:27], s33 offen offset:1024
    buffer_store_dwordx4 v[12:15], v7, s[24:27], s33 offen offset:2048
    buffer_store_dwordx4 v[12:15], v7, s[24:27], s33 offen offset:3072
    s_add_u32 s33, s33, 4096
    buffer_store_dwordx4 v[12:15], v7, s[24:27], s33 offen offset:0
    buffer_store_dwordx4 v[12:15], v7, s[24:27], s33 offen offset:1024
    buffer_store_dwordx4 v[12:15], v7, s[24:27], s33 offen offset:2048
    buffer_store_dwordx4 v[12:15], v7, s[24:27], s33 offen offset:3072
    s_add_u32 s33, s33, 4096
    buffer_store_dwordx4 v[12:15], v7, s[24:27], s33 offen offset:0
    buffer_store_dwordx4 v[12:15], v7, s[24:27], s33 offen offset:1024
    buffer_store_dwordx4 v[12:15], v7, s[24:27], s33 offen offset:2048
    buffer_store_dwordx4 v[12:15], v7, s[24:27], s33 offen offset:3072
    s_add_u32 s33, s33, 4096
    s_branch prep_kernel_end1
prep_kernel_x7:
    s_mov_b32 s28, s4
    s_mov_b32 s29, s5
    s_mov_b32 s30, 1835008
    s_mov_b32 s31, 0x00020000
    s_sub_u32 s32, s2, 460
    s_lshr_b32 s35, s32, 1
    s_and_b32 s36, s32, 1
    s_mul_i32 s33, s35, 28672
    s_mul_i32 s37, s36, 448
    s_add_u32 s34, s33, s37
    v_and_b32 v4, 31, v0
    s_movk_i32 s37, 896
    v_mul_lo_u32 v4, v4, s37
    v_lshlrev_b32 v3, 4, v1
    v_add_u32 v4, v4, v3
    buffer_load_dwordx4 v[16:19], v4, s[28:31], s34 offen offset:0
    buffer_load_dwordx4 v[20:23], v4, s[28:31], s34 offen offset:32
    buffer_load_dwordx4 v[24:27], v4, s[28:31], s34 offen offset:64
    buffer_load_dwordx4 v[28:31], v4, s[28:31], s34 offen offset:96
    buffer_load_dwordx4 v[32:35], v4, s[28:31], s34 offen offset:128
    buffer_load_dwordx4 v[36:39], v4, s[28:31], s34 offen offset:160
    buffer_load_dwordx4 v[40:43], v4, s[28:31], s34 offen offset:192
    buffer_load_dwordx4 v[44:47], v4, s[28:31], s34 offen offset:224
    buffer_load_dwordx4 v[48:51], v4, s[28:31], s34 offen offset:256
    buffer_load_dwordx4 v[52:55], v4, s[28:31], s34 offen offset:288
    buffer_load_dwordx4 v[56:59], v4, s[28:31], s34 offen offset:320
    buffer_load_dwordx4 v[60:63], v4, s[28:31], s34 offen offset:352
    buffer_load_dwordx4 v[64:67], v4, s[28:31], s34 offen offset:384
    buffer_load_dwordx4 v[68:71], v4, s[28:31], s34 offen offset:416
    s_mul_i32 s37, s36, 14336
    s_add_u32 s40, s33, s37
    s_add_u32 s40, s40, 10485760
    v_mov_b32 v10, 0
    v_mov_b32 v11, 0
    s_waitcnt vmcnt(13)
    v_permlane32_swap_b32 v16, v18
    v_permlane32_swap_b32 v17, v19
    buffer_store_dwordx4 v[16:19], v7, s[24:27], s40 offen offset:0
    v_dot2c_f32_bf16 v10, v16, v8
    v_dot2c_f32_bf16 v11, v16, v16
    v_dot2c_f32_bf16 v10, v17, v8
    v_dot2c_f32_bf16 v11, v17, v17
    v_dot2c_f32_bf16 v10, v18, v8
    v_dot2c_f32_bf16 v11, v18, v18
    v_dot2c_f32_bf16 v10, v19, v8
    v_dot2c_f32_bf16 v11, v19, v19
    s_waitcnt vmcnt(13)
    v_permlane32_swap_b32 v20, v22
    v_permlane32_swap_b32 v21, v23
    buffer_store_dwordx4 v[20:23], v7, s[24:27], s40 offen offset:1024
    v_dot2c_f32_bf16 v10, v20, v8
    v_dot2c_f32_bf16 v11, v20, v20
    v_dot2c_f32_bf16 v10, v21, v8
    v_dot2c_f32_bf16 v11, v21, v21
    v_dot2c_f32_bf16 v10, v22, v8
    v_dot2c_f32_bf16 v11, v22, v22
    v_dot2c_f32_bf16 v10, v23, v8
    v_dot2c_f32_bf16 v11, v23, v23
    s_waitcnt vmcnt(13)
    v_permlane32_swap_b32 v24, v26
    v_permlane32_swap_b32 v25, v27
    buffer_store_dwordx4 v[24:27], v7, s[24:27], s40 offen offset:2048
    v_dot2c_f32_bf16 v10, v24, v8
    v_dot2c_f32_bf16 v11, v24, v24
    v_dot2c_f32_bf16 v10, v25, v8
    v_dot2c_f32_bf16 v11, v25, v25
    v_dot2c_f32_bf16 v10, v26, v8
    v_dot2c_f32_bf16 v11, v26, v26
    v_dot2c_f32_bf16 v10, v27, v8
    v_dot2c_f32_bf16 v11, v27, v27
    s_waitcnt vmcnt(13)
    v_permlane32_swap_b32 v28, v30
    v_permlane32_swap_b32 v29, v31
    buffer_store_dwordx4 v[28:31], v7, s[24:27], s40 offen offset:3072
    v_dot2c_f32_bf16 v10, v28, v8
    v_dot2c_f32_bf16 v11, v28, v28
    v_dot2c_f32_bf16 v10, v29, v8
    v_dot2c_f32_bf16 v11, v29, v29
    v_dot2c_f32_bf16 v10, v30, v8
    v_dot2c_f32_bf16 v11, v30, v30
    v_dot2c_f32_bf16 v10, v31, v8
    v_dot2c_f32_bf16 v11, v31, v31
    s_waitcnt vmcnt(13)
    v_permlane32_swap_b32 v32, v34
    v_permlane32_swap_b32 v33, v35
    s_add_u32 s40, s40, 4096
    buffer_store_dwordx4 v[32:35], v7, s[24:27], s40 offen offset:0
    v_dot2c_f32_bf16 v10, v32, v8
    v_dot2c_f32_bf16 v11, v32, v32
    v_dot2c_f32_bf16 v10, v33, v8
    v_dot2c_f32_bf16 v11, v33, v33
    v_dot2c_f32_bf16 v10, v34, v8
    v_dot2c_f32_bf16 v11, v34, v34
    v_dot2c_f32_bf16 v10, v35, v8
    v_dot2c_f32_bf16 v11, v35, v35
    s_waitcnt vmcnt(13)
    v_permlane32_swap_b32 v36, v38
    v_permlane32_swap_b32 v37, v39
    buffer_store_dwordx4 v[36:39], v7, s[24:27], s40 offen offset:1024
    v_dot2c_f32_bf16 v10, v36, v8
    v_dot2c_f32_bf16 v11, v36, v36
    v_dot2c_f32_bf16 v10, v37, v8
    v_dot2c_f32_bf16 v11, v37, v37
    v_dot2c_f32_bf16 v10, v38, v8
    v_dot2c_f32_bf16 v11, v38, v38
    v_dot2c_f32_bf16 v10, v39, v8
    v_dot2c_f32_bf16 v11, v39, v39
    s_waitcnt vmcnt(13)
    v_permlane32_swap_b32 v40, v42
    v_permlane32_swap_b32 v41, v43
    buffer_store_dwordx4 v[40:43], v7, s[24:27], s40 offen offset:2048
    v_dot2c_f32_bf16 v10, v40, v8
    v_dot2c_f32_bf16 v11, v40, v40
    v_dot2c_f32_bf16 v10, v41, v8
    v_dot2c_f32_bf16 v11, v41, v41
    v_dot2c_f32_bf16 v10, v42, v8
    v_dot2c_f32_bf16 v11, v42, v42
    v_dot2c_f32_bf16 v10, v43, v8
    v_dot2c_f32_bf16 v11, v43, v43
    s_waitcnt vmcnt(13)
    v_permlane32_swap_b32 v44, v46
    v_permlane32_swap_b32 v45, v47
    buffer_store_dwordx4 v[44:47], v7, s[24:27], s40 offen offset:3072
    v_dot2c_f32_bf16 v10, v44, v8
    v_dot2c_f32_bf16 v11, v44, v44
    v_dot2c_f32_bf16 v10, v45, v8
    v_dot2c_f32_bf16 v11, v45, v45
    v_dot2c_f32_bf16 v10, v46, v8
    v_dot2c_f32_bf16 v11, v46, v46
    v_dot2c_f32_bf16 v10, v47, v8
    v_dot2c_f32_bf16 v11, v47, v47
    s_waitcnt vmcnt(13)
    v_permlane32_swap_b32 v48, v50
    v_permlane32_swap_b32 v49, v51
    s_add_u32 s40, s40, 4096
    buffer_store_dwordx4 v[48:51], v7, s[24:27], s40 offen offset:0
    v_dot2c_f32_bf16 v10, v48, v8
    v_dot2c_f32_bf16 v11, v48, v48
    v_dot2c_f32_bf16 v10, v49, v8
    v_dot2c_f32_bf16 v11, v49, v49
    v_dot2c_f32_bf16 v10, v50, v8
    v_dot2c_f32_bf16 v11, v50, v50
    v_dot2c_f32_bf16 v10, v51, v8
    v_dot2c_f32_bf16 v11, v51, v51
    s_waitcnt vmcnt(13)
    v_permlane32_swap_b32 v52, v54
    v_permlane32_swap_b32 v53, v55
    buffer_store_dwordx4 v[52:55], v7, s[24:27], s40 offen offset:1024
    v_dot2c_f32_bf16 v10, v52, v8
    v_dot2c_f32_bf16 v11, v52, v52
    v_dot2c_f32_bf16 v10, v53, v8
    v_dot2c_f32_bf16 v11, v53, v53
    v_dot2c_f32_bf16 v10, v54, v8
    v_dot2c_f32_bf16 v11, v54, v54
    v_dot2c_f32_bf16 v10, v55, v8
    v_dot2c_f32_bf16 v11, v55, v55
    s_waitcnt vmcnt(13)
    v_permlane32_swap_b32 v56, v58
    v_permlane32_swap_b32 v57, v59
    buffer_store_dwordx4 v[56:59], v7, s[24:27], s40 offen offset:2048
    v_dot2c_f32_bf16 v10, v56, v8
    v_dot2c_f32_bf16 v11, v56, v56
    v_dot2c_f32_bf16 v10, v57, v8
    v_dot2c_f32_bf16 v11, v57, v57
    v_dot2c_f32_bf16 v10, v58, v8
    v_dot2c_f32_bf16 v11, v58, v58
    v_dot2c_f32_bf16 v10, v59, v8
    v_dot2c_f32_bf16 v11, v59, v59
    s_waitcnt vmcnt(13)
    v_permlane32_swap_b32 v60, v62
    v_permlane32_swap_b32 v61, v63
    buffer_store_dwordx4 v[60:63], v7, s[24:27], s40 offen offset:3072
    v_dot2c_f32_bf16 v10, v60, v8
    v_dot2c_f32_bf16 v11, v60, v60
    v_dot2c_f32_bf16 v10, v61, v8
    v_dot2c_f32_bf16 v11, v61, v61
    v_dot2c_f32_bf16 v10, v62, v8
    v_dot2c_f32_bf16 v11, v62, v62
    v_dot2c_f32_bf16 v10, v63, v8
    v_dot2c_f32_bf16 v11, v63, v63
    s_waitcnt vmcnt(13)
    v_permlane32_swap_b32 v64, v66
    v_permlane32_swap_b32 v65, v67
    s_add_u32 s40, s40, 4096
    buffer_store_dwordx4 v[64:67], v7, s[24:27], s40 offen offset:0
    v_dot2c_f32_bf16 v10, v64, v8
    v_dot2c_f32_bf16 v11, v64, v64
    v_dot2c_f32_bf16 v10, v65, v8
    v_dot2c_f32_bf16 v11, v65, v65
    v_dot2c_f32_bf16 v10, v66, v8
    v_dot2c_f32_bf16 v11, v66, v66
    v_dot2c_f32_bf16 v10, v67, v8
    v_dot2c_f32_bf16 v11, v67, v67
    s_waitcnt vmcnt(13)
    v_permlane32_swap_b32 v68, v70
    v_permlane32_swap_b32 v69, v71
    buffer_store_dwordx4 v[68:71], v7, s[24:27], s40 offen offset:1024
    v_dot2c_f32_bf16 v10, v68, v8
    v_dot2c_f32_bf16 v11, v68, v68
    v_dot2c_f32_bf16 v10, v69, v8
    v_dot2c_f32_bf16 v11, v69, v69
    v_dot2c_f32_bf16 v10, v70, v8
    v_dot2c_f32_bf16 v11, v70, v70
    v_dot2c_f32_bf16 v10, v71, v8
    v_dot2c_f32_bf16 v11, v71, v71
    s_nop 1
    v_mov_b32 v12, v10
    v_mov_b32 v13, v11
    s_nop 0
    v_permlane32_swap_b32 v12, v10
    v_permlane32_swap_b32 v13, v11
    v_add_f32 v10, v12, v10
    v_add_f32 v11, v13, v11
    v_cmp_gt_u32 vcc, 32, v0
    s_mul_i32 s37, s35, 3584
    s_mul_i32 s38, s36, 1792
    s_add_u32 s37, s37, s38
    s_add_u32 s37, s37, 35651584
    v_cndmask_b32 v10, 0, v10, vcc
    v_cndmask_b32 v11, 0, v11, vcc
    v_lshlrev_b32 v12, 3, v0
    v_mov_b32 v14, 0
    v_mov_b32 v15, 0
    buffer_store_dwordx2 v[10:11], v12, s[24:27], s37 offen
    buffer_store_dwordx2 v[14:15], v12, s[24:27], s37 offen offset:512
    buffer_store_dwordx2 v[14:15], v12, s[24:27], s37 offen offset:1024
    buffer_store_dwordx2 v[14:15], v12, s[24:27], s37 offen offset:1280
prep_kernel_end1:
    s_endpgm
.globl mega_kernel
.p2align 8
.type mega_kernel,@function
mega_kernel:
    s_cmp_ge_u32 s2, 256
    s_cbranch_scc1 mega_kernel_end1
    s_load_dwordx2 s[4:5], s[0:1], 72
    s_load_dwordx2 s[6:7], s[0:1], 56
    v_lshrrev_b32 v3, 6, v0
    v_and_b32 v0, 63, v0
    v_readfirstlane_b32 s12, v3
    v_lshlrev_b32 v1, 4, v0
    v_lshlrev_b32 v2, 2, v0
    s_and_b32 s13, s12, 3
    s_lshl_b32 s14, s13, 10
    s_lshl_b32 s15, s13, 8
    s_and_b32 s16, s2, 7
    s_lshr_b32 s17, s2, 3
    s_lshr_b32 s18, s16, 1
    s_lshl_b32 s18, s18, 2
    s_lshr_b32 s40, s17, 3
    s_add_u32 s18, s18, s40
    s_and_b32 s19, s16, 1
    s_lshl_b32 s19, s19, 3
    s_and_b32 s41, s17, 7
    s_add_u32 s19, s19, s41
    s_cmp_ge_u32 s41, 7
    s_cselect_b32 s42, 0, s41
    s_lshl_b32 s42, s42, 12
    s_mov_b32 s26, s42
    s_add_u32 s42, s42, 4096
    s_cmp_ge_u32 s42, 28672
    s_cselect_b32 s42, 0, s42
    s_mov_b32 s27, s42
    s_add_u32 s42, s42, 4096
    s_cmp_ge_u32 s42, 28672
    s_cselect_b32 s42, 0, s42
    s_mov_b32 s28, s42
    s_add_u32 s42, s42, 4096
    s_cmp_ge_u32 s42, 28672
    s_cselect_b32 s42, 0, s42
    s_mov_b32 s29, s42
    s_add_u32 s42, s42, 4096
    s_cmp_ge_u32 s42, 28672
    s_cselect_b32 s42, 0, s42
    s_mov_b32 s30, s42
    s_add_u32 s42, s42, 4096
    s_cmp_ge_u32 s42, 28672
    s_cselect_b32 s42, 0, s42
    s_mov_b32 s31, s42
    s_add_u32 s42, s42, 4096
    s_cmp_ge_u32 s42, 28672
    s_cselect_b32 s42, 0, s42
    s_mov_b32 s32, s42
    s_mov_b32 s20, s18
    s_mov_b32 s21, s19
    s_mov_b32 s33, s26
    s_mov_b32 s34, s27
    s_mov_b32 s35, s28
    s_mov_b32 s36, s29
    s_mov_b32 s37, s30
    s_mov_b32 s38, s31
    s_mov_b32 s39, s32
    s_lshl_b32 s22, s16, 2
    s_and_b32 s40, s17, 3
    s_add_u32 s22, s22, s40
    s_lshr_b32 s23, s17, 2
    s_cmp_lt_u32 s17, 28
    s_cselect_b32 s24, 1, 0
    s_lshr_b32 s56, s22, 1
    s_lshl_b32 s56, s56, 4
    s_and_b32 s40, s22, 1
    s_mul_i32 s41, s40, 7
    s_add_u32 s56, s56, s41
    s_add_u32 s56, s56, s23
    s_mov_b64 s[60:61], 0xffff
    s_mov_b64 s[58:59], 0x3fff
    s_mov_b32 s25, 0x40000
    v_and_b32 v3, 15, v0
    v_lshlrev_b32 v3, 2, v3
    v_add_u32 v3, 163776, v3
    v_mov_b32 v4, 0
    ds_write_b32 v3, v4
    s_waitcnt lgkmcnt(0)
    s_mov_b32 s8, s4
    s_mov_b32 s9, s5
    s_mov_b32 s10, 268435456
    s_mov_b32 s11, 0x00020000
    s_cmp_ge_u32 s12, 4
    s_cbranch_scc1 mega_kernel_loader2
    s_setprio 3
    s_lshl_b32 s40, s18, 2
    s_add_u32 s40, s40, s13
    s_mul_i32 s41, s40, 28672
    s_add_u32 s41, s41, 10485760
    s_mul_i32 s42, s40, 3584
    s_add_u32 s42, s42, 35651584
    v_mov_b32 v5, 0x3f803f80
    v_lshrrev_b32 v228, 5, v0
    v_mul_u32_u24 v228, 1792, v228
    v_and_b32 v229, 31, v0
    v_lshl_add_u32 v228, v229, 3, v228
    v_mov_b32 v10, v1
    v_add_u32 v11, 59392, v1
    v_add_u32 v12, 118784, v1
    s_lshl_b32 s46, s19, 6
    s_add_u32 s46, s46, s40
    s_lshl_b32 s46, s46, 12
    s_add_u32 s46, s46, 37748736
    s_lshl_b32 s47, s13, 12
    s_add_u32 s47, s47, 89088
    v_add_u32 v13, s47, v1
    s_lshl_b32 s48, s18, 4
    s_add_u32 s48, s48, s19
    s_lshl_b32 s48, s48, 8
    s_add_u32 s48, s48, 70254592
    s_add_u32 s48, s48, 4096
    s_add_u32 s43, s41, s26
    buffer_load_dwordx4 v[16:19], v1, s[8:11], s43 offen offset:0 sc1
    buffer_load_dwordx4 v[20:23], v1, s[8:11], s43 offen offset:1024 sc1
    buffer_load_dwordx4 v[24:27], v1, s[8:11], s43 offen offset:2048 sc1
    buffer_load_dwordx4 v[28:31], v1, s[8:11], s43 offen offset:3072 sc1
    s_add_u32 s43, s41, s27
    buffer_load_dwordx4 v[32:35], v1, s[8:11], s43 offen offset:0 sc1
    buffer_load_dwordx4 v[36:39], v1, s[8:11], s43 offen offset:1024 sc1
    buffer_load_dwordx4 v[40:43], v1, s[8:11], s43 offen offset:2048 sc1
    buffer_load_dwordx4 v[44:47], v1, s[8:11], s43 offen offset:3072 sc1
    buffer_load_dwordx2 v[212:213], v228, s[8:11], s42 offen offset:0 sc1
    buffer_load_dwordx2 v[214:215], v228, s[8:11], s42 offen offset:256 sc1
    buffer_load_dwordx2 v[216:217], v228, s[8:11], s42 offen offset:512 sc1
    buffer_load_dwordx2 v[218:219], v228, s[8:11], s42 offen offset:768 sc1
    buffer_load_dwordx2 v[220:221], v228, s[8:11], s42 offen offset:1024 sc1
    buffer_load_dwordx2 v[222:223], v228, s[8:11], s42 offen offset:1280 sc1
    buffer_load_dwordx2 v[224:225], v228, s[8:11], s42 offen offset:1536 sc1
    s_barrier
    ds_read_b128 v[132:135], v10 offset:29696
    ds_read_b128 v[136:139], v11 offset:0
    ds_read_b128 v[140:143], v10 offset:30720
    ds_read_b128 v[144:147], v11 offset:1024
    ds_read_b128 v[148:151], v10 offset:31744
    ds_read_b128 v[152:155], v11 offset:2048
    ds_read_b128 v[156:159], v10 offset:32768
    s_waitcnt vmcnt(11)
    s_waitcnt lgkmcnt(5)
    v_mfma_f32_32x32x16_bf16 v[164:179], v[132:135], v[16:19], 0
    s_add_u32 s43, s41, s28
    buffer_load_dwordx4 v[48:51], v1, s[8:11], s43 offen offset:0 sc1
    buffer_load_dwordx4 v[52:55], v1, s[8:11], s43 offen offset:1024 sc1
    ds_read_b128 v[160:163], v11 offset:3072
    v_mfma_f32_32x32x16_bf16 v[180:195], v[16:19], v[136:139], 0
    buffer_load_dwordx4 v[56:59], v1, s[8:11], s43 offen offset:2048 sc1
    buffer_load_dwordx4 v[60:63], v1, s[8:11], s43 offen offset:3072 sc1
    s_barrier
    ds_read_b128 v[132:135], v10 offset:33792
    s_waitcnt lgkmcnt(5)
    v_mfma_f32_32x32x16_bf16 v[164:179], v[140:143], v[20:23], v[164:179]
    s_add_u32 s43, s41, s29
    buffer_load_dwordx4 v[64:67], v1, s[8:11], s43 offen offset:0 sc1
    buffer_load_dwordx4 v[68:71], v1, s[8:11], s43 offen offset:1024 sc1
    ds_read_b128 v[136:139], v11 offset:4096
    v_mfma_f32_32x32x16_bf16 v[180:195], v[20:23], v[144:147], v[180:195]
    buffer_load_dwordx4 v[72:75], v1, s[8:11], s43 offen offset:2048 sc1
    buffer_load_dwordx4 v[76:79], v1, s[8:11], s43 offen offset:3072 sc1
    ds_read_b128 v[140:143], v10 offset:34816
    s_waitcnt lgkmcnt(5)
    v_mfma_f32_32x32x16_bf16 v[164:179], v[148:151], v[24:27], v[164:179]
    s_add_u32 s43, s41, s30
    buffer_load_dwordx4 v[80:83], v1, s[8:11], s43 offen offset:0 sc1
    buffer_load_dwordx4 v[84:87], v1, s[8:11], s43 offen offset:1024 sc1
    ds_read_b128 v[144:147], v11 offset:5120
    v_mfma_f32_32x32x16_bf16 v[180:195], v[24:27], v[152:155], v[180:195]
    buffer_load_dwordx4 v[88:91], v1, s[8:11], s43 offen offset:2048 sc1
    buffer_load_dwordx4 v[92:95], v1, s[8:11], s43 offen offset:3072 sc1
    ds_read_b128 v[148:151], v10 offset:35840
    s_waitcnt lgkmcnt(5)
    v_mfma_f32_32x32x16_bf16 v[164:179], v[156:159], v[28:31], v[164:179]
    s_add_u32 s43, s41, s31
    buffer_load_dwordx4 v[96:99], v1, s[8:11], s43 offen offset:0 sc1
    ds_read_b128 v[152:155], v11 offset:6144
    v_mfma_f32_32x32x16_bf16 v[180:195], v[28:31], v[160:163], v[180:195]
    buffer_load_dwordx4 v[100:103], v1, s[8:11], s43 offen offset:1024 sc1
    ds_read_b128 v[156:159], v10 offset:36864
    s_waitcnt vmcnt(21)
    s_waitcnt lgkmcnt(5)
    v_mfma_f32_32x32x16_bf16 v[164:179], v[132:135], v[32:35], v[164:179]
    buffer_load_dwordx4 v[104:107], v1, s[8:11], s43 offen offset:2048 sc1
    ds_read_b128 v[160:163], v11 offset:7168
    v_mfma_f32_32x32x16_bf16 v[180:195], v[32:35], v[136:139], v[180:195]
    buffer_load_dwordx4 v[108:111], v1, s[8:11], s43 offen offset:3072 sc1
    s_barrier
    ds_read_b128 v[132:135], v10 offset:37888
    s_waitcnt lgkmcnt(5)
    v_mfma_f32_32x32x16_bf16 v[164:179], v[140:143], v[36:39], v[164:179]
    s_add_u32 s43, s41, s32
    buffer_load_dwordx4 v[112:115], v1, s[8:11], s43 offen offset:0 sc1
    ds_read_b128 v[136:139], v11 offset:8192
    v_mfma_f32_32x32x16_bf16 v[180:195], v[36:39], v[144:147], v[180:195]
    buffer_load_dwordx4 v[116:119], v1, s[8:11], s43 offen offset:1024 sc1
    ds_read_b128 v[140:143], v10 offset:38912
    s_waitcnt lgkmcnt(5)
    v_mfma_f32_32x32x16_bf16 v[164:179], v[148:151], v[40:43], v[164:179]
    buffer_load_dwordx4 v[120:123], v1, s[8:11], s43 offen offset:2048 sc1
    ds_read_b128 v[144:147], v11 offset:9216
    v_mfma_f32_32x32x16_bf16 v[180:195], v[40:43], v[152:155], v[180:195]
    buffer_load_dwordx4 v[124:127], v1, s[8:11], s43 offen offset:3072 sc1
    ds_read_b128 v[148:151], v10 offset:39936
    s_waitcnt lgkmcnt(5)
    v_mfma_f32_32x32x16_bf16 v[164:179], v[156:159], v[44:47], v[164:179]
    ds_read_b128 v[152:155], v11 offset:10240
    v_mfma_f32_32x32x16_bf16 v[180:195], v[44:47], v[160:163], v[180:195]
    ds_read_b128 v[156:159], v10 offset:40960
    s_waitcnt vmcnt(16)
    s_waitcnt lgkmcnt(5)
    v_mfma_f32_32x32x16_bf16 v[164:179], v[132:135], v[48:51], v[164:179]
    v_add_f32 v3, v212, v214
    v_add_f32 v4, v213, v215
    ds_read_b128 v[160:163], v11 offset:11264
    v_mfma_f32_32x32x16_bf16 v[180:195], v[48:51], v[136:139], v[180:195]
    v_add_f32 v3, v3, v216
    v_add_f32 v4, v4, v217
    v_add_f32 v3, v3, v218
    s_barrier
    ds_read_b128 v[132:135], v10 offset:41984
    s_waitcnt lgkmcnt(5)
    v_mfma_f32_32x32x16_bf16 v[164:179], v[140:143], v[52:55], v[164:179]
    v_add_f32 v4, v4, v219
    v_add_f32 v3, v3, v220
    v_add_f32 v4, v4, v221
    ds_read_b128 v[136:139], v11 offset:12288
    v_mfma_f32_32x32x16_bf16 v[180:195], v[52:55], v[144:147], v[180:195]
    v_add_f32 v3, v3, v222
    v_add_f32 v4, v4, v223
    v_add_f32 v3, v3, v224
    ds_read_b128 v[140:143], v10 offset:43008
    s_waitcnt lgkmcnt(5)
    v_mfma_f32_32x32x16_bf16 v[164:179], v[148:151], v[56:59], v[164:179]
    v_add_f32 v4, v4, v225
    v_mov_b32 v228, v3
    v_mov_b32 v229, v4
    ds_read_b128 v[144:147], v11 offset:13312
    v_mfma_f32_32x32x16_bf16 v[180:195], v[56:59], v[152:155], v[180:195]
    v_permlane32_swap_b32 v228, v3
    v_permlane32_swap_b32 v229, v4
    v_add_f32 v3, v228, v3
    ds_read_b128 v[148:151], v10 offset:44032
    s_waitcnt lgkmcnt(5)
    v_mfma_f32_32x32x16_bf16 v[164:179], v[156:159], v[60:63], v[164:179]
    v_add_f32 v4, v229, v4
    v_mul_f32 v3, 0xbb124925, v3
    v_mul_f32 v4, 0x3b124925, v4
    ds_read_b128 v[152:155], v11 offset:14336
    v_mfma_f32_32x32x16_bf16 v[180:195], v[60:63], v[160:163], v[180:195]
    v_fma_f32 v4, -v3, v3, v4
    v_max_f32 v4, 0, v4
    v_add_f32 v9, 0x3727c5ac, v4
    ds_read_b128 v[156:159], v10 offset:45056
    s_waitcnt vmcnt(12)
    s_waitcnt lgkmcnt(5)
    v_mfma_f32_32x32x16_bf16 v[164:179], v[132:135], v[64:67], v[164:179]
    v_cvt_pk_bf16_f32 v128, v3, v3
    v_rsq_f32 v6, v9
    v_lshlrev_b32 v228, 16, v128
    ds_read_b128 v[160:163], v11 offset:15360
    v_mfma_f32_32x32x16_bf16 v[180:195], v[64:67], v[136:139], v[180:195]
    v_sub_f32 v228, v3, v228
    v_cvt_pk_bf16_f32 v129, v228, v228
    v_mov_b32 v130, v128
    s_barrier
    ds_read_b128 v[132:135], v10 offset:46080
    s_waitcnt lgkmcnt(5)
    v_mfma_f32_32x32x16_bf16 v[164:179], v[140:143], v[68:71], v[164:179]
    v_mov_b32 v131, v129
    v_mul_f32 v7, 0x3e8b97f6, v6
    s_lshl_b32 s45, s13, 7
    ds_read_b128 v[136:139], v11 offset:16384
    v_mfma_f32_32x32x16_bf16 v[180:195], v[68:71], v[144:147], v[180:195]
    s_add_u32 s45, s45, 138240
    v_and_b32 v228, 31, v0
    v_lshlrev_b32 v228, 2, v228
    ds_read_b128 v[140:143], v10 offset:47104
    s_waitcnt lgkmcnt(5)
    v_mfma_f32_32x32x16_bf16 v[164:179], v[148:151], v[72:75], v[164:179]
    v_add_u32 v228, s45, v228
    ds_write_b32 v228, v6
    v_lshrrev_b32 v229, 5, v0
    ds_read_b128 v[144:147], v11 offset:17408
    v_mfma_f32_32x32x16_bf16 v[180:195], v[72:75], v[152:155], v[180:195]
    v_lshlrev_b32 v229, 4, v229
    v_add_u32 v229, s45, v229
    ds_read_b128 v[212:215], v229 offset:0
    ds_read_b128 v[148:151], v10 offset:48128
    s_waitcnt lgkmcnt(7)
    v_mfma_f32_32x32x16_bf16 v[164:179], v[156:159], v[76:79], v[164:179]
    ds_read_b128 v[216:219], v229 offset:32
    ds_read_b128 v[220:223], v229 offset:64
    ds_read_b128 v[224:227], v229 offset:96
    ds_read_b128 v[152:155], v11 offset:18432
    v_mfma_f32_32x32x16_bf16 v[180:195], v[76:79], v[160:163], v[180:195]
    ds_read_b128 v[156:159], v10 offset:49152
    s_waitcnt vmcnt(8)
    s_waitcnt lgkmcnt(10)
    v_mfma_f32_32x32x16_bf16 v[164:179], v[132:135], v[80:83], v[164:179]
    ds_read_b128 v[160:163], v11 offset:19456
    v_mfma_f32_32x32x16_bf16 v[180:195], v[80:83], v[136:139], v[180:195]
    s_barrier
    ds_read_b128 v[132:135], v10 offset:50176
    s_waitcnt lgkmcnt(9)
    v_mfma_f32_32x32x16_bf16 v[164:179], v[140:143], v[84:87], v[164:179]
    ds_read_b128 v[136:139], v11 offset:20480
    v_mfma_f32_32x32x16_bf16 v[180:195], v[84:87], v[144:147], v[180:195]
    ds_read_b128 v[140:143], v10 offset:51200
    s_waitcnt lgkmcnt(5)
    v_mfma_f32_32x32x16_bf16 v[164:179], v[148:151], v[88:91], v[164:179]
    ds_read_b128 v[144:147], v11 offset:21504
    v_mfma_f32_32x32x16_bf16 v[180:195], v[88:91], v[152:155], v[180:195]
    ds_read_b128 v[148:151], v10 offset:52224
    s_waitcnt lgkmcnt(5)
    v_mfma_f32_32x32x16_bf16 v[164:179], v[156:159], v[92:95], v[164:179]
    ds_read_b128 v[152:155], v11 offset:22528
    v_mfma_f32_32x32x16_bf16 v[180:195], v[92:95], v[160:163], v[180:195]
    ds_read_b128 v[156:159], v10 offset:53248
    s_waitcnt vmcnt(4)
    s_waitcnt lgkmcnt(5)
    v_mfma_f32_32x32x16_bf16 v[164:179], v[132:135], v[96:99], v[164:179]
    ds_read_b128 v[160:163], v11 offset:23552
    v_mfma_f32_32x32x16_bf16 v[180:195], v[96:99], v[136:139], v[180:195]
    s_barrier
    ds_read_b128 v[132:135], v10 offset:54272
    s_waitcnt lgkmcnt(5)
    v_mfma_f32_32x32x16_bf16 v[164:179], v[140:143], v[100:103], v[164:179]
    ds_read_b128 v[136:139], v11 offset:24576
    v_mfma_f32_32x32x16_bf16 v[180:195], v[100:103], v[144:147], v[180:195]
    ds_read_b128 v[140:143], v10 offset:55296
    s_waitcnt lgkmcnt(5)
    v_mfma_f32_32x32x16_bf16 v[164:179], v[148:151], v[104:107], v[164:179]
    ds_read_b128 v[144:147], v11 offset:25600
    v_mfma_f32_32x32x16_bf16 v[180:195], v[104:107], v[152:155], v[180:195]
    ds_read_b128 v[148:151], v10 offset:56320
    s_waitcnt lgkmcnt(5)
    v_mfma_f32_32x32x16_bf16 v[164:179], v[156:159], v[108:111], v[164:179]
    ds_read_b128 v[152:155], v11 offset:26624
    v_mfma_f32_32x32x16_bf16 v[180:195], v[108:111], v[160:163], v[180:195]
    ds_read_b128 v[156:159], v10 offset:57344
    s_waitcnt vmcnt(0)
    s_waitcnt lgkmcnt(5)
    v_mfma_f32_32x32x16_bf16 v[164:179], v[132:135], v[112:115], v[164:179]
    ds_read_b128 v[160:163], v11 offset:27648
    v_mfma_f32_32x32x16_bf16 v[180:195], v[112:115], v[136:139], v[180:195]
    s_barrier
    ds_read_b128 v[132:135], v10 offset:58368
    s_waitcnt lgkmcnt(5)
    v_mfma_f32_32x32x16_bf16 v[164:179], v[140:143], v[116:119], v[164:179]
    ds_read_b128 v[136:139], v11 offset:28672
    v_mfma_f32_32x32x16_bf16 v[180:195], v[116:119], v[144:147], v[180:195]
    s_barrier
    ds_read_b128 v[140:143], v10 offset:0
    s_waitcnt lgkmcnt(5)
    v_mfma_f32_32x32x16_bf16 v[164:179], v[148:151], v[120:123], v[164:179]
    ds_read_b128 v[144:147], v10 offset:1024
    v_mfma_f32_32x32x16_bf16 v[180:195], v[120:123], v[152:155], v[180:195]
    ds_read_b128 v[148:151], v10 offset:2048
    s_waitcnt lgkmcnt(5)
    v_mfma_f32_32x32x16_bf16 v[164:179], v[156:159], v[124:127], v[164:179]
    ds_read_b128 v[152:155], v10 offset:3072
    v_mfma_f32_32x32x16_bf16 v[180:195], v[124:127], v[160:163], v[180:195]
    ds_read_b128 v[156:159], v10 offset:4096
    s_waitcnt lgkmcnt(5)
    v_mfma_f32_32x32x16_bf16 v[164:179], v[132:135], v[128:131], v[164:179]
    ds_read_b128 v[160:163], v10 offset:5120
    v_mfma_f32_32x32x16_bf16 v[180:195], v[128:131], v[136:139], v[180:195]
    ds_read_b128 v[132:135], v10 offset:6144
    s_waitcnt lgkmcnt(5)
    v_mfma_f32_32x32x16_bf16 v[196:211], v[140:143], v[16:19], 0
    ds_read_b128 v[136:139], v10 offset:7168
    v_mfma_f32_32x32x16_bf16 v[196:211], v[144:147], v[20:23], v[196:211]
    v_and_b32 v229, 31, v0
    v_cmp_eq_u32 vcc, 28, v229
    s_nop 2
    v_mul_f32 v164, v164, v6
    v_mul_f32 v165, v165, v6
    v_mul_f32 v166, v166, v6
    v_mul_f32 v167, v167, v6
    v_mul_f32 v168, v168, v6
    v_mul_f32 v169, v169, v6
    ds_read_b128 v[140:143], v10 offset:8192
    s_waitcnt lgkmcnt(5)
    v_mfma_f32_32x32x16_bf16 v[196:211], v[148:151], v[24:27], v[196:211]
    v_mul_f32 v170, v170, v6
    v_mul_f32 v171, v171, v6
    v_mul_f32 v172, v172, v6
    v_mul_f32 v173, v173, v6
    v_mul_f32 v174, v174, v6
    v_mul_f32 v175, v175, v6
    v_mul_f32 v176, v176, v6
    v_mul_f32 v177, v177, v6
    ds_read_b128 v[144:147], v10 offset:9216
    v_mfma_f32_32x32x16_bf16 v[196:211], v[152:155], v[28:31], v[196:211]
    v_mul_f32 v178, v178, v6
    v_mul_f32 v179, v179, v6
    v_cvt_pk_bf16_f32 v164, v164, v165
    v_cvt_pk_bf16_f32 v165, v166, v167
    v_cvt_pk_bf16_f32 v166, v168, v169
    v_cvt_pk_bf16_f32 v167, v170, v171
    v_cvt_pk_bf16_f32 v168, v172, v173
    v_cvt_pk_bf16_f32 v169, v174, v175
    ds_read_b128 v[148:151], v10 offset:10240
    s_waitcnt lgkmcnt(5)
    v_mfma_f32_32x32x16_bf16 v[196:211], v[156:159], v[32:35], v[196:211]
    v_cvt_pk_bf16_f32 v170, v176, v177
    v_cvt_pk_bf16_f32 v171, v178, v179
    buffer_store_dwordx4 v[164:167], v1, s[8:11], s46 offen offset:0 sc1
    buffer_store_dwordx4 v[168:171], v1, s[8:11], s46 offen offset:1024 sc1
    v_mul_f32 v180, v180, v212
    v_mul_f32 v181, v181, v213
    v_mul_f32 v182, v182, v214
    v_mul_f32 v183, v183, v215
    ds_read_b128 v[152:155], v10 offset:11264
    v_mfma_f32_32x32x16_bf16 v[196:211], v[160:163], v[36:39], v[196:211]
    v_mul_f32 v184, v184, v216
    v_mul_f32 v185, v185, v217
    v_mul_f32 v186, v186, v218
    v_mul_f32 v187, v187, v219
    v_mul_f32 v188, v188, v220
    v_mul_f32 v189, v189, v221
    v_mul_f32 v190, v190, v222
    v_mul_f32 v191, v191, v223
    ds_read_b128 v[156:159], v10 offset:12288
    s_waitcnt lgkmcnt(5)
    v_mfma_f32_32x32x16_bf16 v[196:211], v[132:135], v[40:43], v[196:211]
    v_mul_f32 v192, v192, v224
    v_mul_f32 v193, v193, v225
    v_mul_f32 v194, v194, v226
    v_mul_f32 v195, v195, v227
    v_cvt_pk_bf16_f32 v180, v180, v181
    v_cvt_pk_bf16_f32 v181, v182, v183
    v_cvt_pk_bf16_f32 v182, v184, v185
    v_cvt_pk_bf16_f32 v183, v186, v187
    ds_read_b128 v[160:163], v10 offset:13312
    v_mfma_f32_32x32x16_bf16 v[196:211], v[136:139], v[44:47], v[196:211]
    v_cvt_pk_bf16_f32 v184, v188, v189
    v_cvt_pk_bf16_f32 v185, v190, v191
    v_cvt_pk_bf16_f32 v186, v192, v193
    v_cvt_pk_bf16_f32 v187, v194, v195
    v_cndmask_b32 v180, v180, v5, vcc
    v_cndmask_b32 v181, v181, v5, vcc
    v_cndmask_b32 v182, v182, v5, vcc
    v_cndmask_b32 v183, v183, v5, vcc
    ds_read_b128 v[132:135], v10 offset:14336
    s_waitcnt lgkmcnt(5)
    v_mfma_f32_32x32x16_bf16 v[196:211], v[140:143], v[48:51], v[196:211]
    v_cndmask_b32 v184, v184, v5, vcc
    v_cndmask_b32 v185, v185, v5, vcc
    v_cndmask_b32 v186, v186, v5, vcc
    v_cndmask_b32 v187, v187, v5, vcc
    buffer_store_dwordx4 v[180:183], v1, s[8:11], s46 offen offset:2048 sc1
    buffer_store_dwordx4 v[184:187], v1, s[8:11], s46 offen offset:3072 sc1
    ds_write_b128 v13, v[164:167] offset:32768
    ds_write_b128 v13, v[168:171] offset:33792
    ds_read_b128 v[136:139], v10 offset:15360
    v_mfma_f32_32x32x16_bf16 v[196:211], v[144:147], v[52:55], v[196:211]
    ds_write_b128 v13, v[180:183] offset:34816
    ds_write_b128 v13, v[184:187] offset:35840
    ds_read_b128 v[140:143], v10 offset:16384
    s_waitcnt lgkmcnt(9)
    v_mfma_f32_32x32x16_bf16 v[196:211], v[148:151], v[56:59], v[196:211]
    ds_read_b128 v[144:147], v10 offset:17408
    v_mfma_f32_32x32x16_bf16 v[196:211], v[152:155], v[60:63], v[196:211]
    ds_read_b128 v[148:151], v10 offset:18432
    s_waitcnt lgkmcnt(9)
    v_mfma_f32_32x32x16_bf16 v[196:211], v[156:159], v[64:67], v[196:211]
    ds_read_b128 v[152:155], v10 offset:19456
    v_mfma_f32_32x32x16_bf16 v[196:211], v[160:163], v[68:71], v[196:211]
    ds_read_b128 v[156:159], v10 offset:20480
    s_waitcnt lgkmcnt(7)
    v_mfma_f32_32x32x16_bf16 v[196:211], v[132:135], v[72:75], v[196:211]
    ds_read_b128 v[160:163], v10 offset:21504
    v_mfma_f32_32x32x16_bf16 v[196:211], v[136:139], v[76:79], v[196:211]
    ds_read_b128 v[132:135], v10 offset:22528
    s_waitcnt lgkmcnt(5)
    v_mfma_f32_32x32x16_bf16 v[196:211], v[140:143], v[80:83], v[196:211]
    ds_read_b128 v[136:139], v10 offset:23552
    v_mfma_f32_32x32x16_bf16 v[196:211], v[144:147], v[84:87], v[196:211]
    ds_read_b128 v[140:143], v10 offset:24576
    s_waitcnt lgkmcnt(5)
    v_mfma_f32_32x32x16_bf16 v[196:211], v[148:151], v[88:91], v[196:211]
    ds_read_b128 v[144:147], v10 offset:25600
    v_mfma_f32_32x32x16_bf16 v[196:211], v[152:155], v[92:95], v[196:211]
    ds_read_b128 v[148:151], v10 offset:26624
    s_waitcnt lgkmcnt(5)
    v_mfma_f32_32x32x16_bf16 v[196:211], v[156:159], v[96:99], v[196:211]
    ds_read_b128 v[152:155], v10 offset:27648
    v_mfma_f32_32x32x16_bf16 v[196:211], v[160:163], v[100:103], v[196:211]
    v_mul_u32_u24 v255, 4100, v0
    v_mov_b32 v254, 1
    v_mov_b32 v253, 163776
    s_waitcnt vmcnt(0)
    s_mov_b64 exec, 1
    ds_add_rtn_u32 v253, v253, v254
    s_waitcnt lgkmcnt(0)
    v_readfirstlane_b32 s62, v253
    s_mov_b64 exec, 3
    s_and_b32 s62, s62, 3
    s_cmp_lg_u32 s62, 3
    s_cbranch_scc1 mega_kernel_c_sig1
    buffer_store_dword v254, v255, s[8:11], s48 offen sc1
mega_kernel_c_sig1:
    s_mov_b64 exec, -1
    s_mov_b64 exec, 1
    v_mov_b32 v253, 163780
    v_mov_b32 v254, 1
    ds_add_u32 v253, v254
    s_mov_b64 exec, -1
    ds_read_b128 v[156:159], v10 offset:28672
    v_mfma_f32_32x32x16_bf16 v[196:211], v[132:135], v[104:107], v[196:211]
    v_mfma_f32_32x32x16_bf16 v[196:211], v[136:139], v[108:111], v[196:211]
    v_mfma_f32_32x32x16_bf16 v[196:211], v[140:143], v[112:115], v[196:211]
    v_mfma_f32_32x32x16_bf16 v[196:211], v[144:147], v[116:119], v[196:211]
    v_mfma_f32_32x32x16_bf16 v[196:211], v[148:151], v[120:123], v[196:211]
    v_mfma_f32_32x32x16_bf16 v[196:211], v[152:155], v[124:127], v[196:211]
    s_waitcnt lgkmcnt(0)
    v_mfma_f32_32x32x16_bf16 v[196:211], v[156:159], v[128:131], v[196:211]
    s_nop 11
    v_mul_f32 v196, v196, v7
    v_mul_f32 v197, v197, v7
    v_mul_f32 v198, v198, v7
    v_mul_f32 v199, v199, v7
    v_mul_f32 v200, v200, v7
    v_mul_f32 v201, v201, v7
    v_mul_f32 v202, v202, v7
    v_mul_f32 v203, v203, v7
    v_mul_f32 v204, v204, v7
    v_mul_f32 v205, v205, v7
    v_mul_f32 v206, v206, v7
    v_mul_f32 v207, v207, v7
    v_mul_f32 v208, v208, v7
    v_mul_f32 v209, v209, v7
    v_mul_f32 v210, v210, v7
    v_mul_f32 v211, v211, v7
    v_cvt_pk_bf16_f32 v244, v196, v197
    v_cvt_pk_bf16_f32 v245, v198, v199
    v_cvt_pk_bf16_f32 v246, v200, v201
    v_cvt_pk_bf16_f32 v247, v202, v203
    v_cvt_pk_bf16_f32 v248, v204, v205
    v_cvt_pk_bf16_f32 v249, v206, v207
    v_cvt_pk_bf16_f32 v250, v208, v209
    v_cvt_pk_bf16_f32 v251, v210, v211
    s_waitcnt lgkmcnt(0)
    s_lshl_b32 s40, s18, 2
    s_add_u32 s40, s40, s13
    s_lshl_b32 s41, s40, 5
    s_lshl_b32 s42, s19, 1
    s_add_u32 s41, s41, s42
    s_lshl_b32 s41, s41, 10
    s_add_u32 s41, s41, 48234496
    ds_read_b128 v[80:83], v13 offset:32768
    ds_read_b128 v[84:87], v13 offset:33792
    v_and_b32 v3, 31, v0
    v_lshrrev_b32 v4, 5, v0
    v_lshlrev_b32 v4, 2, v4
    v_sub_u32 v3, v3, v4
    v_mov_b32 v5, 0xf149f2ca
    v_cmp_ge_i32 s[44:45], v3, 0
    v_cmp_ge_i32 s[46:47], v3, 1
    v_cmp_ge_i32 s[48:49], v3, 2
    v_cmp_ge_i32 s[50:51], v3, 3
    v_cndmask_b32 v152, v5, 0, s[44:45]
    v_cndmask_b32 v168, 0, v5, s[44:45]
    v_cndmask_b32 v153, v5, 0, s[46:47]
    v_cndmask_b32 v169, 0, v5, s[46:47]
    v_cndmask_b32 v154, v5, 0, s[48:49]
    v_cndmask_b32 v170, 0, v5, s[48:49]
    v_cndmask_b32 v155, v5, 0, s[50:51]
    v_cndmask_b32 v171, 0, v5, s[50:51]
    v_cmp_ge_i32 s[44:45], v3, 8
    v_cmp_ge_i32 s[46:47], v3, 9
    v_cmp_ge_i32 s[48:49], v3, 10
    v_cmp_ge_i32 s[50:51], v3, 11
    v_cndmask_b32 v156, v5, 0, s[44:45]
    v_cndmask_b32 v172, 0, v5, s[44:45]
    v_cndmask_b32 v157, v5, 0, s[46:47]
    v_cndmask_b32 v173, 0, v5, s[46:47]
    v_cndmask_b32 v158, v5, 0, s[48:49]
    v_cndmask_b32 v174, 0, v5, s[48:49]
    v_cndmask_b32 v159, v5, 0, s[50:51]
    v_cndmask_b32 v175, 0, v5, s[50:51]
    v_cmp_ge_i32 s[44:45], v3, 16
    v_cmp_ge_i32 s[46:47], v3, 17
    v_cmp_ge_i32 s[48:49], v3, 18
    v_cmp_ge_i32 s[50:51], v3, 19
    v_cndmask_b32 v160, v5, 0, s[44:45]
    v_cndmask_b32 v176, 0, v5, s[44:45]
    v_cndmask_b32 v161, v5, 0, s[46:47]
    v_cndmask_b32 v177, 0, v5, s[46:47]
    v_cndmask_b32 v162, v5, 0, s[48:49]
    v_cndmask_b32 v178, 0, v5, s[48:49]
    v_cndmask_b32 v163, v5, 0, s[50:51]
    v_cndmask_b32 v179, 0, v5, s[50:51]
    v_cmp_ge_i32 s[44:45], v3, 24
    v_cmp_ge_i32 s[46:47], v3, 25
    v_cmp_ge_i32 s[48:49], v3, 26
    v_cmp_ge_i32 s[50:51], v3, 27
    v_cndmask_b32 v164, v5, 0, s[44:45]
    v_cndmask_b32 v180, 0, v5, s[44:45]
    v_cndmask_b32 v165, v5, 0, s[46:47]
    v_cndmask_b32 v181, 0, v5, s[46:47]
    v_cndmask_b32 v166, v5, 0, s[48:49]
    v_cndmask_b32 v182, 0, v5, s[48:49]
    v_cndmask_b32 v167, v5, 0, s[50:51]
    v_cndmask_b32 v183, 0, v5, s[50:51]
    v_mov_b32 v184, 0
    v_mov_b32 v185, 0
    v_mov_b32 v186, 0
    v_mov_b32 v187, 0
    v_mov_b32 v188, 0
    v_mov_b32 v189, 0
    v_mov_b32 v190, 0
    v_mov_b32 v191, 0
    v_mov_b32 v192, 0
    v_mov_b32 v193, 0
    v_mov_b32 v194, 0
    v_mov_b32 v195, 0
    v_mov_b32 v196, 0
    v_mov_b32 v197, 0
    v_mov_b32 v198, 0
    v_mov_b32 v199, 0
    s_cmp_ge_u32 s40, 8
    s_cbranch_scc1 mega_kernel_c_b0ok2
    v_mov_b32 v168, v5
    v_mov_b32 v169, v5
    v_mov_b32 v170, v5
    v_mov_b32 v171, v5
    v_mov_b32 v172, v5
    v_mov_b32 v173, v5
    v_mov_b32 v174, v5
    v_mov_b32 v175, v5
    v_mov_b32 v176, v5
    v_mov_b32 v177, v5
    v_mov_b32 v178, v5
    v_mov_b32 v179, v5
    v_mov_b32 v180, v5
    v_mov_b32 v181, v5
    v_mov_b32 v182, v5
    v_mov_b32 v183, v5
mega_kernel_c_b0ok2:
    s_nop 1
    s_waitcnt lgkmcnt(1)
    v_mfma_f32_32x32x16_bf16 v[88:103], v[80:83], v[244:247], v[152:167]
    s_waitcnt lgkmcnt(0)
    v_mfma_f32_32x32x16_bf16 v[88:103], v[84:87], v[248:251], v[88:103]
    s_nop 11
    v_max3_f32 v6, v88, v89, v90
    v_max3_f32 v7, v91, v92, v93
    v_max3_f32 v6, v6, v94, v95
    v_max3_f32 v7, v7, v96, v97
    v_max3_f32 v6, v6, v98, v99
    v_max3_f32 v7, v7, v100, v101
    v_max3_f32 v6, v6, v102, v103
    s_barrier
    ds_read_b128 v[72:75], v13 offset:28672
    ds_read_b128 v[76:79], v13 offset:29696
    ds_read_b128 v[64:67], v13 offset:24576
    ds_read_b128 v[68:71], v13 offset:25600
    ds_read_b128 v[56:59], v13 offset:20480
    ds_read_b128 v[60:63], v13 offset:21504
    ds_read_b128 v[48:51], v13 offset:16384
    ds_read_b128 v[52:55], v13 offset:17408
    s_cmp_lg_u32 s40, 0
    s_cbranch_scc1 mega_kernel_c_inv3
    s_nop 7
    v_mov_b32 v184, v5
    v_mov_b32 v185, v5
    v_mov_b32 v186, v5
    v_mov_b32 v187, v5
    v_mov_b32 v188, v5
    v_mov_b32 v189, v5
    v_mov_b32 v190, v5
    v_mov_b32 v191, v5
    v_mov_b32 v192, v5
    v_mov_b32 v193, v5
    v_mov_b32 v194, v5
    v_mov_b32 v195, v5
    v_mov_b32 v196, v5
    v_mov_b32 v197, v5
    v_mov_b32 v198, v5
    v_mov_b32 v199, v5
    s_nop 1
mega_kernel_c_inv3:
    s_waitcnt lgkmcnt(7)
    v_mfma_f32_32x32x16_bf16 v[104:119], v[72:75], v[244:247], v[184:199]
    s_waitcnt lgkmcnt(6)
    v_mfma_f32_32x32x16_bf16 v[104:119], v[76:79], v[248:251], v[104:119]
    ds_read_b128 v[40:43], v13 offset:12288
    ds_read_b128 v[44:47], v13 offset:13312
    s_cmp_lg_u32 s40, 1
    s_cbranch_scc1 mega_kernel_c_inv4
    s_nop 7
    v_mov_b32 v184, v5
    v_mov_b32 v185, v5
    v_mov_b32 v186, v5
    v_mov_b32 v187, v5
    v_mov_b32 v188, v5
    v_mov_b32 v189, v5
    v_mov_b32 v190, v5
    v_mov_b32 v191, v5
    v_mov_b32 v192, v5
    v_mov_b32 v193, v5
    v_mov_b32 v194, v5
    v_mov_b32 v195, v5
    v_mov_b32 v196, v5
    v_mov_b32 v197, v5
    v_mov_b32 v198, v5
    v_mov_b32 v199, v5
    s_nop 1
mega_kernel_c_inv4:
    s_waitcnt lgkmcnt(7)
    v_mfma_f32_32x32x16_bf16 v[120:135], v[64:67], v[244:247], v[184:199]
    s_waitcnt lgkmcnt(6)
    v_mfma_f32_32x32x16_bf16 v[120:135], v[68:71], v[248:251], v[120:135]
    ds_read_b128 v[32:35], v13 offset:8192
    ds_read_b128 v[36:39], v13 offset:9216
    s_cmp_lg_u32 s40, 2
    s_cbranch_scc1 mega_kernel_c_inv5
    s_nop 7
    v_mov_b32 v184, v5
    v_mov_b32 v185, v5
    v_mov_b32 v186, v5
    v_mov_b32 v187, v5
    v_mov_b32 v188, v5
    v_mov_b32 v189, v5
    v_mov_b32 v190, v5
    v_mov_b32 v191, v5
    v_mov_b32 v192, v5
    v_mov_b32 v193, v5
    v_mov_b32 v194, v5
    v_mov_b32 v195, v5
    v_mov_b32 v196, v5
    v_mov_b32 v197, v5
    v_mov_b32 v198, v5
    v_mov_b32 v199, v5
    s_nop 1
mega_kernel_c_inv5:
    s_waitcnt lgkmcnt(7)
    v_mfma_f32_32x32x16_bf16 v[136:151], v[56:59], v[244:247], v[184:199]
    v_max3_f32 v6, v6, v104, v105
    v_max3_f32 v7, v7, v106, v107
    v_max3_f32 v6, v6, v108, v109
    v_max3_f32 v7, v7, v110, v111
    s_waitcnt lgkmcnt(6)
    v_mfma_f32_32x32x16_bf16 v[136:151], v[60:63], v[248:251], v[136:151]
    v_max3_f32 v6, v6, v112, v113
    v_max3_f32 v7, v7, v114, v115
    v_max3_f32 v6, v6, v116, v117
    v_max3_f32 v7, v7, v118, v119
    ds_read_b128 v[24:27], v13 offset:4096
    ds_read_b128 v[28:31], v13 offset:5120
    s_cmp_lg_u32 s40, 3
    s_cbranch_scc1 mega_kernel_c_inv6
    s_nop 7
    v_mov_b32 v184, v5
    v_mov_b32 v185, v5
    v_mov_b32 v186, v5
    v_mov_b32 v187, v5
    v_mov_b32 v188, v5
    v_mov_b32 v189, v5
    v_mov_b32 v190, v5
    v_mov_b32 v191, v5
    v_mov_b32 v192, v5
    v_mov_b32 v193, v5
    v_mov_b32 v194, v5
    v_mov_b32 v195, v5
    v_mov_b32 v196, v5
    v_mov_b32 v197, v5
    v_mov_b32 v198, v5
    v_mov_b32 v199, v5
    s_nop 1
mega_kernel_c_inv6:
    s_waitcnt lgkmcnt(7)
    v_mfma_f32_32x32x16_bf16 v[88:103], v[48:51], v[244:247], v[184:199]
    v_max3_f32 v6, v6, v120, v121
    v_max3_f32 v7, v7, v122, v123
    v_max3_f32 v6, v6, v124, v125
    v_max3_f32 v7, v7, v126, v127
    s_waitcnt lgkmcnt(6)
    v_mfma_f32_32x32x16_bf16 v[88:103], v[52:55], v[248:251], v[88:103]
    v_max3_f32 v6, v6, v128, v129
    v_max3_f32 v7, v7, v130, v131
    v_max3_f32 v6, v6, v132, v133
    v_max3_f32 v7, v7, v134, v135
    ds_read_b128 v[16:19], v13 offset:0
    ds_read_b128 v[20:23], v13 offset:1024
    s_cmp_lg_u32 s40, 4
    s_cbranch_scc1 mega_kernel_c_inv7
    s_nop 7
    v_mov_b32 v184, v5
    v_mov_b32 v185, v5
    v_mov_b32 v186, v5
    v_mov_b32 v187, v5
    v_mov_b32 v188, v5
    v_mov_b32 v189, v5
    v_mov_b32 v190, v5
    v_mov_b32 v191, v5
    v_mov_b32 v192, v5
    v_mov_b32 v193, v5
    v_mov_b32 v194, v5
    v_mov_b32 v195, v5
    v_mov_b32 v196, v5
    v_mov_b32 v197, v5
    v_mov_b32 v198, v5
    v_mov_b32 v199, v5
    s_nop 1
mega_kernel_c_inv7:
    s_waitcnt lgkmcnt(7)
    v_mfma_f32_32x32x16_bf16 v[104:119], v[40:43], v[244:247], v[184:199]
    v_max3_f32 v6, v6, v136, v137
    v_max3_f32 v7, v7, v138, v139
    v_max3_f32 v6, v6, v140, v141
    v_max3_f32 v7, v7, v142, v143
    s_waitcnt lgkmcnt(6)
    v_mfma_f32_32x32x16_bf16 v[104:119], v[44:47], v[248:251], v[104:119]
    v_max3_f32 v6, v6, v144, v145
    v_max3_f32 v7, v7, v146, v147
    v_max3_f32 v6, v6, v148, v149
    v_max3_f32 v7, v7, v150, v151
    s_cmp_lg_u32 s40, 5
    s_cbranch_scc1 mega_kernel_c_inv8
    s_nop 7
    v_mov_b32 v184, v5
    v_mov_b32 v185, v5
    v_mov_b32 v186, v5
    v_mov_b32 v187, v5
    v_mov_b32 v188, v5
    v_mov_b32 v189, v5
    v_mov_b32 v190, v5
    v_mov_b32 v191, v5
    v_mov_b32 v192, v5
    v_mov_b32 v193, v5
    v_mov_b32 v194, v5
    v_mov_b32 v195, v5
    v_mov_b32 v196, v5
    v_mov_b32 v197, v5
    v_mov_b32 v198, v5
    v_mov_b32 v199, v5
    s_nop 1
mega_kernel_c_inv8:
    s_waitcnt lgkmcnt(5)
    v_mfma_f32_32x32x16_bf16 v[120:135], v[32:35], v[244:247], v[184:199]
    v_max3_f32 v6, v6, v88, v89
    v_max3_f32 v7, v7, v90, v91
    v_max3_f32 v6, v6, v92, v93
    v_max3_f32 v7, v7, v94, v95
    s_waitcnt lgkmcnt(4)
    v_mfma_f32_32x32x16_bf16 v[120:135], v[36:39], v[248:251], v[120:135]
    v_max3_f32 v6, v6, v96, v97
    v_max3_f32 v7, v7, v98, v99
    v_max3_f32 v6, v6, v100, v101
    v_max3_f32 v7, v7, v102, v103
    s_cmp_lg_u32 s40, 6
    s_cbranch_scc1 mega_kernel_c_inv9
    s_nop 7
    v_mov_b32 v184, v5
    v_mov_b32 v185, v5
    v_mov_b32 v186, v5
    v_mov_b32 v187, v5
    v_mov_b32 v188, v5
    v_mov_b32 v189, v5
    v_mov_b32 v190, v5
    v_mov_b32 v191, v5
    v_mov_b32 v192, v5
    v_mov_b32 v193, v5
    v_mov_b32 v194, v5
    v_mov_b32 v195, v5
    v_mov_b32 v196, v5
    v_mov_b32 v197, v5
    v_mov_b32 v198, v5
    v_mov_b32 v199, v5
    s_nop 1
mega_kernel_c_inv9:
    s_waitcnt lgkmcnt(3)
    v_mfma_f32_32x32x16_bf16 v[136:151], v[24:27], v[244:247], v[184:199]
    v_max3_f32 v6, v6, v104, v105
    v_max3_f32 v7, v7, v106, v107
    v_max3_f32 v6, v6, v108, v109
    v_max3_f32 v7, v7, v110, v111
    s_waitcnt lgkmcnt(2)
    v_mfma_f32_32x32x16_bf16 v[136:151], v[28:31], v[248:251], v[136:151]
    v_max3_f32 v6, v6, v112, v113
    v_max3_f32 v7, v7, v114, v115
    v_max3_f32 v6, v6, v116, v117
    v_max3_f32 v7, v7, v118, v119
    s_waitcnt lgkmcnt(1)
    v_mfma_f32_32x32x16_bf16 v[88:103], v[16:19], v[244:247], v[168:183]
    v_max3_f32 v6, v6, v120, v121
    v_max3_f32 v7, v7, v122, v123
    v_max3_f32 v6, v6, v124, v125
    v_max3_f32 v7, v7, v126, v127
    s_waitcnt lgkmcnt(0)
    v_mfma_f32_32x32x16_bf16 v[88:103], v[20:23], v[248:251], v[88:103]
    v_max3_f32 v6, v6, v128, v129
    v_max3_f32 v7, v7, v130, v131
    v_max3_f32 v6, v6, v132, v133
    v_max3_f32 v7, v7, v134, v135
    ds_read_b128 v[216:219], v13 offset:34816
    ds_read_b128 v[220:223], v13 offset:35840
    v_max3_f32 v6, v6, v136, v137
    v_max3_f32 v7, v7, v138, v139
    v_max3_f32 v6, v6, v140, v141
    v_max3_f32 v7, v7, v142, v143
    v_max3_f32 v6, v6, v144, v145
    v_max3_f32 v7, v7, v146, v147
    v_max3_f32 v6, v6, v148, v149
    v_max3_f32 v7, v7, v150, v151
    v_max3_f32 v6, v6, v88, v89
    v_max3_f32 v7, v7, v90, v91
    v_max3_f32 v6, v6, v92, v93
    v_max3_f32 v7, v7, v94, v95
    v_max3_f32 v6, v6, v96, v97
    v_max3_f32 v7, v7, v98, v99
    v_max3_f32 v6, v6, v100, v101
    v_max3_f32 v7, v7, v102, v103
    v_max_f32 v6, v6, v7
    v_mov_b32 v7, v6
    s_nop 1
    v_permlane32_swap_b32 v7, v6
    v_max_f32 v6, v6, v7
    v_sub_f32 v152, v152, v6
    v_sub_f32 v153, v153, v6
    v_sub_f32 v154, v154, v6
    v_sub_f32 v155, v155, v6
    v_sub_f32 v156, v156, v6
    v_sub_f32 v157, v157, v6
    v_sub_f32 v158, v158, v6
    v_sub_f32 v159, v159, v6
    v_sub_f32 v160, v160, v6
    v_sub_f32 v161, v161, v6
    v_sub_f32 v162, v162, v6
    v_sub_f32 v163, v163, v6
    v_sub_f32 v164, v164, v6
    v_sub_f32 v165, v165, v6
    v_sub_f32 v166, v166, v6
    v_sub_f32 v167, v167, v6
    s_nop 1
    v_mfma_f32_32x32x16_bf16 v[88:103], v[80:83], v[244:247], v[152:167]
    v_mfma_f32_32x32x16_bf16 v[88:103], v[84:87], v[248:251], v[88:103]
    v_sub_f32 v184, 0, v6
    v_sub_f32 v185, 0, v6
    v_sub_f32 v186, 0, v6
    v_sub_f32 v187, 0, v6
    v_sub_f32 v188, 0, v6
    v_sub_f32 v189, 0, v6
    v_sub_f32 v190, 0, v6
    v_sub_f32 v191, 0, v6
    v_sub_f32 v192, 0, v6
    v_sub_f32 v193, 0, v6
    v_sub_f32 v194, 0, v6
    v_sub_f32 v195, 0, v6
    v_sub_f32 v196, 0, v6
    v_sub_f32 v197, 0, v6
    v_sub_f32 v198, 0, v6
    v_sub_f32 v199, 0, v6
    v_sub_f32 v168, v168, v6
    v_sub_f32 v169, v169, v6
    v_sub_f32 v170, v170, v6
    v_sub_f32 v171, v171, v6
    v_sub_f32 v172, v172, v6
    v_sub_f32 v173, v173, v6
    v_sub_f32 v174, v174, v6
    v_sub_f32 v175, v175, v6
    v_sub_f32 v176, v176, v6
    v_sub_f32 v177, v177, v6
    v_sub_f32 v178, v178, v6
    v_sub_f32 v179, v179, v6
    v_sub_f32 v180, v180, v6
    v_sub_f32 v181, v181, v6
    v_sub_f32 v182, v182, v6
    v_sub_f32 v183, v183, v6
    s_cmp_lg_u32 s40, 0
    s_cbranch_scc1 mega_kernel_c_inv10
    s_nop 7
    v_mov_b32 v184, v5
    v_mov_b32 v185, v5
    v_mov_b32 v186, v5
    v_mov_b32 v187, v5
    v_mov_b32 v188, v5
    v_mov_b32 v189, v5
    v_mov_b32 v190, v5
    v_mov_b32 v191, v5
    v_mov_b32 v192, v5
    v_mov_b32 v193, v5
    v_mov_b32 v194, v5
    v_mov_b32 v195, v5
    v_mov_b32 v196, v5
    v_mov_b32 v197, v5
    v_mov_b32 v198, v5
    v_mov_b32 v199, v5
    s_nop 1
mega_kernel_c_inv10:
    ds_read_b128 v[224:227], v13 offset:30720
    ds_read_b128 v[228:231], v13 offset:31744
    v_mfma_f32_32x32x16_bf16 v[104:119], v[72:75], v[244:247], v[184:199]
    v_exp_f32 v88, v88
    v_exp_f32 v89, v89
    v_exp_f32 v90, v90
    v_exp_f32 v91, v91
    v_mfma_f32_32x32x16_bf16 v[104:119], v[76:79], v[248:251], v[104:119]
    v_exp_f32 v92, v92
    v_exp_f32 v93, v93
    v_exp_f32 v94, v94
    v_exp_f32 v95, v95
    v_exp_f32 v96, v96
    v_exp_f32 v97, v97
    v_exp_f32 v98, v98
    v_exp_f32 v99, v99
    v_exp_f32 v100, v100
    v_exp_f32 v101, v101
    v_exp_f32 v102, v102
    v_exp_f32 v103, v103
    v_cvt_pk_bf16_f32 v88, v88, v89
    v_cvt_pk_bf16_f32 v89, v90, v91
    v_cvt_pk_bf16_f32 v90, v92, v93
    v_cvt_pk_bf16_f32 v91, v94, v95
    v_cvt_pk_bf16_f32 v92, v96, v97
    v_cvt_pk_bf16_f32 v93, v98, v99
    v_cvt_pk_bf16_f32 v94, v100, v101
    v_cvt_pk_bf16_f32 v95, v102, v103
    s_cmp_lg_u32 s40, 1
    s_cbranch_scc1 mega_kernel_c_inv11
    s_nop 7
    v_mov_b32 v184, v5
    v_mov_b32 v185, v5
    v_mov_b32 v186, v5
    v_mov_b32 v187, v5
    v_mov_b32 v188, v5
    v_mov_b32 v189, v5
    v_mov_b32 v190, v5
    v_mov_b32 v191, v5
    v_mov_b32 v192, v5
    v_mov_b32 v193, v5
    v_mov_b32 v194, v5
    v_mov_b32 v195, v5
    v_mov_b32 v196, v5
    v_mov_b32 v197, v5
    v_mov_b32 v198, v5
    v_mov_b32 v199, v5
    s_nop 1
mega_kernel_c_inv11:
    ds_read_b128 v[232:235], v13 offset:26624
    ds_read_b128 v[236:239], v13 offset:27648
    v_mfma_f32_32x32x16_bf16 v[120:135], v[64:67], v[244:247], v[184:199]
    v_exp_f32 v104, v104
    v_exp_f32 v105, v105
    v_exp_f32 v106, v106
    v_exp_f32 v107, v107
    v_mfma_f32_32x32x16_bf16 v[120:135], v[68:71], v[248:251], v[120:135]
    v_exp_f32 v108, v108
    v_exp_f32 v109, v109
    v_exp_f32 v110, v110
    v_exp_f32 v111, v111
    s_waitcnt lgkmcnt(5)
    v_mfma_f32_32x32x16_bf16 v[200:215], v[216:219], v[88:91], 0
    v_exp_f32 v112, v112
    v_exp_f32 v113, v113
    v_exp_f32 v114, v114
    v_exp_f32 v115, v115
    s_waitcnt lgkmcnt(4)
    v_mfma_f32_32x32x16_bf16 v[200:215], v[220:223], v[92:95], v[200:215]
    v_exp_f32 v116, v116
    v_exp_f32 v117, v117
    v_exp_f32 v118, v118
    v_exp_f32 v119, v119
    v_cvt_pk_bf16_f32 v104, v104, v105
    v_cvt_pk_bf16_f32 v105, v106, v107
    v_cvt_pk_bf16_f32 v106, v108, v109
    v_cvt_pk_bf16_f32 v107, v110, v111
    v_cvt_pk_bf16_f32 v108, v112, v113
    v_cvt_pk_bf16_f32 v109, v114, v115
    v_cvt_pk_bf16_f32 v110, v116, v117
    v_cvt_pk_bf16_f32 v111, v118, v119
    s_cmp_lg_u32 s40, 2
    s_cbranch_scc1 mega_kernel_c_inv12
    s_nop 7
    v_mov_b32 v184, v5
    v_mov_b32 v185, v5
    v_mov_b32 v186, v5
    v_mov_b32 v187, v5
    v_mov_b32 v188, v5
    v_mov_b32 v189, v5
    v_mov_b32 v190, v5
    v_mov_b32 v191, v5
    v_mov_b32 v192, v5
    v_mov_b32 v193, v5
    v_mov_b32 v194, v5
    v_mov_b32 v195, v5
    v_mov_b32 v196, v5
    v_mov_b32 v197, v5
    v_mov_b32 v198, v5
    v_mov_b32 v199, v5
    s_nop 1
mega_kernel_c_inv12:
    ds_read_b128 v[216:219], v13 offset:22528
    ds_read_b128 v[220:223], v13 offset:23552
    v_mfma_f32_32x32x16_bf16 v[136:151], v[56:59], v[244:247], v[184:199]
    v_exp_f32 v120, v120
    v_exp_f32 v121, v121
    v_exp_f32 v122, v122
    v_exp_f32 v123, v123
    v_mfma_f32_32x32x16_bf16 v[136:151], v[60:63], v[248:251], v[136:151]
    v_exp_f32 v124, v124
    v_exp_f32 v125, v125
    v_exp_f32 v126, v126
    v_exp_f32 v127, v127
    s_waitcnt lgkmcnt(5)
    v_mfma_f32_32x32x16_bf16 v[200:215], v[224:227], v[104:107], v[200:215]
    v_exp_f32 v128, v128
    v_exp_f32 v129, v129
    v_exp_f32 v130, v130
    v_exp_f32 v131, v131
    s_waitcnt lgkmcnt(4)
    v_mfma_f32_32x32x16_bf16 v[200:215], v[228:231], v[108:111], v[200:215]
    v_exp_f32 v132, v132
    v_exp_f32 v133, v133
    v_exp_f32 v134, v134
    v_exp_f32 v135, v135
    v_cvt_pk_bf16_f32 v120, v120, v121
    v_cvt_pk_bf16_f32 v121, v122, v123
    v_cvt_pk_bf16_f32 v122, v124, v125
    v_cvt_pk_bf16_f32 v123, v126, v127
    v_cvt_pk_bf16_f32 v124, v128, v129
    v_cvt_pk_bf16_f32 v125, v130, v131
    v_cvt_pk_bf16_f32 v126, v132, v133
    v_cvt_pk_bf16_f32 v127, v134, v135
    s_cmp_lg_u32 s40, 3
    s_cbranch_scc1 mega_kernel_c_inv13
    s_nop 7
    v_mov_b32 v184, v5
    v_mov_b32 v185, v5
    v_mov_b32 v186, v5
    v_mov_b32 v187, v5
    v_mov_b32 v188, v5
    v_mov_b32 v189, v5
    v_mov_b32 v190, v5
    v_mov_b32 v191, v5
    v_mov_b32 v192, v5
    v_mov_b32 v193, v5
    v_mov_b32 v194, v5
    v_mov_b32 v195, v5
    v_mov_b32 v196, v5
    v_mov_b32 v197, v5
    v_mov_b32 v198, v5
    v_mov_b32 v199, v5
    s_nop 1
mega_kernel_c_inv13:
    ds_read_b128 v[224:227], v13 offset:18432
    ds_read_b128 v[228:231], v13 offset:19456
    v_mfma_f32_32x32x16_bf16 v[88:103], v[48:51], v[244:247], v[184:199]
    v_exp_f32 v136, v136
    v_exp_f32 v137, v137
    v_exp_f32 v138, v138
    v_exp_f32 v139, v139
    v_mfma_f32_32x32x16_bf16 v[88:103], v[52:55], v[248:251], v[88:103]
    v_exp_f32 v140, v140
    v_exp_f32 v141, v141
    v_exp_f32 v142, v142
    v_exp_f32 v143, v143
    s_waitcnt lgkmcnt(5)
    v_mfma_f32_32x32x16_bf16 v[200:215], v[232:235], v[120:123], v[200:215]
    v_exp_f32 v144, v144
    v_exp_f32 v145, v145
    v_exp_f32 v146, v146
    v_exp_f32 v147, v147
    s_waitcnt lgkmcnt(4)
    v_mfma_f32_32x32x16_bf16 v[200:215], v[236:239], v[124:127], v[200:215]
    v_exp_f32 v148, v148
    v_exp_f32 v149, v149
    v_exp_f32 v150, v150
    v_exp_f32 v151, v151
    v_cvt_pk_bf16_f32 v136, v136, v137
    v_cvt_pk_bf16_f32 v137, v138, v139
    v_cvt_pk_bf16_f32 v138, v140, v141
    v_cvt_pk_bf16_f32 v139, v142, v143
    v_cvt_pk_bf16_f32 v140, v144, v145
    v_cvt_pk_bf16_f32 v141, v146, v147
    v_cvt_pk_bf16_f32 v142, v148, v149
    v_cvt_pk_bf16_f32 v143, v150, v151
    s_cmp_lg_u32 s40, 4
    s_cbranch_scc1 mega_kernel_c_inv14
    s_nop 7
    v_mov_b32 v184, v5
    v_mov_b32 v185, v5
    v_mov_b32 v186, v5
    v_mov_b32 v187, v5
    v_mov_b32 v188, v5
    v_mov_b32 v189, v5
    v_mov_b32 v190, v5
    v_mov_b32 v191, v5
    v_mov_b32 v192, v5
    v_mov_b32 v193, v5
    v_mov_b32 v194, v5
    v_mov_b32 v195, v5
    v_mov_b32 v196, v5
    v_mov_b32 v197, v5
    v_mov_b32 v198, v5
    v_mov_b32 v199, v5
    s_nop 1
mega_kernel_c_inv14:
    ds_read_b128 v[232:235], v13 offset:14336
    ds_read_b128 v[236:239], v13 offset:15360
    v_mfma_f32_32x32x16_bf16 v[104:119], v[40:43], v[244:247], v[184:199]
    v_exp_f32 v88, v88
    v_exp_f32 v89, v89
    v_exp_f32 v90, v90
    v_exp_f32 v91, v91
    v_mfma_f32_32x32x16_bf16 v[104:119], v[44:47], v[248:251], v[104:119]
    v_exp_f32 v92, v92
    v_exp_f32 v93, v93
    v_exp_f32 v94, v94
    v_exp_f32 v95, v95
    s_waitcnt lgkmcnt(5)
    v_mfma_f32_32x32x16_bf16 v[200:215], v[216:219], v[136:139], v[200:215]
    v_exp_f32 v96, v96
    v_exp_f32 v97, v97
    v_exp_f32 v98, v98
    v_exp_f32 v99, v99
    s_waitcnt lgkmcnt(4)
    v_mfma_f32_32x32x16_bf16 v[200:215], v[220:223], v[140:143], v[200:215]
    v_exp_f32 v100, v100
    v_exp_f32 v101, v101
    v_exp_f32 v102, v102
    v_exp_f32 v103, v103
    v_cvt_pk_bf16_f32 v88, v88, v89
    v_cvt_pk_bf16_f32 v89, v90, v91
    v_cvt_pk_bf16_f32 v90, v92, v93
    v_cvt_pk_bf16_f32 v91, v94, v95
    v_cvt_pk_bf16_f32 v92, v96, v97
    v_cvt_pk_bf16_f32 v93, v98, v99
    v_cvt_pk_bf16_f32 v94, v100, v101
    v_cvt_pk_bf16_f32 v95, v102, v103
    s_cmp_lg_u32 s40, 5
    s_cbranch_scc1 mega_kernel_c_inv15
    s_nop 7
    v_mov_b32 v184, v5
    v_mov_b32 v185, v5
    v_mov_b32 v186, v5
    v_mov_b32 v187, v5
    v_mov_b32 v188, v5
    v_mov_b32 v189, v5
    v_mov_b32 v190, v5
    v_mov_b32 v191, v5
    v_mov_b32 v192, v5
    v_mov_b32 v193, v5
    v_mov_b32 v194, v5
    v_mov_b32 v195, v5
    v_mov_b32 v196, v5
    v_mov_b32 v197, v5
    v_mov_b32 v198, v5
    v_mov_b32 v199, v5
    s_nop 1
mega_kernel_c_inv15:
    ds_read_b128 v[216:219], v13 offset:10240
    ds_read_b128 v[220:223], v13 offset:11264
    v_mfma_f32_32x32x16_bf16 v[120:135], v[32:35], v[244:247], v[184:199]
    v_exp_f32 v104, v104
    v_exp_f32 v105, v105
    v_exp_f32 v106, v106
    v_exp_f32 v107, v107
    v_mfma_f32_32x32x16_bf16 v[120:135], v[36:39], v[248:251], v[120:135]
    v_exp_f32 v108, v108
    v_exp_f32 v109, v109
    v_exp_f32 v110, v110
    v_exp_f32 v111, v111
    s_waitcnt lgkmcnt(5)
    v_mfma_f32_32x32x16_bf16 v[200:215], v[224:227], v[88:91], v[200:215]
    v_exp_f32 v112, v112
    v_exp_f32 v113, v113
    v_exp_f32 v114, v114
    v_exp_f32 v115, v115
    s_waitcnt lgkmcnt(4)
    v_mfma_f32_32x32x16_bf16 v[200:215], v[228:231], v[92:95], v[200:215]
    v_exp_f32 v116, v116
    v_exp_f32 v117, v117
    v_exp_f32 v118, v118
    v_exp_f32 v119, v119
    v_cvt_pk_bf16_f32 v104, v104, v105
    v_cvt_pk_bf16_f32 v105, v106, v107
    v_cvt_pk_bf16_f32 v106, v108, v109
    v_cvt_pk_bf16_f32 v107, v110, v111
    v_cvt_pk_bf16_f32 v108, v112, v113
    v_cvt_pk_bf16_f32 v109, v114, v115
    v_cvt_pk_bf16_f32 v110, v116, v117
    v_cvt_pk_bf16_f32 v111, v118, v119
    s_cmp_lg_u32 s40, 6
    s_cbranch_scc1 mega_kernel_c_inv16
    s_nop 7
    v_mov_b32 v184, v5
    v_mov_b32 v185, v5
    v_mov_b32 v186, v5
    v_mov_b32 v187, v5
    v_mov_b32 v188, v5
    v_mov_b32 v189, v5
    v_mov_b32 v190, v5
    v_mov_b32 v191, v5
    v_mov_b32 v192, v5
    v_mov_b32 v193, v5
    v_mov_b32 v194, v5
    v_mov_b32 v195, v5
    v_mov_b32 v196, v5
    v_mov_b32 v197, v5
    v_mov_b32 v198, v5
    v_mov_b32 v199, v5
    s_nop 1
mega_kernel_c_inv16:
    ds_read_b128 v[224:227], v13 offset:6144
    ds_read_b128 v[228:231], v13 offset:7168
    v_mfma_f32_32x32x16_bf16 v[136:151], v[24:27], v[244:247], v[184:199]
    v_exp_f32 v120, v120
    v_exp_f32 v121, v121
    v_exp_f32 v122, v122
    v_exp_f32 v123, v123
    v_mfma_f32_32x32x16_bf16 v[136:151], v[28:31], v[248:251], v[136:151]
    v_exp_f32 v124, v124
    v_exp_f32 v125, v125
    v_exp_f32 v126, v126
    v_exp_f32 v127, v127
    s_waitcnt lgkmcnt(5)
    v_mfma_f32_32x32x16_bf16 v[200:215], v[232:235], v[104:107], v[200:215]
    v_exp_f32 v128, v128
    v_exp_f32 v129, v129
    v_exp_f32 v130, v130
    v_exp_f32 v131, v131
    s_waitcnt lgkmcnt(4)
    v_mfma_f32_32x32x16_bf16 v[200:215], v[236:239], v[108:111], v[200:215]
    v_exp_f32 v132, v132
    v_exp_f32 v133, v133
    v_exp_f32 v134, v134
    v_exp_f32 v135, v135
    v_cvt_pk_bf16_f32 v120, v120, v121
    v_cvt_pk_bf16_f32 v121, v122, v123
    v_cvt_pk_bf16_f32 v122, v124, v125
    v_cvt_pk_bf16_f32 v123, v126, v127
    v_cvt_pk_bf16_f32 v124, v128, v129
    v_cvt_pk_bf16_f32 v125, v130, v131
    v_cvt_pk_bf16_f32 v126, v132, v133
    v_cvt_pk_bf16_f32 v127, v134, v135
    ds_read_b128 v[232:235], v13 offset:2048
    ds_read_b128 v[236:239], v13 offset:3072
    v_mfma_f32_32x32x16_bf16 v[88:103], v[16:19], v[244:247], v[168:183]
    v_exp_f32 v136, v136
    v_exp_f32 v137, v137
    v_exp_f32 v138, v138
    v_exp_f32 v139, v139
    v_mfma_f32_32x32x16_bf16 v[88:103], v[20:23], v[248:251], v[88:103]
    v_exp_f32 v140, v140
    v_exp_f32 v141, v141
    v_exp_f32 v142, v142
    v_exp_f32 v143, v143
    s_waitcnt lgkmcnt(5)
    v_mfma_f32_32x32x16_bf16 v[200:215], v[216:219], v[120:123], v[200:215]
    v_exp_f32 v144, v144
    v_exp_f32 v145, v145
    v_exp_f32 v146, v146
    v_exp_f32 v147, v147
    s_waitcnt lgkmcnt(4)
    v_mfma_f32_32x32x16_bf16 v[200:215], v[220:223], v[124:127], v[200:215]
    v_exp_f32 v148, v148
    v_exp_f32 v149, v149
    v_exp_f32 v150, v150
    v_exp_f32 v151, v151
    v_cvt_pk_bf16_f32 v136, v136, v137
    v_cvt_pk_bf16_f32 v137, v138, v139
    v_cvt_pk_bf16_f32 v138, v140, v141
    v_cvt_pk_bf16_f32 v139, v142, v143
    v_cvt_pk_bf16_f32 v140, v144, v145
    v_cvt_pk_bf16_f32 v141, v146, v147
    v_cvt_pk_bf16_f32 v142, v148, v149
    v_cvt_pk_bf16_f32 v143, v150, v151
    s_waitcnt lgkmcnt(3)
    v_mfma_f32_32x32x16_bf16 v[200:215], v[224:227], v[136:139], v[200:215]
    v_exp_f32 v88, v88
    v_exp_f32 v89, v89
    v_exp_f32 v90, v90
    v_exp_f32 v91, v91
    s_waitcnt lgkmcnt(2)
    v_mfma_f32_32x32x16_bf16 v[200:215], v[228:231], v[140:143], v[200:215]
    v_exp_f32 v92, v92
    v_exp_f32 v93, v93
    v_exp_f32 v94, v94
    v_exp_f32 v95, v95
    v_exp_f32 v96, v96
    v_exp_f32 v97, v97
    v_exp_f32 v98, v98
    v_exp_f32 v99, v99
    v_exp_f32 v100, v100
    v_exp_f32 v101, v101
    v_exp_f32 v102, v102
    v_exp_f32 v103, v103
    v_cvt_pk_bf16_f32 v88, v88, v89
    v_cvt_pk_bf16_f32 v89, v90, v91
    v_cvt_pk_bf16_f32 v90, v92, v93
    v_cvt_pk_bf16_f32 v91, v94, v95
    v_cvt_pk_bf16_f32 v92, v96, v97
    v_cvt_pk_bf16_f32 v93, v98, v99
    v_cvt_pk_bf16_f32 v94, v100, v101
    v_cvt_pk_bf16_f32 v95, v102, v103
    s_waitcnt lgkmcnt(1)
    v_mfma_f32_32x32x16_bf16 v[200:215], v[232:235], v[88:91], v[200:215]
    s_waitcnt lgkmcnt(0)
    v_mfma_f32_32x32x16_bf16 v[200:215], v[236:239], v[92:95], v[200:215]
    s_nop 11
    v_mov_b32 v3, v212
    v_mov_b32 v4, v212
    s_nop 1
    v_permlane32_swap_b32 v3, v4
    v_rcp_f32 v4, v4
    s_nop 0
    v_mul_f32 v200, v200, v4
    v_mul_f32 v201, v201, v4
    v_mul_f32 v202, v202, v4
    v_mul_f32 v203, v203, v4
    v_mul_f32 v204, v204, v4
    v_mul_f32 v205, v205, v4
    v_mul_f32 v206, v206, v4
    v_mul_f32 v207, v207, v4
    v_mul_f32 v208, v208, v4
    v_mul_f32 v209, v209, v4
    v_mul_f32 v210, v210, v4
    v_mul_f32 v211, v211, v4
    v_mul_f32 v212, v212, v4
    v_mul_f32 v213, v213, v4
    v_mul_f32 v214, v214, v4
    v_mul_f32 v215, v215, v4
    v_cvt_pk_bf16_f32 v200, v200, v201
    v_cvt_pk_bf16_f32 v201, v202, v203
    v_cvt_pk_bf16_f32 v202, v204, v205
    v_cvt_pk_bf16_f32 v203, v206, v207
    v_cvt_pk_bf16_f32 v204, v208, v209
    v_cvt_pk_bf16_f32 v205, v210, v211
    v_cvt_pk_bf16_f32 v206, v212, v213
    v_cvt_pk_bf16_f32 v207, v214, v215
    buffer_store_dwordx4 v[200:203], v1, s[8:11], s41 offen sc1
    buffer_store_dwordx4 v[204:207], v1, s[8:11], s41 offen offset:1024 sc1
    s_mov_b32 s42, s18
    s_mov_b32 s63, s19
    s_lshl_b32 s42, s42, 12
    s_lshl_b32 s63, s63, 2
    s_add_u32 s42, s42, s63
    s_add_u32 s42, s42, 70336512
    v_mul_u32_u24 v255, 256, v0
    v_mov_b32 v254, 1
    v_mov_b32 v253, 163776
    s_waitcnt vmcnt(0)
    s_mov_b64 exec, 1
    ds_add_rtn_u32 v253, v253, v254
    s_waitcnt lgkmcnt(0)
    v_readfirstlane_b32 s62, v253
    s_mov_b64 exec, 16383
    s_and_b32 s62, s62, 3
    s_cmp_lg_u32 s62, 3
    s_cbranch_scc1 mega_kernel_c_sig17
    buffer_store_dword v254, v255, s[8:11], s42 offen sc1
mega_kernel_c_sig17:
    s_mov_b64 exec, -1
    s_barrier
    s_cmp_eq_u32 s24, 0
    s_cbranch_scc1 mega_kernel_c_skip18
    s_and_b32 s43, s13, 1
    s_lshr_b32 s44, s13, 1
    s_lshl_b32 s40, s22, 1
    s_add_u32 s40, s40, s43
    s_lshl_b32 s41, s23, 1
    s_add_u32 s41, s41, s44
    s_mul_i32 s42, s40, 28
    s_lshl_b32 s45, s41, 1
    s_add_u32 s42, s42, s45
    s_lshl_b32 s42, s42, 10
    s_add_u32 s45, s42, 10485760
    buffer_load_dwordx4 v[48:51], v1, s[8:11], s45 offen offset:0 sc1
    buffer_load_dwordx4 v[52:55], v1, s[8:11], s45 offen offset:1024 sc1
    s_mul_i32 s47, s40, 32768
    s_lshl_b32 s45, s44, 11
    s_add_u32 s47, s47, s45
    s_add_u32 s47, s47, 48234496
    s_mul_i32 s48, s44, 32768
    s_add_u32 s48, s48, s45
    s_xor_b32 s49, s44, 1
    s_mul_i32 s49, s49, 32768
    s_add_u32 s49, s49, s45
    v_add_u32 v3, s48, v1
    v_add_u32 v6, s49, v1
    v_add_u32 v4, s48, v1
    v_add_u32 v7, s49, v1
    v_add_u32 v4, 61440, v4
    v_add_u32 v7, 61440, v7
    v_add_u32 v5, s48, v1
    v_add_u32 v8, s49, v1
    v_add_u32 v5, 122880, v5
    v_add_u32 v8, 122880, v8
    s_lshl_b32 s48, s13, 12
    s_add_u32 s48, s48, 65536
    v_add_u32 v9, s48, v1
    s_xor_b32 s48, s13, 2
    s_lshl_b32 s48, s48, 12
    s_add_u32 s48, s48, 65536
    v_add_u32 v10, s48, v1
    s_waitcnt vmcnt(0)
    v_lshlrev_b32 v16, 16, v48
    v_and_b32 v17, 0xffff0000, v48
    v_lshlrev_b32 v18, 16, v49
    v_and_b32 v19, 0xffff0000, v49
    v_lshlrev_b32 v20, 16, v50
    v_and_b32 v21, 0xffff0000, v50
    v_lshlrev_b32 v22, 16, v51
    v_and_b32 v23, 0xffff0000, v51
    v_lshlrev_b32 v24, 16, v52
    v_and_b32 v25, 0xffff0000, v52
    v_lshlrev_b32 v26, 16, v53
    v_and_b32 v27, 0xffff0000, v53
    v_lshlrev_b32 v28, 16, v54
    v_and_b32 v29, 0xffff0000, v54
    v_lshlrev_b32 v30, 16, v55
    v_and_b32 v31, 0xffff0000, v55
    v_mov_b32 v48, 0x3f803f80
    s_lshl_b32 s46, s56, 8
    s_add_u32 s46, s46, 70336512
    s_cmp_lg_u32 s12, 0
    s_cbranch_scc1 mega_kernel_c_dwo19
mega_kernel_c_mbw21:
    buffer_load_dword v252, v2, s[8:11], s46 offen sc1
    s_waitcnt vmcnt(0)
    v_cmp_eq_u32 vcc, 0, v252
    s_nop 1
    s_and_b64 vcc, vcc, s[60:61]
    s_cbranch_scc0 mega_kernel_c_mbd22
    s_sub_u32 s25, s25, 1
    s_cbranch_scc0 mega_kernel_c_mbw21
    s_mov_b32 s25, 0
mega_kernel_c_mbd22:
    s_mov_b64 exec, 1
    v_mov_b32 v253, 163792
    v_mov_b32 v254, 1
    ds_add_u32 v253, v254
    s_mov_b64 exec, -1
    s_branch mega_kernel_c_dwg20
mega_kernel_c_dwo19:
    v_mov_b32 v253, 163792
mega_kernel_c_lw23:
    ds_read_b32 v254, v253
    s_waitcnt lgkmcnt(0)
    v_readfirstlane_b32 s62, v254
    s_nop 1
    s_cmp_ge_u32 s62, 1
    s_cbranch_scc1 mega_kernel_c_lwd24
    s_sleep 1
    s_sub_u32 s25, s25, 1
    s_cbranch_scc0 mega_kernel_c_lw23
    s_mov_b32 s25, 0
mega_kernel_c_lwd24:
mega_kernel_c_dwg20:
    s_waitcnt lgkmcnt(0)
    buffer_load_dwordx4 v[96:99], v1, s[8:11], s47 offen offset:0 sc1
    buffer_load_dwordx4 v[100:103], v1, s[8:11], s47 offen offset:1024 sc1
    s_add_u32 s47, s47, 4096
    buffer_load_dwordx4 v[104:107], v1, s[8:11], s47 offen offset:0 sc1
    buffer_load_dwordx4 v[108:111], v1, s[8:11], s47 offen offset:1024 sc1
    s_add_u32 s47, s47, 4096
    buffer_load_dwordx4 v[112:115], v1, s[8:11], s47 offen offset:0 sc1
    buffer_load_dwordx4 v[116:119], v1, s[8:11], s47 offen offset:1024 sc1
    s_add_u32 s47, s47, 4096
    buffer_load_dwordx4 v[120:123], v1, s[8:11], s47 offen offset:0 sc1
    buffer_load_dwordx4 v[124:127], v1, s[8:11], s47 offen offset:1024 sc1
    s_add_u32 s47, s47, 4096
    buffer_load_dwordx4 v[128:131], v1, s[8:11], s47 offen offset:0 sc1
    buffer_load_dwordx4 v[132:135], v1, s[8:11], s47 offen offset:1024 sc1
    ds_read_b128 v[64:67], v3 offset:0
    ds_read_b128 v[68:71], v6 offset:0
    ds_read_b128 v[72:75], v3 offset:1024
    ds_read_b128 v[76:79], v6 offset:1024
    ds_read_b128 v[80:83], v3 offset:4096
    ds_read_b128 v[84:87], v6 offset:4096
    ds_read_b128 v[88:91], v3 offset:5120
    ds_read_b128 v[92:95], v6 offset:5120
    s_waitcnt vmcnt(9)
    s_waitcnt lgkmcnt(7)
    v_mfma_f32_32x32x16_bf16 v[16:31], v[64:67], v[96:99], v[16:31]
    s_waitcnt lgkmcnt(6)
    v_mfma_f32_32x32x16_bf16 v[32:47], v[68:71], v[96:99], 0
    s_add_u32 s47, s47, 4096
    buffer_load_dwordx4 v[136:139], v1, s[8:11], s47 offen offset:0 sc1
    ds_read_b128 v[64:67], v3 offset:8192
    ds_read_b128 v[68:71], v6 offset:8192
    s_waitcnt vmcnt(9)
    s_waitcnt lgkmcnt(7)
    v_mfma_f32_32x32x16_bf16 v[16:31], v[72:75], v[100:103], v[16:31]
    s_waitcnt lgkmcnt(6)
    v_mfma_f32_32x32x16_bf16 v[32:47], v[76:79], v[100:103], v[32:47]
    buffer_load_dwordx4 v[140:143], v1, s[8:11], s47 offen offset:1024 sc1
    ds_read_b128 v[72:75], v3 offset:9216
    ds_read_b128 v[76:79], v6 offset:9216
    s_waitcnt vmcnt(9)
    s_waitcnt lgkmcnt(7)
    v_mfma_f32_32x32x16_bf16 v[16:31], v[80:83], v[104:107], v[16:31]
    s_waitcnt lgkmcnt(6)
    v_mfma_f32_32x32x16_bf16 v[32:47], v[84:87], v[104:107], v[32:47]
    s_add_u32 s47, s47, 4096
    buffer_load_dwordx4 v[144:147], v1, s[8:11], s47 offen offset:0 sc1
    ds_read_b128 v[80:83], v3 offset:12288
    ds_read_b128 v[84:87], v6 offset:12288
    s_waitcnt vmcnt(9)
    s_waitcnt lgkmcnt(7)
    v_mfma_f32_32x32x16_bf16 v[16:31], v[88:91], v[108:111], v[16:31]
    s_waitcnt lgkmcnt(6)
    v_mfma_f32_32x32x16_bf16 v[32:47], v[92:95], v[108:111], v[32:47]
    buffer_load_dwordx4 v[148:151], v1, s[8:11], s47 offen offset:1024 sc1
    ds_read_b128 v[88:91], v3 offset:13312
    ds_read_b128 v[92:95], v6 offset:13312
    s_waitcnt vmcnt(9)
    s_waitcnt lgkmcnt(7)
    v_mfma_f32_32x32x16_bf16 v[16:31], v[64:67], v[112:115], v[16:31]
    s_waitcnt lgkmcnt(6)
    v_mfma_f32_32x32x16_bf16 v[32:47], v[68:71], v[112:115], v[32:47]
    s_add_u32 s47, s47, 4096
    buffer_load_dwordx4 v[152:155], v1, s[8:11], s47 offen offset:0 sc1
    ds_read_b128 v[64:67], v3 offset:16384
    ds_read_b128 v[68:71], v6 offset:16384
    s_waitcnt vmcnt(9)
    s_waitcnt lgkmcnt(7)
    v_mfma_f32_32x32x16_bf16 v[16:31], v[72:75], v[116:119], v[16:31]
    s_waitcnt lgkmcnt(6)
    v_mfma_f32_32x32x16_bf16 v[32:47], v[76:79], v[116:119], v[32:47]
    buffer_load_dwordx4 v[156:159], v1, s[8:11], s47 offen offset:1024 sc1
    ds_read_b128 v[72:75], v3 offset:17408
    ds_read_b128 v[76:79], v6 offset:17408
    s_waitcnt vmcnt(9)
    s_waitcnt lgkmcnt(7)
    v_mfma_f32_32x32x16_bf16 v[16:31], v[80:83], v[120:123], v[16:31]
    s_waitcnt lgkmcnt(6)
    v_mfma_f32_32x32x16_bf16 v[32:47], v[84:87], v[120:123], v[32:47]
    ds_read_b128 v[80:83], v3 offset:20480
    ds_read_b128 v[84:87], v6 offset:20480
    s_waitcnt vmcnt(8)
    s_waitcnt lgkmcnt(7)
    v_mfma_f32_32x32x16_bf16 v[16:31], v[88:91], v[124:127], v[16:31]
    s_waitcnt lgkmcnt(6)
    v_mfma_f32_32x32x16_bf16 v[32:47], v[92:95], v[124:127], v[32:47]
    ds_read_b128 v[88:91], v3 offset:21504
    ds_read_b128 v[92:95], v6 offset:21504
    s_waitcnt vmcnt(7)
    s_waitcnt lgkmcnt(7)
    v_mfma_f32_32x32x16_bf16 v[16:31], v[64:67], v[128:131], v[16:31]
    s_waitcnt lgkmcnt(6)
    v_mfma_f32_32x32x16_bf16 v[32:47], v[68:71], v[128:131], v[32:47]
    ds_read_b128 v[64:67], v3 offset:24576
    ds_read_b128 v[68:71], v6 offset:24576
    s_waitcnt vmcnt(6)
    s_waitcnt lgkmcnt(7)
    v_mfma_f32_32x32x16_bf16 v[16:31], v[72:75], v[132:135], v[16:31]
    s_waitcnt lgkmcnt(6)
    v_mfma_f32_32x32x16_bf16 v[32:47], v[76:79], v[132:135], v[32:47]
    ds_read_b128 v[72:75], v3 offset:25600
    ds_read_b128 v[76:79], v6 offset:25600
    s_waitcnt vmcnt(5)
    s_waitcnt lgkmcnt(7)
    v_mfma_f32_32x32x16_bf16 v[16:31], v[80:83], v[136:139], v[16:31]
    s_waitcnt lgkmcnt(6)
    v_mfma_f32_32x32x16_bf16 v[32:47], v[84:87], v[136:139], v[32:47]
    ds_read_b128 v[80:83], v3 offset:28672
    ds_read_b128 v[84:87], v6 offset:28672
    s_waitcnt vmcnt(4)
    s_waitcnt lgkmcnt(7)
    v_mfma_f32_32x32x16_bf16 v[16:31], v[88:91], v[140:143], v[16:31]
    s_waitcnt lgkmcnt(6)
    v_mfma_f32_32x32x16_bf16 v[32:47], v[92:95], v[140:143], v[32:47]
    ds_read_b128 v[88:91], v3 offset:29696
    ds_read_b128 v[92:95], v6 offset:29696
    s_waitcnt vmcnt(3)
    s_waitcnt lgkmcnt(7)
    v_mfma_f32_32x32x16_bf16 v[16:31], v[64:67], v[144:147], v[16:31]
    s_waitcnt lgkmcnt(6)
    v_mfma_f32_32x32x16_bf16 v[32:47], v[68:71], v[144:147], v[32:47]
    s_waitcnt vmcnt(2)
    s_waitcnt lgkmcnt(5)
    v_mfma_f32_32x32x16_bf16 v[16:31], v[72:75], v[148:151], v[16:31]
    s_waitcnt lgkmcnt(4)
    v_mfma_f32_32x32x16_bf16 v[32:47], v[76:79], v[148:151], v[32:47]
    s_waitcnt vmcnt(1)
    s_waitcnt lgkmcnt(3)
    v_mfma_f32_32x32x16_bf16 v[16:31], v[80:83], v[152:155], v[16:31]
    s_waitcnt lgkmcnt(2)
    v_mfma_f32_32x32x16_bf16 v[32:47], v[84:87], v[152:155], v[32:47]
    s_waitcnt vmcnt(0)
    s_waitcnt lgkmcnt(1)
    v_mfma_f32_32x32x16_bf16 v[16:31], v[88:91], v[156:159], v[16:31]
    s_waitcnt lgkmcnt(0)
    v_mfma_f32_32x32x16_bf16 v[32:47], v[92:95], v[156:159], v[32:47]
    s_nop 11
    ds_write_b128 v9, v[32:35] offset:0
    ds_write_b128 v9, v[36:39] offset:1024
    ds_write_b128 v9, v[40:43] offset:2048
    ds_write_b128 v9, v[44:47] offset:3072
    s_waitcnt lgkmcnt(0)
    s_barrier
    ds_read_b128 v[64:67], v10 offset:0
    ds_read_b128 v[68:71], v10 offset:1024
    ds_read_b128 v[72:75], v10 offset:2048
    ds_read_b128 v[76:79], v10 offset:3072
    s_waitcnt lgkmcnt(3)
    v_add_f32 v16, v16, v64
    v_add_f32 v17, v17, v65
    v_add_f32 v18, v18, v66
    v_add_f32 v19, v19, v67
    v_cvt_pk_bf16_f32 v96, v16, v17
    v_cvt_pk_bf16_f32 v97, v18, v19
    s_waitcnt lgkmcnt(2)
    v_add_f32 v20, v20, v68
    v_add_f32 v21, v21, v69
    v_add_f32 v22, v22, v70
    v_add_f32 v23, v23, v71
    v_cvt_pk_bf16_f32 v98, v20, v21
    v_cvt_pk_bf16_f32 v99, v22, v23
    s_waitcnt lgkmcnt(1)
    v_add_f32 v24, v24, v72
    v_add_f32 v25, v25, v73
    v_add_f32 v26, v26, v74
    v_add_f32 v27, v27, v75
    v_cvt_pk_bf16_f32 v100, v24, v25
    v_cvt_pk_bf16_f32 v101, v26, v27
    s_waitcnt lgkmcnt(0)
    v_add_f32 v28, v28, v76
    v_add_f32 v29, v29, v77
    v_add_f32 v30, v30, v78
    v_add_f32 v31, v31, v79
    v_cvt_pk_bf16_f32 v102, v28, v29
    v_cvt_pk_bf16_f32 v103, v30, v31
    s_add_u32 s45, s42, 12582912
    buffer_store_dwordx4 v[96:99], v1, s[8:11], s45 offen sc1
    buffer_store_dwordx4 v[100:103], v1, s[8:11], s45 offen offset:1024 sc1
    v_mov_b32 v56, 0
    v_mov_b32 v57, 0
    v_dot2c_f32_bf16 v56, v96, v48
    v_dot2c_f32_bf16 v57, v96, v96
    v_dot2c_f32_bf16 v56, v97, v48
    v_dot2c_f32_bf16 v57, v97, v97
    v_dot2c_f32_bf16 v56, v98, v48
    v_dot2c_f32_bf16 v57, v98, v98
    v_dot2c_f32_bf16 v56, v99, v48
    v_dot2c_f32_bf16 v57, v99, v99
    v_dot2c_f32_bf16 v56, v100, v48
    v_dot2c_f32_bf16 v57, v100, v100
    v_dot2c_f32_bf16 v56, v101, v48
    v_dot2c_f32_bf16 v57, v101, v101
    v_dot2c_f32_bf16 v56, v102, v48
    v_dot2c_f32_bf16 v57, v102, v102
    v_dot2c_f32_bf16 v56, v103, v48
    v_dot2c_f32_bf16 v57, v103, v103
    s_nop 1
    v_mov_b32 v58, v56
    v_mov_b32 v59, v57
    s_nop 0
    v_permlane32_swap_b32 v58, v56
    v_permlane32_swap_b32 v59, v57
    v_add_f32 v56, v56, v58
    v_add_f32 v57, v57, v59
    v_and_b32 v58, 31, v0
    v_lshlrev_b32 v58, 3, v58
    s_mul_i32 s45, s40, 14
    s_add_u32 s45, s45, s41
    s_lshl_b32 s45, s45, 8
    s_add_u32 s45, s45, 35913728
    buffer_store_dwordx2 v[56:57], v58, s[8:11], s45 offen sc1
    s_lshr_b32 s46, s56, 4
    s_and_b32 s63, s56, 15
    s_lshl_b32 s46, s46, 12
    s_lshl_b32 s63, s63, 2
    s_add_u32 s46, s46, s63
    s_add_u32 s46, s46, 70418432
    v_mul_u32_u24 v255, 256, v0
    v_mov_b32 v254, 1
    v_mov_b32 v253, 163776
    s_waitcnt vmcnt(0)
    s_mov_b64 exec, 1
    ds_add_rtn_u32 v253, v253, v254
    s_waitcnt lgkmcnt(0)
    v_readfirstlane_b32 s62, v253
    s_mov_b64 exec, 65535
    s_and_b32 s62, s62, 3
    s_cmp_lg_u32 s62, 3
    s_cbranch_scc1 mega_kernel_c_sig25
    buffer_store_dword v254, v255, s[8:11], s46 offen sc1
mega_kernel_c_sig25:
    s_mov_b64 exec, -1
mega_kernel_c_skip18:
    s_nop 7
    s_nop 7
    s_lshl_b32 s40, s20, 2
    s_add_u32 s40, s40, s13
    s_mul_i32 s41, s40, 28672
    s_add_u32 s41, s41, 12582912
    s_mul_i32 s42, s40, 3584
    s_add_u32 s42, s42, 35913728
    v_mov_b32 v5, 0x3f803f80
    v_lshrrev_b32 v228, 5, v0
    v_mul_u32_u24 v228, 1792, v228
    v_and_b32 v229, 31, v0
    v_lshl_add_u32 v228, v229, 3, v228
    v_mov_b32 v10, v1
    v_add_u32 v11, 59392, v1
    v_add_u32 v12, 118784, v1
    s_mul_i32 s44, s40, 114688
    s_add_u32 s44, s44, 52428800
    s_mul_i32 s46, s21, 3072
    s_add_u32 s45, s44, s46
    s_add_u32 s45, s45, 65536
    s_lshl_b32 s46, s21, 12
    s_add_u32 s44, s44, s46
    s_mov_b32 s47, s20
    s_mov_b32 s63, s21
    s_lshl_b32 s47, s47, 12
    s_lshl_b32 s63, s63, 2
    s_add_u32 s47, s47, s63
    s_add_u32 s47, s47, 70500352
    s_mov_b32 s48, s20
    s_mov_b32 s63, s21
    s_lshl_b32 s48, s48, 12
    s_lshl_b32 s63, s63, 2
    s_add_u32 s48, s48, s63
    s_add_u32 s48, s48, 70582272
    s_lshl_b32 s46, s20, 4
    s_add_u32 s46, s46, s21
    s_lshl_b32 s46, s46, 8
    s_add_u32 s46, s46, 70418432
    s_cmp_lg_u32 s12, 0
    s_cbranch_scc1 mega_kernel_c_dwo26
mega_kernel_c_mbw28:
    buffer_load_dword v252, v2, s[8:11], s46 offen sc1
    s_waitcnt vmcnt(0)
    v_cmp_eq_u32 vcc, 0, v252
    s_nop 1
    s_and_b64 vcc, vcc, s[58:59]
    s_cbranch_scc0 mega_kernel_c_mbd29
    s_sub_u32 s25, s25, 1
    s_cbranch_scc0 mega_kernel_c_mbw28
    s_mov_b32 s25, 0
mega_kernel_c_mbd29:
    s_mov_b64 exec, 1
    v_mov_b32 v253, 163788
    v_mov_b32 v254, 1
    ds_add_u32 v253, v254
    s_mov_b64 exec, -1
    s_branch mega_kernel_c_dwg27
mega_kernel_c_dwo26:
    v_mov_b32 v253, 163788
mega_kernel_c_lw30:
    ds_read_b32 v254, v253
    s_waitcnt lgkmcnt(0)
    v_readfirstlane_b32 s62, v254
    s_nop 1
    s_cmp_ge_u32 s62, 1
    s_cbranch_scc1 mega_kernel_c_lwd31
    s_sleep 1
    s_sub_u32 s25, s25, 1
    s_cbranch_scc0 mega_kernel_c_lw30
    s_mov_b32 s25, 0
mega_kernel_c_lwd31:
mega_kernel_c_dwg27:
    s_waitcnt lgkmcnt(0)
    s_add_u32 s43, s41, s33
    buffer_load_dwordx4 v[16:19], v1, s[8:11], s43 offen offset:0 sc1
    buffer_load_dwordx4 v[20:23], v1, s[8:11], s43 offen offset:1024 sc1
    buffer_load_dwordx4 v[24:27], v1, s[8:11], s43 offen offset:2048 sc1
    buffer_load_dwordx4 v[28:31], v1, s[8:11], s43 offen offset:3072 sc1
    s_add_u32 s43, s41, s34
    buffer_load_dwordx4 v[32:35], v1, s[8:11], s43 offen offset:0 sc1
    buffer_load_dwordx4 v[36:39], v1, s[8:11], s43 offen offset:1024 sc1
    buffer_load_dwordx4 v[40:43], v1, s[8:11], s43 offen offset:2048 sc1
    buffer_load_dwordx4 v[44:47], v1, s[8:11], s43 offen offset:3072 sc1
    s_add_u32 s43, s41, s35
    buffer_load_dwordx4 v[48:51], v1, s[8:11], s43 offen offset:0 sc1
    buffer_load_dwordx4 v[52:55], v1, s[8:11], s43 offen offset:1024 sc1
    buffer_load_dwordx4 v[56:59], v1, s[8:11], s43 offen offset:2048 sc1
    buffer_load_dwordx4 v[60:63], v1, s[8:11], s43 offen offset:3072 sc1
    buffer_load_dwordx2 v[212:213], v228, s[8:11], s42 offen offset:0 sc1
    buffer_load_dwordx2 v[214:215], v228, s[8:11], s42 offen offset:256 sc1
    buffer_load_dwordx2 v[216:217], v228, s[8:11], s42 offen offset:512 sc1
    buffer_load_dwordx2 v[218:219], v228, s[8:11], s42 offen offset:768 sc1
    buffer_load_dwordx2 v[220:221], v228, s[8:11], s42 offen offset:1024 sc1
    buffer_load_dwordx2 v[222:223], v228, s[8:11], s42 offen offset:1280 sc1
    buffer_load_dwordx2 v[224:225], v228, s[8:11], s42 offen offset:1536 sc1
    v_mov_b32 v253, 163804
mega_kernel_c_lw32:
    ds_read_b32 v254, v253
    s_waitcnt lgkmcnt(0)
    v_readfirstlane_b32 s62, v254
    s_nop 1
    s_cmp_ge_u32 s62, 4
    s_cbranch_scc1 mega_kernel_c_lwd33
    s_sleep 1
    s_sub_u32 s25, s25, 1
    s_cbranch_scc0 mega_kernel_c_lw32
    s_mov_b32 s25, 0
mega_kernel_c_lwd33:
    ds_read_b128 v[132:135], v10 offset:0
    ds_read_b128 v[136:139], v10 offset:29696
    ds_read_b128 v[140:143], v10 offset:1024
    ds_read_b128 v[144:147], v10 offset:30720
    ds_read_b128 v[148:151], v10 offset:2048
    ds_read_b128 v[152:155], v10 offset:31744
    ds_read_b128 v[156:159], v10 offset:3072
    s_waitcnt vmcnt(15)
    s_waitcnt lgkmcnt(5)
    v_mfma_f32_32x32x16_bf16 v[164:179], v[132:135], v[16:19], 0
    s_add_u32 s43, s41, s36
    buffer_load_dwordx4 v[64:67], v1, s[8:11], s43 offen offset:0 sc1
    buffer_load_dwordx4 v[68:71], v1, s[8:11], s43 offen offset:1024 sc1
    ds_read_b128 v[160:163], v10 offset:32768
    v_mfma_f32_32x32x16_bf16 v[180:195], v[136:139], v[16:19], 0
    buffer_load_dwordx4 v[72:75], v1, s[8:11], s43 offen offset:2048 sc1
    buffer_load_dwordx4 v[76:79], v1, s[8:11], s43 offen offset:3072 sc1
    ds_read_b128 v[132:135], v10 offset:4096
    s_waitcnt lgkmcnt(5)
    v_mfma_f32_32x32x16_bf16 v[164:179], v[140:143], v[20:23], v[164:179]
    s_add_u32 s43, s41, s37
    buffer_load_dwordx4 v[80:83], v1, s[8:11], s43 offen offset:0 sc1
    buffer_load_dwordx4 v[84:87], v1, s[8:11], s43 offen offset:1024 sc1
    ds_read_b128 v[136:139], v10 offset:33792
    v_mfma_f32_32x32x16_bf16 v[180:195], v[144:147], v[20:23], v[180:195]
    buffer_load_dwordx4 v[88:91], v1, s[8:11], s43 offen offset:2048 sc1
    buffer_load_dwordx4 v[92:95], v1, s[8:11], s43 offen offset:3072 sc1
    ds_read_b128 v[140:143], v10 offset:5120
    s_waitcnt lgkmcnt(5)
    v_mfma_f32_32x32x16_bf16 v[164:179], v[148:151], v[24:27], v[164:179]
    s_add_u32 s43, s41, s38
    buffer_load_dwordx4 v[96:99], v1, s[8:11], s43 offen offset:0 sc1
    buffer_load_dwordx4 v[100:103], v1, s[8:11], s43 offen offset:1024 sc1
    ds_read_b128 v[144:147], v10 offset:34816
    v_mfma_f32_32x32x16_bf16 v[180:195], v[152:155], v[24:27], v[180:195]
    buffer_load_dwordx4 v[104:107], v1, s[8:11], s43 offen offset:2048 sc1
    buffer_load_dwordx4 v[108:111], v1, s[8:11], s43 offen offset:3072 sc1
    ds_read_b128 v[148:151], v10 offset:6144
    s_waitcnt lgkmcnt(5)
    v_mfma_f32_32x32x16_bf16 v[164:179], v[156:159], v[28:31], v[164:179]
    s_add_u32 s43, s41, s39
    buffer_load_dwordx4 v[112:115], v1, s[8:11], s43 offen offset:0 sc1
    ds_read_b128 v[152:155], v10 offset:35840
    v_mfma_f32_32x32x16_bf16 v[180:195], v[160:163], v[28:31], v[180:195]
    buffer_load_dwordx4 v[116:119], v1, s[8:11], s43 offen offset:1024 sc1
    ds_read_b128 v[156:159], v10 offset:7168
    s_waitcnt vmcnt(25)
    s_waitcnt lgkmcnt(5)
    v_mfma_f32_32x32x16_bf16 v[164:179], v[132:135], v[32:35], v[164:179]
    buffer_load_dwordx4 v[120:123], v1, s[8:11], s43 offen offset:2048 sc1
    ds_read_b128 v[160:163], v10 offset:36864
    v_mfma_f32_32x32x16_bf16 v[180:195], v[136:139], v[32:35], v[180:195]
    buffer_load_dwordx4 v[124:127], v1, s[8:11], s43 offen offset:3072 sc1
    ds_read_b128 v[132:135], v10 offset:8192
    s_waitcnt lgkmcnt(5)
    v_mfma_f32_32x32x16_bf16 v[164:179], v[140:143], v[36:39], v[164:179]
    ds_read_b128 v[136:139], v10 offset:37888
    v_mfma_f32_32x32x16_bf16 v[180:195], v[144:147], v[36:39], v[180:195]
    ds_read_b128 v[140:143], v10 offset:9216
    s_waitcnt lgkmcnt(5)
    v_mfma_f32_32x32x16_bf16 v[164:179], v[148:151], v[40:43], v[164:179]
    ds_read_b128 v[144:147], v10 offset:38912
    v_mfma_f32_32x32x16_bf16 v[180:195], v[152:155], v[40:43], v[180:195]
    ds_read_b128 v[148:151], v10 offset:10240
    s_waitcnt lgkmcnt(5)
    v_mfma_f32_32x32x16_bf16 v[164:179], v[156:159], v[44:47], v[164:179]
    ds_read_b128 v[152:155], v10 offset:39936
    v_mfma_f32_32x32x16_bf16 v[180:195], v[160:163], v[44:47], v[180:195]
    ds_read_b128 v[156:159], v10 offset:11264
    s_waitcnt vmcnt(23)
    s_waitcnt lgkmcnt(5)
    v_mfma_f32_32x32x16_bf16 v[164:179], v[132:135], v[48:51], v[164:179]
    s_waitcnt vmcnt(16)
    v_add_f32 v3, v212, v214
    v_add_f32 v4, v213, v215
    ds_read_b128 v[160:163], v10 offset:40960
    v_mfma_f32_32x32x16_bf16 v[180:195], v[136:139], v[48:51], v[180:195]
    v_add_f32 v3, v3, v216
    v_add_f32 v4, v4, v217
    v_add_f32 v3, v3, v218
    ds_read_b128 v[132:135], v10 offset:12288
    s_waitcnt lgkmcnt(5)
    v_mfma_f32_32x32x16_bf16 v[164:179], v[140:143], v[52:55], v[164:179]
    v_add_f32 v4, v4, v219
    v_add_f32 v3, v3, v220
    v_add_f32 v4, v4, v221
    ds_read_b128 v[136:139], v10 offset:41984
    v_mfma_f32_32x32x16_bf16 v[180:195], v[144:147], v[52:55], v[180:195]
    v_add_f32 v3, v3, v222
    v_add_f32 v4, v4, v223
    v_add_f32 v3, v3, v224
    ds_read_b128 v[140:143], v10 offset:13312
    s_waitcnt lgkmcnt(5)
    v_mfma_f32_32x32x16_bf16 v[164:179], v[148:151], v[56:59], v[164:179]
    v_add_f32 v4, v4, v225
    v_mov_b32 v228, v3
    v_mov_b32 v229, v4
    ds_read_b128 v[144:147], v10 offset:43008
    v_mfma_f32_32x32x16_bf16 v[180:195], v[152:155], v[56:59], v[180:195]
    v_permlane32_swap_b32 v228, v3
    v_permlane32_swap_b32 v229, v4
    v_add_f32 v3, v228, v3
    ds_read_b128 v[148:151], v10 offset:14336
    s_waitcnt lgkmcnt(5)
    v_mfma_f32_32x32x16_bf16 v[164:179], v[156:159], v[60:63], v[164:179]
    v_add_f32 v4, v229, v4
    v_mul_f32 v3, 0xbb124925, v3
    v_mul_f32 v4, 0x3b124925, v4
    ds_read_b128 v[152:155], v10 offset:44032
    v_mfma_f32_32x32x16_bf16 v[180:195], v[160:163], v[60:63], v[180:195]
    v_fma_f32 v4, -v3, v3, v4
    v_max_f32 v4, 0, v4
    v_add_f32 v9, 0x3727c5ac, v4
    ds_read_b128 v[156:159], v10 offset:15360
    s_waitcnt vmcnt(12)
    s_waitcnt lgkmcnt(5)
    v_mfma_f32_32x32x16_bf16 v[164:179], v[132:135], v[64:67], v[164:179]
    v_cvt_pk_bf16_f32 v128, v3, v3
    v_rsq_f32 v6, v9
    v_lshlrev_b32 v228, 16, v128
    ds_read_b128 v[160:163], v10 offset:45056
    v_mfma_f32_32x32x16_bf16 v[180:195], v[136:139], v[64:67], v[180:195]
    v_sub_f32 v228, v3, v228
    v_cvt_pk_bf16_f32 v129, v228, v228
    v_mov_b32 v130, v128
    ds_read_b128 v[132:135], v10 offset:16384
    s_waitcnt lgkmcnt(5)
    v_mfma_f32_32x32x16_bf16 v[164:179], v[140:143], v[68:71], v[164:179]
    v_mov_b32 v131, v129
    v_mul_f32 v7, 0xc0135761, v6
    v_mul_f32 v228, v6, v6
    ds_read_b128 v[136:139], v10 offset:46080
    v_mfma_f32_32x32x16_bf16 v[180:195], v[144:147], v[68:71], v[180:195]
    v_mul_f32 v228, v228, v6
    v_mul_f32 v8, 0xbdd2d3e8, v228
    v_mov_b32 v14, v7
    ds_read_b128 v[140:143], v10 offset:17408
    s_waitcnt lgkmcnt(5)
    v_mfma_f32_32x32x16_bf16 v[164:179], v[148:151], v[72:75], v[164:179]
    ds_read_b128 v[144:147], v10 offset:47104
    v_mfma_f32_32x32x16_bf16 v[180:195], v[152:155], v[72:75], v[180:195]
    ds_read_b128 v[148:151], v10 offset:18432
    s_waitcnt lgkmcnt(5)
    v_mfma_f32_32x32x16_bf16 v[164:179], v[156:159], v[76:79], v[164:179]
    ds_read_b128 v[152:155], v10 offset:48128
    v_mfma_f32_32x32x16_bf16 v[180:195], v[160:163], v[76:79], v[180:195]
    ds_read_b128 v[156:159], v10 offset:19456
    s_waitcnt vmcnt(8)
    s_waitcnt lgkmcnt(5)
    v_mfma_f32_32x32x16_bf16 v[164:179], v[132:135], v[80:83], v[164:179]
    ds_read_b128 v[160:163], v10 offset:49152
    v_mfma_f32_32x32x16_bf16 v[180:195], v[136:139], v[80:83], v[180:195]
    ds_read_b128 v[132:135], v10 offset:20480
    s_waitcnt lgkmcnt(5)
    v_mfma_f32_32x32x16_bf16 v[164:179], v[140:143], v[84:87], v[164:179]
    ds_read_b128 v[136:139], v10 offset:50176
    v_mfma_f32_32x32x16_bf16 v[180:195], v[144:147], v[84:87], v[180:195]
    ds_read_b128 v[140:143], v10 offset:21504
    s_waitcnt lgkmcnt(5)
    v_mfma_f32_32x32x16_bf16 v[164:179], v[148:151], v[88:91], v[164:179]
    ds_read_b128 v[144:147], v10 offset:51200
    v_mfma_f32_32x32x16_bf16 v[180:195], v[152:155], v[88:91], v[180:195]
    ds_read_b128 v[148:151], v10 offset:22528
    s_waitcnt lgkmcnt(5)
    v_mfma_f32_32x32x16_bf16 v[164:179], v[156:159], v[92:95], v[164:179]
    ds_read_b128 v[152:155], v10 offset:52224
    v_mfma_f32_32x32x16_bf16 v[180:195], v[160:163], v[92:95], v[180:195]
    ds_read_b128 v[156:159], v10 offset:23552
    s_waitcnt vmcnt(4)
    s_waitcnt lgkmcnt(5)
    v_mfma_f32_32x32x16_bf16 v[164:179], v[132:135], v[96:99], v[164:179]
    ds_read_b128 v[160:163], v10 offset:53248
    v_mfma_f32_32x32x16_bf16 v[180:195], v[136:139], v[96:99], v[180:195]
    ds_read_b128 v[132:135], v10 offset:24576
    s_waitcnt lgkmcnt(5)
    v_mfma_f32_32x32x16_bf16 v[164:179], v[140:143], v[100:103], v[164:179]
    ds_read_b128 v[136:139], v10 offset:54272
    v_mfma_f32_32x32x16_bf16 v[180:195], v[144:147], v[100:103], v[180:195]
    ds_read_b128 v[140:143], v10 offset:25600
    s_waitcnt lgkmcnt(5)
    v_mfma_f32_32x32x16_bf16 v[164:179], v[148:151], v[104:107], v[164:179]
    ds_read_b128 v[144:147], v10 offset:55296
    v_mfma_f32_32x32x16_bf16 v[180:195], v[152:155], v[104:107], v[180:195]
    ds_read_b128 v[148:151], v10 offset:26624
    s_waitcnt lgkmcnt(5)
    v_mfma_f32_32x32x16_bf16 v[164:179], v[156:159], v[108:111], v[164:179]
    ds_read_b128 v[152:155], v10 offset:56320
    v_mfma_f32_32x32x16_bf16 v[180:195], v[160:163], v[108:111], v[180:195]
    ds_read_b128 v[156:159], v10 offset:27648
    s_waitcnt vmcnt(0)
    s_waitcnt lgkmcnt(5)
    v_mfma_f32_32x32x16_bf16 v[164:179], v[132:135], v[112:115], v[164:179]
    ds_read_b128 v[160:163], v10 offset:57344
    v_mfma_f32_32x32x16_bf16 v[180:195], v[136:139], v[112:115], v[180:195]
    ds_read_b128 v[132:135], v10 offset:28672
    s_waitcnt lgkmcnt(5)
    v_mfma_f32_32x32x16_bf16 v[164:179], v[140:143], v[116:119], v[164:179]
    ds_read_b128 v[136:139], v10 offset:58368
    v_mfma_f32_32x32x16_bf16 v[180:195], v[144:147], v[116:119], v[180:195]
    s_barrier
    ds_read_b128 v[140:143], v11 offset:0
    s_waitcnt lgkmcnt(5)
    v_mfma_f32_32x32x16_bf16 v[164:179], v[148:151], v[120:123], v[164:179]
    ds_read_b128 v[144:147], v11 offset:1024
    v_mfma_f32_32x32x16_bf16 v[180:195], v[152:155], v[120:123], v[180:195]
    ds_read_b128 v[148:151], v11 offset:2048
    s_waitcnt lgkmcnt(5)
    v_mfma_f32_32x32x16_bf16 v[164:179], v[156:159], v[124:127], v[164:179]
    ds_read_b128 v[152:155], v11 offset:3072
    v_mfma_f32_32x32x16_bf16 v[180:195], v[160:163], v[124:127], v[180:195]
    ds_read_b128 v[156:159], v11 offset:4096
    s_waitcnt lgkmcnt(5)
    v_mfma_f32_32x32x16_bf16 v[164:179], v[132:135], v[128:131], v[164:179]
    ds_read_b128 v[160:163], v11 offset:5120
    v_mfma_f32_32x32x16_bf16 v[180:195], v[136:139], v[128:131], v[180:195]
    ds_read_b128 v[132:135], v11 offset:6144
    s_waitcnt lgkmcnt(5)
    v_mfma_f32_32x32x16_bf16 v[196:211], v[140:143], v[16:19], 0
    s_barrier
    ds_read_b128 v[136:139], v11 offset:7168
    v_mfma_f32_32x32x16_bf16 v[196:211], v[144:147], v[20:23], v[196:211]
    s_nop 3
    v_mul_f32 v228, v164, v164
    v_mul_f32 v229, v165, v165
    v_mul_f32 v230, v166, v166
    v_mul_f32 v231, v167, v167
    ds_read_b128 v[140:143], v11 offset:8192
    s_waitcnt lgkmcnt(5)
    v_mfma_f32_32x32x16_bf16 v[196:211], v[148:151], v[24:27], v[196:211]
    v_fma_f32 v228, v228, v8, v7
    v_fma_f32 v229, v229, v8, v7
    v_fma_f32 v230, v230, v8, v7
    v_fma_f32 v231, v231, v8, v7
    ds_read_b128 v[144:147], v11 offset:9216
    v_mfma_f32_32x32x16_bf16 v[196:211], v[152:155], v[28:31], v[196:211]
    v_mul_f32 v228, v164, v228
    v_mul_f32 v229, v165, v229
    v_mul_f32 v230, v166, v230
    v_mul_f32 v231, v167, v231
    ds_read_b128 v[148:151], v11 offset:10240
    s_waitcnt lgkmcnt(5)
    v_mfma_f32_32x32x16_bf16 v[196:211], v[156:159], v[32:35], v[196:211]
    v_exp_f32 v228, v228
    v_mul_f32 v164, v164, v172
    v_exp_f32 v229, v229
    ds_read_b128 v[152:155], v11 offset:11264
    v_mfma_f32_32x32x16_bf16 v[196:211], v[160:163], v[36:39], v[196:211]
    v_mul_f32 v165, v165, v173
    v_exp_f32 v230, v230
    v_mul_f32 v166, v166, v174
    ds_read_b128 v[156:159], v11 offset:12288
    s_waitcnt lgkmcnt(5)
    v_mfma_f32_32x32x16_bf16 v[196:211], v[132:135], v[40:43], v[196:211]
    v_exp_f32 v231, v231
    v_mul_f32 v167, v167, v175
    v_fma_f32 v228, v228, v9, v9
    ds_read_b128 v[160:163], v11 offset:13312
    v_mfma_f32_32x32x16_bf16 v[196:211], v[136:139], v[44:47], v[196:211]
    v_fma_f32 v229, v229, v9, v9
    v_fma_f32 v230, v230, v9, v9
    v_fma_f32 v231, v231, v9, v9
    v_rcp_f32 v228, v228
    ds_read_b128 v[132:135], v11 offset:14336
    s_waitcnt lgkmcnt(5)
    v_mfma_f32_32x32x16_bf16 v[196:211], v[140:143], v[48:51], v[196:211]
    v_rcp_f32 v229, v229
    v_rcp_f32 v230, v230
    ds_read_b128 v[136:139], v11 offset:15360
    v_mfma_f32_32x32x16_bf16 v[196:211], v[144:147], v[52:55], v[196:211]
    v_rcp_f32 v231, v231
    v_mul_f32 v164, v164, v228
    v_mul_f32 v165, v165, v229
    ds_read_b128 v[140:143], v11 offset:16384
    s_waitcnt lgkmcnt(5)
    v_mfma_f32_32x32x16_bf16 v[196:211], v[148:151], v[56:59], v[196:211]
    v_mul_f32 v166, v166, v230
    v_mul_f32 v167, v167, v231
    v_mul_f32 v232, v168, v168
    v_mul_f32 v233, v169, v169
    ds_read_b128 v[144:147], v11 offset:17408
    v_mfma_f32_32x32x16_bf16 v[196:211], v[152:155], v[60:63], v[196:211]
    v_mul_f32 v234, v170, v170
    v_mul_f32 v235, v171, v171
    v_fma_f32 v232, v232, v8, v7
    v_fma_f32 v233, v233, v8, v7
    ds_read_b128 v[148:151], v11 offset:18432
    s_waitcnt lgkmcnt(5)
    v_mfma_f32_32x32x16_bf16 v[196:211], v[156:159], v[64:67], v[196:211]
    v_fma_f32 v234, v234, v8, v7
    v_fma_f32 v235, v235, v8, v7
    v_mul_f32 v232, v168, v232
    v_mul_f32 v233, v169, v233
    ds_read_b128 v[152:155], v11 offset:19456
    v_mfma_f32_32x32x16_bf16 v[196:211], v[160:163], v[68:71], v[196:211]
    v_mul_f32 v234, v170, v234
    v_mul_f32 v235, v171, v235
    v_exp_f32 v232, v232
    ds_read_b128 v[156:159], v11 offset:20480
    s_waitcnt lgkmcnt(5)
    v_mfma_f32_32x32x16_bf16 v[196:211], v[132:135], v[72:75], v[196:211]
    v_mul_f32 v168, v168, v176
    v_exp_f32 v233, v233
    v_mul_f32 v169, v169, v177
    ds_read_b128 v[160:163], v11 offset:21504
    v_mfma_f32_32x32x16_bf16 v[196:211], v[136:139], v[76:79], v[196:211]
    v_exp_f32 v234, v234
    v_mul_f32 v170, v170, v178
    v_exp_f32 v235, v235
    ds_read_b128 v[132:135], v11 offset:22528
    s_waitcnt lgkmcnt(5)
    v_mfma_f32_32x32x16_bf16 v[196:211], v[140:143], v[80:83], v[196:211]
    v_mul_f32 v171, v171, v179
    v_fma_f32 v232, v232, v9, v9
    v_fma_f32 v233, v233, v9, v9
    v_fma_f32 v234, v234, v9, v9
    ds_read_b128 v[136:139], v11 offset:23552
    v_mfma_f32_32x32x16_bf16 v[196:211], v[144:147], v[84:87], v[196:211]
    v_fma_f32 v235, v235, v9, v9
    v_rcp_f32 v232, v232
    v_rcp_f32 v233, v233
    ds_read_b128 v[140:143], v11 offset:24576
    s_waitcnt lgkmcnt(5)
    v_mfma_f32_32x32x16_bf16 v[196:211], v[148:151], v[88:91], v[196:211]
    v_rcp_f32 v234, v234
    v_rcp_f32 v235, v235
    ds_read_b128 v[144:147], v11 offset:25600
    v_mfma_f32_32x32x16_bf16 v[196:211], v[152:155], v[92:95], v[196:211]
    v_mul_f32 v168, v168, v232
    v_mul_f32 v169, v169, v233
    v_mul_f32 v170, v170, v234
    v_mul_f32 v171, v171, v235
    ds_read_b128 v[148:151], v11 offset:26624
    s_waitcnt lgkmcnt(5)
    v_mfma_f32_32x32x16_bf16 v[196:211], v[156:159], v[96:99], v[196:211]
    v_cvt_pk_bf16_f32 v236, v164, v165
    v_cvt_pk_bf16_f32 v237, v166, v167
    v_cvt_pk_bf16_f32 v238, v168, v169
    v_cvt_pk_bf16_f32 v239, v170, v171
    ds_read_b128 v[152:155], v11 offset:27648
    v_mfma_f32_32x32x16_bf16 v[196:211], v[160:163], v[100:103], v[196:211]
    buffer_store_dwordx4 v[236:239], v1, s[8:11], s44 offen offset:0 sc1
    v_mul_f32 v228, v180, v180
    v_mul_f32 v229, v181, v181
    v_mul_f32 v230, v182, v182
    ds_read_b128 v[156:159], v11 offset:28672
    s_waitcnt lgkmcnt(5)
    v_mfma_f32_32x32x16_bf16 v[196:211], v[132:135], v[104:107], v[196:211]
    v_mul_f32 v231, v183, v183
    v_fma_f32 v228, v228, v8, v7
    v_fma_f32 v229, v229, v8, v7
    v_fma_f32 v230, v230, v8, v7
    ds_read_b128 v[160:163], v11 offset:29696
    v_mfma_f32_32x32x16_bf16 v[196:211], v[136:139], v[108:111], v[196:211]
    v_fma_f32 v231, v231, v8, v7
    v_mul_f32 v228, v180, v228
    v_mul_f32 v229, v181, v229
    v_mul_f32 v230, v182, v230
    ds_read_b128 v[132:135], v11 offset:30720
    s_waitcnt lgkmcnt(5)
    v_mfma_f32_32x32x16_bf16 v[196:211], v[140:143], v[112:115], v[196:211]
    v_mul_f32 v231, v183, v231
    v_exp_f32 v228, v228
    v_mul_f32 v180, v180, v188
    ds_read_b128 v[136:139], v11 offset:31744
    v_mfma_f32_32x32x16_bf16 v[196:211], v[144:147], v[116:119], v[196:211]
    v_exp_f32 v229, v229
    v_mul_f32 v181, v181, v189
    v_exp_f32 v230, v230
    ds_read_b128 v[140:143], v11 offset:32768
    s_waitcnt lgkmcnt(5)
    v_mfma_f32_32x32x16_bf16 v[196:211], v[148:151], v[120:123], v[196:211]
    v_mul_f32 v182, v182, v190
    v_exp_f32 v231, v231
    v_mul_f32 v183, v183, v191
    ds_read_b128 v[144:147], v11 offset:33792
    v_mfma_f32_32x32x16_bf16 v[196:211], v[152:155], v[124:127], v[196:211]
    v_fma_f32 v228, v228, v9, v9
    v_fma_f32 v229, v229, v9, v9
    v_fma_f32 v230, v230, v9, v9
    v_fma_f32 v231, v231, v9, v9
    ds_read_b128 v[148:151], v11 offset:34816
    s_waitcnt lgkmcnt(5)
    v_mfma_f32_32x32x16_bf16 v[196:211], v[156:159], v[128:131], v[196:211]
    v_rcp_f32 v228, v228
    v_rcp_f32 v229, v229
    ds_read_b128 v[152:155], v11 offset:35840
    v_mfma_f32_32x32x16_bf16 v[212:227], v[160:163], v[16:19], 0
    v_rcp_f32 v230, v230
    v_rcp_f32 v231, v231
    s_mov_b64 exec, 1
    v_mov_b32 v253, 163796
    v_mov_b32 v254, 1
    ds_add_u32 v253, v254
    s_mov_b64 exec, -1
    ds_read_b128 v[156:159], v11 offset:36864
    s_waitcnt lgkmcnt(6)
    v_mfma_f32_32x32x16_bf16 v[212:227], v[132:135], v[20:23], v[212:227]
    v_mul_f32 v180, v180, v228
    v_mul_f32 v181, v181, v229
    v_mul_f32 v182, v182, v230
    v_mul_f32 v183, v183, v231
    ds_read_b128 v[160:163], v11 offset:37888
    v_mfma_f32_32x32x16_bf16 v[212:227], v[136:139], v[24:27], v[212:227]
    v_mul_f32 v232, v184, v184
    v_mul_f32 v233, v185, v185
    v_mul_f32 v234, v186, v186
    v_mul_f32 v235, v187, v187
    ds_read_b128 v[132:135], v11 offset:38912
    s_waitcnt lgkmcnt(6)
    v_mfma_f32_32x32x16_bf16 v[212:227], v[140:143], v[28:31], v[212:227]
    v_fma_f32 v232, v232, v8, v7
    v_fma_f32 v233, v233, v8, v7
    v_fma_f32 v234, v234, v8, v7
    v_fma_f32 v235, v235, v8, v7
    ds_read_b128 v[136:139], v11 offset:39936
    v_mfma_f32_32x32x16_bf16 v[212:227], v[144:147], v[32:35], v[212:227]
    v_mul_f32 v232, v184, v232
    v_mul_f32 v233, v185, v233
    v_mul_f32 v234, v186, v234
    v_mul_f32 v235, v187, v235
    ds_read_b128 v[140:143], v11 offset:40960
    s_waitcnt lgkmcnt(6)
    v_mfma_f32_32x32x16_bf16 v[212:227], v[148:151], v[36:39], v[212:227]
    v_exp_f32 v232, v232
    v_mul_f32 v184, v184, v192
    v_exp_f32 v233, v233
    ds_read_b128 v[144:147], v11 offset:41984
    v_mfma_f32_32x32x16_bf16 v[212:227], v[152:155], v[40:43], v[212:227]
    v_mul_f32 v185, v185, v193
    v_exp_f32 v234, v234
    v_mul_f32 v186, v186, v194
    ds_read_b128 v[148:151], v11 offset:43008
    s_waitcnt lgkmcnt(5)
    v_mfma_f32_32x32x16_bf16 v[212:227], v[156:159], v[44:47], v[212:227]
    v_exp_f32 v235, v235
    v_mul_f32 v187, v187, v195
    v_fma_f32 v232, v232, v9, v9
    ds_read_b128 v[152:155], v11 offset:44032
    v_mfma_f32_32x32x16_bf16 v[212:227], v[160:163], v[48:51], v[212:227]
    v_fma_f32 v233, v233, v9, v9
    v_fma_f32 v234, v234, v9, v9
    v_fma_f32 v235, v235, v9, v9
    v_rcp_f32 v232, v232
    ds_read_b128 v[156:159], v11 offset:45056
    s_waitcnt lgkmcnt(5)
    v_mfma_f32_32x32x16_bf16 v[212:227], v[132:135], v[52:55], v[212:227]
    v_rcp_f32 v233, v233
    v_rcp_f32 v234, v234
    ds_read_b128 v[160:163], v11 offset:46080
    v_mfma_f32_32x32x16_bf16 v[212:227], v[136:139], v[56:59], v[212:227]
    v_rcp_f32 v235, v235
    v_mul_f32 v184, v184, v232
    v_mul_f32 v185, v185, v233
    ds_read_b128 v[132:135], v11 offset:47104
    s_waitcnt lgkmcnt(5)
    v_mfma_f32_32x32x16_bf16 v[212:227], v[140:143], v[60:63], v[212:227]
    v_mul_f32 v186, v186, v234
    v_mul_f32 v187, v187, v235
    v_cvt_pk_bf16_f32 v240, v180, v181
    v_cvt_pk_bf16_f32 v241, v182, v183
    ds_read_b128 v[136:139], v11 offset:48128
    v_mfma_f32_32x32x16_bf16 v[212:227], v[144:147], v[64:67], v[212:227]
    v_cvt_pk_bf16_f32 v242, v184, v185
    v_cvt_pk_bf16_f32 v243, v186, v187
    buffer_store_dwordx4 v[240:243], v1, s[8:11], s44 offen offset:1024 sc1
    v_mul_f32 v228, v196, v196
    ds_read_b128 v[140:143], v11 offset:49152
    s_waitcnt lgkmcnt(5)
    v_mfma_f32_32x32x16_bf16 v[212:227], v[148:151], v[68:71], v[212:227]
    v_mul_f32 v229, v197, v197
    v_mul_f32 v230, v198, v198
    v_mul_f32 v231, v199, v199
    v_fma_f32 v228, v228, v8, v7
    ds_read_b128 v[144:147], v11 offset:50176
    v_mfma_f32_32x32x16_bf16 v[212:227], v[152:155], v[72:75], v[212:227]
    v_fma_f32 v229, v229, v8, v7
    v_fma_f32 v230, v230, v8, v7
    v_fma_f32 v231, v231, v8, v7
    v_mul_f32 v228, v196, v228
    ds_read_b128 v[148:151], v11 offset:51200
    s_waitcnt lgkmcnt(5)
    v_mfma_f32_32x32x16_bf16 v[212:227], v[156:159], v[76:79], v[212:227]
    v_mul_f32 v229, v197, v229
    v_mul_f32 v230, v198, v230
    v_mul_f32 v231, v199, v231
    v_exp_f32 v228, v228
    ds_read_b128 v[152:155], v11 offset:52224
    v_mfma_f32_32x32x16_bf16 v[212:227], v[160:163], v[80:83], v[212:227]
    v_mul_f32 v196, v196, v204
    v_exp_f32 v229, v229
    v_mul_f32 v197, v197, v205
    ds_read_b128 v[156:159], v11 offset:53248
    s_waitcnt lgkmcnt(5)
    v_mfma_f32_32x32x16_bf16 v[212:227], v[132:135], v[84:87], v[212:227]
    v_exp_f32 v230, v230
    v_mul_f32 v198, v198, v206
    v_exp_f32 v231, v231
    ds_read_b128 v[160:163], v11 offset:54272
    v_mfma_f32_32x32x16_bf16 v[212:227], v[136:139], v[88:91], v[212:227]
    v_mul_f32 v199, v199, v207
    v_fma_f32 v228, v228, v9, v9
    v_fma_f32 v229, v229, v9, v9
    v_fma_f32 v230, v230, v9, v9
    ds_read_b128 v[132:135], v11 offset:55296
    s_waitcnt lgkmcnt(5)
    v_mfma_f32_32x32x16_bf16 v[212:227], v[140:143], v[92:95], v[212:227]
    v_fma_f32 v231, v231, v9, v9
    v_rcp_f32 v228, v228
    v_rcp_f32 v229, v229
    ds_read_b128 v[136:139], v11 offset:56320
    v_mfma_f32_32x32x16_bf16 v[212:227], v[144:147], v[96:99], v[212:227]
    v_rcp_f32 v230, v230
    v_rcp_f32 v231, v231
    ds_read_b128 v[140:143], v11 offset:57344
    s_waitcnt lgkmcnt(5)
    v_mfma_f32_32x32x16_bf16 v[212:227], v[148:151], v[100:103], v[212:227]
    v_mul_f32 v196, v196, v228
    v_mul_f32 v197, v197, v229
    v_mul_f32 v198, v198, v230
    v_mul_f32 v199, v199, v231
    ds_read_b128 v[144:147], v11 offset:58368
    v_mfma_f32_32x32x16_bf16 v[212:227], v[152:155], v[104:107], v[212:227]
    v_mul_f32 v232, v200, v200
    v_mul_f32 v233, v201, v201
    v_mul_f32 v234, v202, v202
    v_mul_f32 v235, v203, v203
    ds_read_b128 v[148:151], v12 offset:0
    s_waitcnt lgkmcnt(5)
    v_mfma_f32_32x32x16_bf16 v[212:227], v[156:159], v[108:111], v[212:227]
    v_fma_f32 v232, v232, v8, v7
    v_fma_f32 v233, v233, v8, v7
    v_fma_f32 v234, v234, v8, v7
    v_fma_f32 v235, v235, v8, v7
    ds_read_b128 v[152:155], v12 offset:1024
    v_mfma_f32_32x32x16_bf16 v[212:227], v[160:163], v[112:115], v[212:227]
    v_mul_f32 v232, v200, v232
    v_mul_f32 v233, v201, v233
    v_mul_f32 v234, v202, v234
    v_mul_f32 v235, v203, v235
    ds_read_b128 v[156:159], v12 offset:2048
    s_waitcnt lgkmcnt(5)
    v_mfma_f32_32x32x16_bf16 v[212:227], v[132:135], v[116:119], v[212:227]
    v_exp_f32 v232, v232
    v_mul_f32 v200, v200, v208
    v_exp_f32 v233, v233
    ds_read_b128 v[160:163], v12 offset:3072
    v_mfma_f32_32x32x16_bf16 v[212:227], v[136:139], v[120:123], v[212:227]
    v_mul_f32 v201, v201, v209
    v_exp_f32 v234, v234
    v_mul_f32 v202, v202, v210
    ds_read_b128 v[132:135], v12 offset:4096
    s_waitcnt lgkmcnt(5)
    v_mfma_f32_32x32x16_bf16 v[212:227], v[140:143], v[124:127], v[212:227]
    v_exp_f32 v235, v235
    v_mul_f32 v203, v203, v211
    v_fma_f32 v232, v232, v9, v9
    ds_read_b128 v[136:139], v12 offset:5120
    v_mfma_f32_32x32x16_bf16 v[212:227], v[144:147], v[128:131], v[212:227]
    v_fma_f32 v233, v233, v9, v9
    v_fma_f32 v234, v234, v9, v9
    v_fma_f32 v235, v235, v9, v9
    v_rcp_f32 v232, v232
    ds_read_b128 v[140:143], v12 offset:6144
    s_waitcnt lgkmcnt(5)
    v_mfma_f32_32x32x16_bf16 v[164:179], v[148:151], v[16:19], 0
    v_rcp_f32 v233, v233
    v_rcp_f32 v234, v234
    s_mov_b64 exec, 1
    v_mov_b32 v253, 163796
    v_mov_b32 v254, 1
    ds_add_u32 v253, v254
    s_mov_b64 exec, -1
    ds_read_b128 v[144:147], v12 offset:7168
    v_mfma_f32_32x32x16_bf16 v[164:179], v[152:155], v[20:23], v[164:179]
    v_rcp_f32 v235, v235
    v_mul_f32 v200, v200, v232
    v_mul_f32 v201, v201, v233
    ds_read_b128 v[148:151], v12 offset:8192
    s_waitcnt lgkmcnt(6)
    v_mfma_f32_32x32x16_bf16 v[164:179], v[156:159], v[24:27], v[164:179]
    v_mul_f32 v202, v202, v234
    v_mul_f32 v203, v203, v235
    v_cvt_pk_bf16_f32 v236, v196, v197
    v_cvt_pk_bf16_f32 v237, v198, v199
    ds_read_b128 v[152:155], v12 offset:9216
    v_mfma_f32_32x32x16_bf16 v[164:179], v[160:163], v[28:31], v[164:179]
    v_cvt_pk_bf16_f32 v238, v200, v201
    v_cvt_pk_bf16_f32 v239, v202, v203
    buffer_store_dwordx4 v[236:239], v1, s[8:11], s44 offen offset:2048 sc1
    v_mul_f32 v228, v212, v212
    ds_read_b128 v[156:159], v12 offset:10240
    s_waitcnt lgkmcnt(6)
    v_mfma_f32_32x32x16_bf16 v[164:179], v[132:135], v[32:35], v[164:179]
    v_mul_f32 v229, v213, v213
    v_mul_f32 v230, v214, v214
    v_mul_f32 v231, v215, v215
    v_fma_f32 v228, v228, v8, v7
    ds_read_b128 v[160:163], v12 offset:11264
    v_mfma_f32_32x32x16_bf16 v[164:179], v[136:139], v[36:39], v[164:179]
    v_fma_f32 v229, v229, v8, v7
    v_fma_f32 v230, v230, v8, v7
    v_fma_f32 v231, v231, v8, v7
    v_mul_f32 v228, v212, v228
    ds_read_b128 v[132:135], v12 offset:12288
    s_waitcnt lgkmcnt(5)
    v_mfma_f32_32x32x16_bf16 v[164:179], v[140:143], v[40:43], v[164:179]
    v_mul_f32 v229, v213, v229
    v_mul_f32 v230, v214, v230
    v_mul_f32 v231, v215, v231
    v_exp_f32 v228, v228
    ds_read_b128 v[136:139], v12 offset:13312
    v_mfma_f32_32x32x16_bf16 v[164:179], v[144:147], v[44:47], v[164:179]
    v_mul_f32 v212, v212, v220
    v_exp_f32 v229, v229
    v_mul_f32 v213, v213, v221
    ds_read_b128 v[140:143], v12 offset:14336
    s_waitcnt lgkmcnt(5)
    v_mfma_f32_32x32x16_bf16 v[164:179], v[148:151], v[48:51], v[164:179]
    v_exp_f32 v230, v230
    v_mul_f32 v214, v214, v222
    v_exp_f32 v231, v231
    ds_read_b128 v[144:147], v12 offset:15360
    v_mfma_f32_32x32x16_bf16 v[164:179], v[152:155], v[52:55], v[164:179]
    v_mul_f32 v215, v215, v223
    v_fma_f32 v228, v228, v9, v9
    v_fma_f32 v229, v229, v9, v9
    v_fma_f32 v230, v230, v9, v9
    ds_read_b128 v[148:151], v12 offset:16384
    s_waitcnt lgkmcnt(5)
    v_mfma_f32_32x32x16_bf16 v[164:179], v[156:159], v[56:59], v[164:179]
    v_fma_f32 v231, v231, v9, v9
    v_rcp_f32 v228, v228
    v_rcp_f32 v229, v229
    ds_read_b128 v[152:155], v12 offset:17408
    v_mfma_f32_32x32x16_bf16 v[164:179], v[160:163], v[60:63], v[164:179]
    v_rcp_f32 v230, v230
    v_rcp_f32 v231, v231
    ds_read_b128 v[156:159], v12 offset:18432
    s_waitcnt lgkmcnt(5)
    v_mfma_f32_32x32x16_bf16 v[164:179], v[132:135], v[64:67], v[164:179]
    v_mul_f32 v212, v212, v228
    v_mul_f32 v213, v213, v229
    v_mul_f32 v214, v214, v230
    v_mul_f32 v215, v215, v231
    ds_read_b128 v[160:163], v12 offset:19456
    v_mfma_f32_32x32x16_bf16 v[164:179], v[136:139], v[68:71], v[164:179]
    v_mul_f32 v232, v216, v216
    v_mul_f32 v233, v217, v217
    v_mul_f32 v234, v218, v218
    v_mul_f32 v235, v219, v219
    ds_read_b128 v[132:135], v12 offset:20480
    s_waitcnt lgkmcnt(5)
    v_mfma_f32_32x32x16_bf16 v[164:179], v[140:143], v[72:75], v[164:179]
    v_fma_f32 v232, v232, v8, v7
    v_fma_f32 v233, v233, v8, v7
    v_fma_f32 v234, v234, v8, v7
    v_fma_f32 v235, v235, v8, v7
    ds_read_b128 v[136:139], v12 offset:21504
    v_mfma_f32_32x32x16_bf16 v[164:179], v[144:147], v[76:79], v[164:179]
    v_mul_f32 v232, v216, v232
    v_mul_f32 v233, v217, v233
    v_mul_f32 v234, v218, v234
    v_mul_f32 v235, v219, v235
    ds_read_b128 v[140:143], v12 offset:22528
    s_waitcnt lgkmcnt(5)
    v_mfma_f32_32x32x16_bf16 v[164:179], v[148:151], v[80:83], v[164:179]
    v_exp_f32 v232, v232
    v_mul_f32 v216, v216, v224
    v_exp_f32 v233, v233
    ds_read_b128 v[144:147], v12 offset:23552
    v_mfma_f32_32x32x16_bf16 v[164:179], v[152:155], v[84:87], v[164:179]
    v_mul_f32 v217, v217, v225
    v_exp_f32 v234, v234
    v_mul_f32 v218, v218, v226
    ds_read_b128 v[148:151], v12 offset:24576
    s_waitcnt lgkmcnt(5)
    v_mfma_f32_32x32x16_bf16 v[164:179], v[156:159], v[88:91], v[164:179]
    v_exp_f32 v235, v235
    v_mul_f32 v219, v219, v227
    v_fma_f32 v232, v232, v9, v9
    ds_read_b128 v[152:155], v12 offset:25600
    v_mfma_f32_32x32x16_bf16 v[164:179], v[160:163], v[92:95], v[164:179]
    v_fma_f32 v233, v233, v9, v9
    v_fma_f32 v234, v234, v9, v9
    v_fma_f32 v235, v235, v9, v9
    v_rcp_f32 v232, v232
    ds_read_b128 v[156:159], v12 offset:26624
    s_waitcnt lgkmcnt(5)
    v_mfma_f32_32x32x16_bf16 v[164:179], v[132:135], v[96:99], v[164:179]
    v_rcp_f32 v233, v233
    v_rcp_f32 v234, v234
    ds_read_b128 v[160:163], v12 offset:27648
    v_mfma_f32_32x32x16_bf16 v[164:179], v[136:139], v[100:103], v[164:179]
    v_rcp_f32 v235, v235
    v_mul_f32 v216, v216, v232
    v_mul_f32 v217, v217, v233
    ds_read_b128 v[132:135], v12 offset:28672
    s_waitcnt lgkmcnt(5)
    v_mfma_f32_32x32x16_bf16 v[164:179], v[140:143], v[104:107], v[164:179]
    v_mul_f32 v218, v218, v234
    v_mul_f32 v219, v219, v235
    v_cvt_pk_bf16_f32 v240, v212, v213
    v_cvt_pk_bf16_f32 v241, v214, v215
    v_mov_b32 v253, 163800
mega_kernel_c_lw34:
    ds_read_b32 v254, v253
    s_waitcnt lgkmcnt(0)
    v_readfirstlane_b32 s62, v254
    s_nop 1
    s_cmp_ge_u32 s62, 4
    s_cbranch_scc1 mega_kernel_c_lwd35
    s_sleep 1
    s_sub_u32 s25, s25, 1
    s_cbranch_scc0 mega_kernel_c_lw34
    s_mov_b32 s25, 0
mega_kernel_c_lwd35:
    ds_read_b128 v[136:139], v10 offset:0
    v_mfma_f32_32x32x16_bf16 v[164:179], v[144:147], v[108:111], v[164:179]
    v_cvt_pk_bf16_f32 v242, v216, v217
    v_cvt_pk_bf16_f32 v243, v218, v219
    buffer_store_dwordx4 v[240:243], v1, s[8:11], s44 offen offset:3072 sc1
    ds_read_b128 v[140:143], v10 offset:1024
    v_mfma_f32_32x32x16_bf16 v[164:179], v[148:151], v[112:115], v[164:179]
    ds_read_b128 v[144:147], v10 offset:2048
    v_mfma_f32_32x32x16_bf16 v[164:179], v[152:155], v[116:119], v[164:179]
    ds_read_b128 v[148:151], v10 offset:3072
    v_mfma_f32_32x32x16_bf16 v[164:179], v[156:159], v[120:123], v[164:179]
    ds_read_b128 v[152:155], v10 offset:4096
    v_mfma_f32_32x32x16_bf16 v[164:179], v[160:163], v[124:127], v[164:179]
    ds_read_b128 v[156:159], v10 offset:5120
    s_waitcnt lgkmcnt(5)
    v_mfma_f32_32x32x16_bf16 v[164:179], v[132:135], v[128:131], v[164:179]
    ds_read_b128 v[160:163], v10 offset:6144
    v_mfma_f32_32x32x16_bf16 v[180:195], v[136:139], v[16:19], 0
    s_mov_b64 exec, 1
    v_mov_b32 v253, 163796
    v_mov_b32 v254, 1
    ds_add_u32 v253, v254
    s_mov_b64 exec, -1
    ds_read_b128 v[132:135], v10 offset:7168
    s_waitcnt lgkmcnt(6)
    v_mfma_f32_32x32x16_bf16 v[180:195], v[140:143], v[20:23], v[180:195]
    s_nop 1
    v_mul_f32 v228, v164, v164
    v_mul_f32 v229, v165, v165
    v_mul_f32 v230, v166, v166
    v_mul_f32 v231, v167, v167
    ds_read_b128 v[136:139], v10 offset:8192
    v_mfma_f32_32x32x16_bf16 v[180:195], v[144:147], v[24:27], v[180:195]
    v_fma_f32 v228, v228, v8, v7
    v_fma_f32 v229, v229, v8, v7
    v_fma_f32 v230, v230, v8, v7
    v_fma_f32 v231, v231, v8, v7
    ds_read_b128 v[140:143], v10 offset:9216
    s_waitcnt lgkmcnt(6)
    v_mfma_f32_32x32x16_bf16 v[180:195], v[148:151], v[28:31], v[180:195]
    v_mul_f32 v228, v164, v228
    v_mul_f32 v229, v165, v229
    v_mul_f32 v230, v166, v230
    v_mul_f32 v231, v167, v231
    ds_read_b128 v[144:147], v10 offset:10240
    v_mfma_f32_32x32x16_bf16 v[180:195], v[152:155], v[32:35], v[180:195]
    v_exp_f32 v228, v228
    v_mul_f32 v164, v164, v172
    v_exp_f32 v229, v229
    ds_read_b128 v[148:151], v10 offset:11264
    s_waitcnt lgkmcnt(6)
    v_mfma_f32_32x32x16_bf16 v[180:195], v[156:159], v[36:39], v[180:195]
    v_mul_f32 v165, v165, v173
    v_exp_f32 v230, v230
    v_mul_f32 v166, v166, v174
    ds_read_b128 v[152:155], v10 offset:12288
    v_mfma_f32_32x32x16_bf16 v[180:195], v[160:163], v[40:43], v[180:195]
    v_exp_f32 v231, v231
    v_mul_f32 v167, v167, v175
    v_fma_f32 v228, v228, v9, v9
    ds_read_b128 v[156:159], v10 offset:13312
    s_waitcnt lgkmcnt(5)
    v_mfma_f32_32x32x16_bf16 v[180:195], v[132:135], v[44:47], v[180:195]
    v_fma_f32 v229, v229, v9, v9
    v_fma_f32 v230, v230, v9, v9
    v_fma_f32 v231, v231, v9, v9
    v_rcp_f32 v228, v228
    ds_read_b128 v[160:163], v10 offset:14336
    v_mfma_f32_32x32x16_bf16 v[180:195], v[136:139], v[48:51], v[180:195]
    v_rcp_f32 v229, v229
    v_rcp_f32 v230, v230
    ds_read_b128 v[132:135], v10 offset:15360
    s_waitcnt lgkmcnt(5)
    v_mfma_f32_32x32x16_bf16 v[180:195], v[140:143], v[52:55], v[180:195]
    v_rcp_f32 v231, v231
    v_mul_f32 v164, v164, v228
    v_mul_f32 v165, v165, v229
    ds_read_b128 v[136:139], v10 offset:16384
    v_mfma_f32_32x32x16_bf16 v[180:195], v[144:147], v[56:59], v[180:195]
    v_mul_f32 v166, v166, v230
    v_mul_f32 v167, v167, v231
    v_mul_f32 v232, v168, v168
    v_mul_f32 v233, v169, v169
    ds_read_b128 v[140:143], v10 offset:17408
    s_waitcnt lgkmcnt(5)
    v_mfma_f32_32x32x16_bf16 v[180:195], v[148:151], v[60:63], v[180:195]
    v_mul_f32 v234, v170, v170
    v_mul_f32 v235, v171, v171
    v_fma_f32 v232, v232, v8, v7
    v_fma_f32 v233, v233, v8, v7
    ds_read_b128 v[144:147], v10 offset:18432
    v_mfma_f32_32x32x16_bf16 v[180:195], v[152:155], v[64:67], v[180:195]
    v_fma_f32 v234, v234, v8, v7
    v_fma_f32 v235, v235, v8, v7
    v_mul_f32 v232, v168, v232
    v_mul_f32 v233, v169, v233
    ds_read_b128 v[148:151], v10 offset:19456
    s_waitcnt lgkmcnt(5)
    v_mfma_f32_32x32x16_bf16 v[180:195], v[156:159], v[68:71], v[180:195]
    v_mul_f32 v234, v170, v234
    v_mul_f32 v235, v171, v235
    v_exp_f32 v232, v232
    ds_read_b128 v[152:155], v10 offset:20480
    v_mfma_f32_32x32x16_bf16 v[180:195], v[160:163], v[72:75], v[180:195]
    v_mul_f32 v168, v168, v176
    v_exp_f32 v233, v233
    v_mul_f32 v169, v169, v177
    ds_read_b128 v[156:159], v10 offset:21504
    s_waitcnt lgkmcnt(5)
    v_mfma_f32_32x32x16_bf16 v[180:195], v[132:135], v[76:79], v[180:195]
    v_exp_f32 v234, v234
    v_mul_f32 v170, v170, v178
    v_exp_f32 v235, v235
    ds_read_b128 v[160:163], v10 offset:22528
    v_mfma_f32_32x32x16_bf16 v[180:195], v[136:139], v[80:83], v[180:195]
    v_mul_f32 v171, v171, v179
    v_fma_f32 v232, v232, v9, v9
    v_fma_f32 v233, v233, v9, v9
    v_fma_f32 v234, v234, v9, v9
    ds_read_b128 v[132:135], v10 offset:23552
    s_waitcnt lgkmcnt(5)
    v_mfma_f32_32x32x16_bf16 v[180:195], v[140:143], v[84:87], v[180:195]
    v_fma_f32 v235, v235, v9, v9
    v_rcp_f32 v232, v232
    v_rcp_f32 v233, v233
    ds_read_b128 v[136:139], v10 offset:24576
    v_mfma_f32_32x32x16_bf16 v[180:195], v[144:147], v[88:91], v[180:195]
    v_rcp_f32 v234, v234
    v_rcp_f32 v235, v235
    ds_read_b128 v[140:143], v10 offset:25600
    s_waitcnt lgkmcnt(5)
    v_mfma_f32_32x32x16_bf16 v[180:195], v[148:151], v[92:95], v[180:195]
    v_mul_f32 v168, v168, v232
    v_mul_f32 v169, v169, v233
    v_mul_f32 v170, v170, v234
    v_mul_f32 v171, v171, v235
    ds_read_b128 v[144:147], v10 offset:26624
    v_mfma_f32_32x32x16_bf16 v[180:195], v[152:155], v[96:99], v[180:195]
    v_cvt_pk_bf16_f32 v236, v164, v165
    v_cvt_pk_bf16_f32 v237, v166, v167
    v_cvt_pk_bf16_f32 v238, v168, v169
    v_cvt_pk_bf16_f32 v239, v170, v171
    ds_read_b128 v[148:151], v10 offset:27648
    s_waitcnt lgkmcnt(5)
    v_mfma_f32_32x32x16_bf16 v[180:195], v[156:159], v[100:103], v[180:195]
    buffer_store_dwordx4 v[236:239], v1, s[8:11], s45 offen offset:0 sc1
    v_mul_u32_u24 v255, 256, v0
    v_mov_b32 v254, 1
    v_mov_b32 v253, 163776
    s_waitcnt vmcnt(1)
    s_mov_b64 exec, 1
    ds_add_rtn_u32 v253, v253, v254
    s_waitcnt lgkmcnt(0)
    v_readfirstlane_b32 s62, v253
    s_mov_b64 exec, 16383
    s_and_b32 s62, s62, 3
    s_cmp_lg_u32 s62, 3
    s_cbranch_scc1 mega_kernel_c_sig36
    buffer_store_dword v254, v255, s[8:11], s47 offen sc1
mega_kernel_c_sig36:
    s_mov_b64 exec, -1
    ds_read_b128 v[152:155], v10 offset:28672
    v_mfma_f32_32x32x16_bf16 v[180:195], v[160:163], v[104:107], v[180:195]
    ds_read_b128 v[156:159], v10 offset:29696
    v_mfma_f32_32x32x16_bf16 v[180:195], v[132:135], v[108:111], v[180:195]
    ds_read_b128 v[160:163], v10 offset:30720
    v_mfma_f32_32x32x16_bf16 v[180:195], v[136:139], v[112:115], v[180:195]
    ds_read_b128 v[132:135], v10 offset:31744
    v_mfma_f32_32x32x16_bf16 v[180:195], v[140:143], v[116:119], v[180:195]
    ds_read_b128 v[136:139], v10 offset:32768
    v_mfma_f32_32x32x16_bf16 v[180:195], v[144:147], v[120:123], v[180:195]
    ds_read_b128 v[140:143], v10 offset:33792
    s_waitcnt lgkmcnt(5)
    v_mfma_f32_32x32x16_bf16 v[180:195], v[148:151], v[124:127], v[180:195]
    ds_read_b128 v[144:147], v10 offset:34816
    v_mfma_f32_32x32x16_bf16 v[180:195], v[152:155], v[128:131], v[180:195]
    ds_read_b128 v[148:151], v10 offset:35840
    s_waitcnt lgkmcnt(5)
    v_mfma_f32_32x32x16_bf16 v[196:211], v[156:159], v[16:19], 0
    ds_read_b128 v[152:155], v10 offset:36864
    v_mfma_f32_32x32x16_bf16 v[196:211], v[160:163], v[20:23], v[196:211]
    s_nop 6
    v_mul_f32 v228, v180, v180
    v_mul_f32 v229, v181, v181
    v_mul_f32 v230, v182, v182
    v_mul_f32 v231, v183, v183
    ds_read_b128 v[156:159], v10 offset:37888
    s_waitcnt lgkmcnt(5)
    v_mfma_f32_32x32x16_bf16 v[196:211], v[132:135], v[24:27], v[196:211]
    v_fma_f32 v228, v228, v8, v7
    v_fma_f32 v229, v229, v8, v7
    v_fma_f32 v230, v230, v8, v7
    v_fma_f32 v231, v231, v8, v7
    ds_read_b128 v[160:163], v10 offset:38912
    v_mfma_f32_32x32x16_bf16 v[196:211], v[136:139], v[28:31], v[196:211]
    v_mul_f32 v228, v180, v228
    v_mul_f32 v229, v181, v229
    v_mul_f32 v230, v182, v230
    v_mul_f32 v231, v183, v231
    ds_read_b128 v[132:135], v10 offset:39936
    s_waitcnt lgkmcnt(5)
    v_mfma_f32_32x32x16_bf16 v[196:211], v[140:143], v[32:35], v[196:211]
    v_exp_f32 v228, v228
    v_mul_f32 v180, v180, v188
    v_exp_f32 v229, v229
    ds_read_b128 v[136:139], v10 offset:40960
    v_mfma_f32_32x32x16_bf16 v[196:211], v[144:147], v[36:39], v[196:211]
    v_mul_f32 v181, v181, v189
    v_exp_f32 v230, v230
    v_mul_f32 v182, v182, v190
    ds_read_b128 v[140:143], v10 offset:41984
    s_waitcnt lgkmcnt(5)
    v_mfma_f32_32x32x16_bf16 v[196:211], v[148:151], v[40:43], v[196:211]
    v_exp_f32 v231, v231
    v_mul_f32 v183, v183, v191
    v_fma_f32 v228, v228, v9, v9
    ds_read_b128 v[144:147], v10 offset:43008
    v_mfma_f32_32x32x16_bf16 v[196:211], v[152:155], v[44:47], v[196:211]
    v_fma_f32 v229, v229, v9, v9
    v_fma_f32 v230, v230, v9, v9
    v_fma_f32 v231, v231, v9, v9
    v_rcp_f32 v228, v228
    ds_read_b128 v[148:151], v10 offset:44032
    s_waitcnt lgkmcnt(5)
    v_mfma_f32_32x32x16_bf16 v[196:211], v[156:159], v[48:51], v[196:211]
    v_rcp_f32 v229, v229
    v_rcp_f32 v230, v230
    ds_read_b128 v[152:155], v10 offset:45056
    v_mfma_f32_32x32x16_bf16 v[196:211], v[160:163], v[52:55], v[196:211]
    v_rcp_f32 v231, v231
    v_mul_f32 v180, v180, v228
    v_mul_f32 v181, v181, v229
    ds_read_b128 v[156:159], v10 offset:46080
    s_waitcnt lgkmcnt(5)
    v_mfma_f32_32x32x16_bf16 v[196:211], v[132:135], v[56:59], v[196:211]
    v_mul_f32 v182, v182, v230
    v_mul_f32 v183, v183, v231
    v_mul_f32 v232, v184, v184
    v_mul_f32 v233, v185, v185
    ds_read_b128 v[160:163], v10 offset:47104
    v_mfma_f32_32x32x16_bf16 v[196:211], v[136:139], v[60:63], v[196:211]
    v_mul_f32 v234, v186, v186
    v_mul_f32 v235, v187, v187
    v_fma_f32 v232, v232, v8, v7
    v_fma_f32 v233, v233, v8, v7
    ds_read_b128 v[132:135], v10 offset:48128
    s_waitcnt lgkmcnt(5)
    v_mfma_f32_32x32x16_bf16 v[196:211], v[140:143], v[64:67], v[196:211]
    v_fma_f32 v234, v234, v8, v7
    v_fma_f32 v235, v235, v8, v7
    v_mul_f32 v232, v184, v232
    v_mul_f32 v233, v185, v233
    ds_read_b128 v[136:139], v10 offset:49152
    v_mfma_f32_32x32x16_bf16 v[196:211], v[144:147], v[68:71], v[196:211]
    v_mul_f32 v234, v186, v234
    v_mul_f32 v235, v187, v235
    v_exp_f32 v232, v232
    s_lshl_b32 s49, s56, 8
    s_add_u32 s49, s49, 70500352
    s_cmp_lg_u32 s12, 0
    s_cbranch_scc1 mega_kernel_c_w037
    buffer_load_dword v252, v2, s[8:11], s49 offen sc1
mega_kernel_c_w037:
    ds_read_b128 v[140:143], v10 offset:50176
    s_waitcnt lgkmcnt(5)
    v_mfma_f32_32x32x16_bf16 v[196:211], v[148:151], v[72:75], v[196:211]
    v_mul_f32 v184, v184, v192
    v_exp_f32 v233, v233
    v_mul_f32 v185, v185, v193
    ds_read_b128 v[144:147], v10 offset:51200
    v_mfma_f32_32x32x16_bf16 v[196:211], v[152:155], v[76:79], v[196:211]
    v_exp_f32 v234, v234
    v_mul_f32 v186, v186, v194
    v_exp_f32 v235, v235
    ds_read_b128 v[148:151], v10 offset:52224
    s_waitcnt lgkmcnt(5)
    v_mfma_f32_32x32x16_bf16 v[196:211], v[156:159], v[80:83], v[196:211]
    v_mul_f32 v187, v187, v195
    v_fma_f32 v232, v232, v9, v9
    v_fma_f32 v233, v233, v9, v9
    v_fma_f32 v234, v234, v9, v9
    ds_read_b128 v[152:155], v10 offset:53248
    v_mfma_f32_32x32x16_bf16 v[196:211], v[160:163], v[84:87], v[196:211]
    v_fma_f32 v235, v235, v9, v9
    v_rcp_f32 v232, v232
    v_rcp_f32 v233, v233
    ds_read_b128 v[156:159], v10 offset:54272
    s_waitcnt lgkmcnt(5)
    v_mfma_f32_32x32x16_bf16 v[196:211], v[132:135], v[88:91], v[196:211]
    v_rcp_f32 v234, v234
    v_rcp_f32 v235, v235
    ds_read_b128 v[160:163], v10 offset:55296
    v_mfma_f32_32x32x16_bf16 v[196:211], v[136:139], v[92:95], v[196:211]
    v_mul_f32 v184, v184, v232
    v_mul_f32 v185, v185, v233
    v_mul_f32 v186, v186, v234
    v_mul_f32 v187, v187, v235
    ds_read_b128 v[132:135], v10 offset:56320
    s_waitcnt lgkmcnt(5)
    v_mfma_f32_32x32x16_bf16 v[196:211], v[140:143], v[96:99], v[196:211]
    v_cvt_pk_bf16_f32 v240, v180, v181
    v_cvt_pk_bf16_f32 v241, v182, v183
    v_cvt_pk_bf16_f32 v242, v184, v185
    v_cvt_pk_bf16_f32 v243, v186, v187
    ds_read_b128 v[136:139], v10 offset:57344
    v_mfma_f32_32x32x16_bf16 v[196:211], v[144:147], v[100:103], v[196:211]
    buffer_store_dwordx4 v[240:243], v1, s[8:11], s45 offen offset:1024 sc1
    ds_read_b128 v[140:143], v10 offset:58368
    s_waitcnt lgkmcnt(5)
    v_mfma_f32_32x32x16_bf16 v[196:211], v[148:151], v[104:107], v[196:211]
    v_mfma_f32_32x32x16_bf16 v[196:211], v[152:155], v[108:111], v[196:211]
    s_waitcnt lgkmcnt(3)
    v_mfma_f32_32x32x16_bf16 v[196:211], v[156:159], v[112:115], v[196:211]
    v_mfma_f32_32x32x16_bf16 v[196:211], v[160:163], v[116:119], v[196:211]
    s_waitcnt lgkmcnt(1)
    v_mfma_f32_32x32x16_bf16 v[196:211], v[132:135], v[120:123], v[196:211]
    v_mfma_f32_32x32x16_bf16 v[196:211], v[136:139], v[124:127], v[196:211]
    s_waitcnt lgkmcnt(0)
    v_mfma_f32_32x32x16_bf16 v[196:211], v[140:143], v[128:131], v[196:211]
    s_mov_b64 exec, 1
    v_mov_b32 v253, 163796
    v_mov_b32 v254, 1
    ds_add_u32 v253, v254
    s_mov_b64 exec, -1
    s_nop 6
    v_pk_mul_f32 v[228:229], v[196:197], v[196:197]
    v_pk_mul_f32 v[230:231], v[198:199], v[198:199]
    v_pk_fma_f32 v[228:229], v[228:229], v[8:9], v[14:15] op_sel_hi:[1,0,0]
    v_pk_fma_f32 v[230:231], v[230:231], v[8:9], v[14:15] op_sel_hi:[1,0,0]
    v_pk_mul_f32 v[228:229], v[196:197], v[228:229]
    v_pk_mul_f32 v[230:231], v[198:199], v[230:231]
    v_exp_f32 v228, v228
    v_pk_mul_f32 v[196:197], v[196:197], v[204:205]
    v_exp_f32 v229, v229
    v_exp_f32 v230, v230
    v_pk_mul_f32 v[198:199], v[198:199], v[206:207]
    v_exp_f32 v231, v231
    v_pk_fma_f32 v[228:229], v[228:229], v[8:9], v[8:9] op_sel:[0,1,1] op_sel_hi:[1,1,1]
    v_pk_fma_f32 v[230:231], v[230:231], v[8:9], v[8:9] op_sel:[0,1,1] op_sel_hi:[1,1,1]
    v_rcp_f32 v228, v228
    v_rcp_f32 v229, v229
    v_rcp_f32 v230, v230
    v_rcp_f32 v231, v231
    v_pk_mul_f32 v[196:197], v[196:197], v[228:229]
    v_pk_mul_f32 v[198:199], v[198:199], v[230:231]
    v_pk_mul_f32 v[232:233], v[200:201], v[200:201]
    v_pk_mul_f32 v[234:235], v[202:203], v[202:203]
    v_pk_fma_f32 v[232:233], v[232:233], v[8:9], v[14:15] op_sel_hi:[1,0,0]
    v_pk_fma_f32 v[234:235], v[234:235], v[8:9], v[14:15] op_sel_hi:[1,0,0]
    v_pk_mul_f32 v[232:233], v[200:201], v[232:233]
    v_pk_mul_f32 v[234:235], v[202:203], v[234:235]
    v_exp_f32 v232, v232
    v_pk_mul_f32 v[200:201], v[200:201], v[208:209]
    v_exp_f32 v233, v233
    v_exp_f32 v234, v234
    v_pk_mul_f32 v[202:203], v[202:203], v[210:211]
    v_exp_f32 v235, v235
    v_pk_fma_f32 v[232:233], v[232:233], v[8:9], v[8:9] op_sel:[0,1,1] op_sel_hi:[1,1,1]
    v_pk_fma_f32 v[234:235], v[234:235], v[8:9], v[8:9] op_sel:[0,1,1] op_sel_hi:[1,1,1]
    v_rcp_f32 v232, v232
    v_rcp_f32 v233, v233
    v_rcp_f32 v234, v234
    v_rcp_f32 v235, v235
    v_pk_mul_f32 v[200:201], v[200:201], v[232:233]
    v_pk_mul_f32 v[202:203], v[202:203], v[234:235]
    v_cvt_pk_bf16_f32 v236, v196, v197
    v_cvt_pk_bf16_f32 v237, v198, v199
    v_cvt_pk_bf16_f32 v238, v200, v201
    v_cvt_pk_bf16_f32 v239, v202, v203
    buffer_store_dwordx4 v[236:239], v1, s[8:11], s45 offen offset:2048 sc1
    v_mul_u32_u24 v255, 256, v0
    v_mov_b32 v254, 1
    v_mov_b32 v253, 163776
    s_waitcnt vmcnt(0)
    s_mov_b64 exec, 1
    ds_add_rtn_u32 v253, v253, v254
    s_waitcnt lgkmcnt(0)
    v_readfirstlane_b32 s62, v253
    s_mov_b64 exec, 16383
    s_and_b32 s62, s62, 3
    s_cmp_lg_u32 s62, 3
    s_cbranch_scc1 mega_kernel_c_sig38
    buffer_store_dword v254, v255, s[8:11], s48 offen sc1
mega_kernel_c_sig38:
    s_mov_b64 exec, -1
    s_cmp_eq_u32 s24, 0
    s_cbranch_scc1 mega_kernel_c_skip39
    s_and_b32 s43, s13, 1
    s_lshr_b32 s44, s13, 1
    s_lshl_b32 s40, s22, 1
    s_add_u32 s40, s40, s43
    s_lshl_b32 s41, s23, 1
    s_add_u32 s41, s41, s44
    s_mul_i32 s42, s40, 28
    s_lshl_b32 s45, s41, 1
    s_add_u32 s42, s42, s45
    s_lshl_b32 s42, s42, 10
    s_add_u32 s45, s42, 12582912
    buffer_load_dwordx4 v[48:51], v1, s[8:11], s45 offen offset:0 sc1
    buffer_load_dwordx4 v[52:55], v1, s[8:11], s45 offen offset:1024 sc1
    s_mul_i32 s47, s40, 114688
    s_lshl_b32 s45, s44, 11
    s_add_u32 s47, s47, s45
    s_add_u32 s47, s47, 52428800
    s_mul_i32 s48, s44, 4096
    s_add_u32 s48, s48, s45
    s_xor_b32 s49, s44, 1
    s_mul_i32 s49, s49, 4096
    s_add_u32 s49, s49, s45
    v_add_u32 v3, s48, v1
    v_add_u32 v6, s49, v1
    v_add_u32 v4, s48, v1
    v_add_u32 v7, s49, v1
    v_add_u32 v4, 61440, v4
    v_add_u32 v7, 61440, v7
    v_add_u32 v5, s48, v1
    v_add_u32 v8, s49, v1
    v_add_u32 v5, 122880, v5
    v_add_u32 v8, 122880, v8
    s_lshl_b32 s48, s13, 12
    s_add_u32 s48, s48, 0
    v_add_u32 v9, s48, v1
    s_xor_b32 s48, s13, 2
    s_lshl_b32 s48, s48, 12
    s_add_u32 s48, s48, 0
    v_add_u32 v10, s48, v1
    s_waitcnt vmcnt(0)
    v_lshlrev_b32 v16, 16, v48
    v_and_b32 v17, 0xffff0000, v48
    v_lshlrev_b32 v18, 16, v49
    v_and_b32 v19, 0xffff0000, v49
    v_lshlrev_b32 v20, 16, v50
    v_and_b32 v21, 0xffff0000, v50
    v_lshlrev_b32 v22, 16, v51
    v_and_b32 v23, 0xffff0000, v51
    v_lshlrev_b32 v24, 16, v52
    v_and_b32 v25, 0xffff0000, v52
    v_lshlrev_b32 v26, 16, v53
    v_and_b32 v27, 0xffff0000, v53
    v_lshlrev_b32 v28, 16, v54
    v_and_b32 v29, 0xffff0000, v54
    v_lshlrev_b32 v30, 16, v55
    v_and_b32 v31, 0xffff0000, v55
    v_mov_b32 v48, 0x3f803f80
    s_lshl_b32 s46, s56, 8
    s_add_u32 s46, s46, 70500352
    s_cmp_lg_u32 s12, 0
    s_cbranch_scc1 mega_kernel_c_dwo40
    v_cmp_eq_u32 vcc, 0, v252
    s_nop 1
    s_and_b64 vcc, vcc, s[60:61]
    s_cbranch_scc0 mega_kernel_c_mbd43
mega_kernel_c_mbw42:
    buffer_load_dword v252, v2, s[8:11], s46 offen sc1
    s_waitcnt vmcnt(0)
    v_cmp_eq_u32 vcc, 0, v252
    s_nop 1
    s_and_b64 vcc, vcc, s[60:61]
    s_cbranch_scc0 mega_kernel_c_mbd43
    s_sub_u32 s25, s25, 1
    s_cbranch_scc0 mega_kernel_c_mbw42
    s_mov_b32 s25, 0
mega_kernel_c_mbd43:
    s_mov_b64 exec, 1
    v_mov_b32 v253, 163792
    v_mov_b32 v254, 1
    ds_add_u32 v253, v254
    s_mov_b64 exec, -1
    s_branch mega_kernel_c_dwg41
mega_kernel_c_dwo40:
    v_mov_b32 v253, 163792
mega_kernel_c_lw44:
    ds_read_b32 v254, v253
    s_waitcnt lgkmcnt(0)
    v_readfirstlane_b32 s62, v254
    s_nop 1
    s_cmp_ge_u32 s62, 2
    s_cbranch_scc1 mega_kernel_c_lwd45
    s_sleep 1
    s_sub_u32 s25, s25, 1
    s_cbranch_scc0 mega_kernel_c_lw44
    s_mov_b32 s25, 0
mega_kernel_c_lwd45:
mega_kernel_c_dwg41:
    s_waitcnt lgkmcnt(0)
    s_lshl_b32 s46, s56, 8
    s_add_u32 s46, s46, 70582272
    buffer_load_dwordx4 v[96:99], v1, s[8:11], s47 offen offset:0 sc1
    buffer_load_dwordx4 v[100:103], v1, s[8:11], s47 offen offset:1024 sc1
    s_add_u32 s47, s47, 4096
    buffer_load_dwordx4 v[104:107], v1, s[8:11], s47 offen offset:0 sc1
    buffer_load_dwordx4 v[108:111], v1, s[8:11], s47 offen offset:1024 sc1
    s_add_u32 s47, s47, 4096
    buffer_load_dwordx4 v[112:115], v1, s[8:11], s47 offen offset:0 sc1
    buffer_load_dwordx4 v[116:119], v1, s[8:11], s47 offen offset:1024 sc1
    s_add_u32 s47, s47, 4096
    buffer_load_dwordx4 v[120:123], v1, s[8:11], s47 offen offset:0 sc1
    buffer_load_dwordx4 v[124:127], v1, s[8:11], s47 offen offset:1024 sc1
    s_add_u32 s47, s47, 4096
    buffer_load_dwordx4 v[128:131], v1, s[8:11], s47 offen offset:0 sc1
    buffer_load_dwordx4 v[132:135], v1, s[8:11], s47 offen offset:1024 sc1
    s_barrier
    ds_read_b128 v[64:67], v5 offset:26624
    ds_read_b128 v[68:71], v8 offset:26624
    ds_read_b128 v[72:75], v5 offset:27648
    ds_read_b128 v[76:79], v8 offset:27648
    ds_read_b128 v[80:83], v3 offset:59392
    ds_read_b128 v[84:87], v6 offset:59392
    ds_read_b128 v[88:91], v3 offset:60416
    ds_read_b128 v[92:95], v6 offset:60416
    s_waitcnt vmcnt(9)
    s_waitcnt lgkmcnt(7)
    v_mfma_f32_32x32x16_bf16 v[16:31], v[64:67], v[96:99], v[16:31]
    s_waitcnt lgkmcnt(6)
    v_mfma_f32_32x32x16_bf16 v[32:47], v[68:71], v[96:99], 0
    s_add_u32 s47, s47, 4096
    buffer_load_dwordx4 v[136:139], v1, s[8:11], s47 offen offset:0 sc1
    ds_read_b128 v[64:67], v4 offset:6144
    ds_read_b128 v[68:71], v7 offset:6144
    s_waitcnt vmcnt(9)
    s_waitcnt lgkmcnt(7)
    v_mfma_f32_32x32x16_bf16 v[16:31], v[72:75], v[100:103], v[16:31]
    s_waitcnt lgkmcnt(6)
    v_mfma_f32_32x32x16_bf16 v[32:47], v[76:79], v[100:103], v[32:47]
    buffer_load_dwordx4 v[140:143], v1, s[8:11], s47 offen offset:1024 sc1
    ds_read_b128 v[72:75], v4 offset:7168
    ds_read_b128 v[76:79], v7 offset:7168
    s_waitcnt vmcnt(9)
    s_waitcnt lgkmcnt(7)
    v_mfma_f32_32x32x16_bf16 v[16:31], v[80:83], v[104:107], v[16:31]
    s_waitcnt lgkmcnt(6)
    v_mfma_f32_32x32x16_bf16 v[32:47], v[84:87], v[104:107], v[32:47]
    s_add_u32 s47, s47, 4096
    buffer_load_dwordx4 v[144:147], v1, s[8:11], s47 offen offset:0 sc1
    ds_read_b128 v[80:83], v4 offset:14336
    ds_read_b128 v[84:87], v7 offset:14336
    s_waitcnt vmcnt(9)
    s_waitcnt lgkmcnt(7)
    v_mfma_f32_32x32x16_bf16 v[16:31], v[88:91], v[108:111], v[16:31]
    s_waitcnt lgkmcnt(6)
    v_mfma_f32_32x32x16_bf16 v[32:47], v[92:95], v[108:111], v[32:47]
    buffer_load_dwordx4 v[148:151], v1, s[8:11], s47 offen offset:1024 sc1
    ds_read_b128 v[88:91], v4 offset:15360
    ds_read_b128 v[92:95], v7 offset:15360
    s_waitcnt vmcnt(9)
    s_waitcnt lgkmcnt(7)
    v_mfma_f32_32x32x16_bf16 v[16:31], v[64:67], v[112:115], v[16:31]
    s_waitcnt lgkmcnt(6)
    v_mfma_f32_32x32x16_bf16 v[32:47], v[68:71], v[112:115], v[32:47]
    s_add_u32 s47, s47, 4096
    buffer_load_dwordx4 v[152:155], v1, s[8:11], s47 offen offset:0 sc1
    ds_read_b128 v[64:67], v4 offset:22528
    ds_read_b128 v[68:71], v7 offset:22528
    s_waitcnt vmcnt(9)
    s_waitcnt lgkmcnt(7)
    v_mfma_f32_32x32x16_bf16 v[16:31], v[72:75], v[116:119], v[16:31]
    s_waitcnt lgkmcnt(6)
    v_mfma_f32_32x32x16_bf16 v[32:47], v[76:79], v[116:119], v[32:47]
    buffer_load_dwordx4 v[156:159], v1, s[8:11], s47 offen offset:1024 sc1
    ds_read_b128 v[72:75], v4 offset:23552
    ds_read_b128 v[76:79], v7 offset:23552
    s_waitcnt vmcnt(9)
    s_waitcnt lgkmcnt(7)
    v_mfma_f32_32x32x16_bf16 v[16:31], v[80:83], v[120:123], v[16:31]
    s_waitcnt lgkmcnt(6)
    v_mfma_f32_32x32x16_bf16 v[32:47], v[84:87], v[120:123], v[32:47]
    s_add_u32 s47, s47, 4096
    buffer_load_dwordx4 v[160:163], v1, s[8:11], s47 offen offset:0 sc1
    ds_read_b128 v[80:83], v4 offset:30720
    ds_read_b128 v[84:87], v7 offset:30720
    s_waitcnt vmcnt(9)
    s_waitcnt lgkmcnt(7)
    v_mfma_f32_32x32x16_bf16 v[16:31], v[88:91], v[124:127], v[16:31]
    s_waitcnt lgkmcnt(6)
    v_mfma_f32_32x32x16_bf16 v[32:47], v[92:95], v[124:127], v[32:47]
    buffer_load_dwordx4 v[164:167], v1, s[8:11], s47 offen offset:1024 sc1
    ds_read_b128 v[88:91], v4 offset:31744
    ds_read_b128 v[92:95], v7 offset:31744
    s_waitcnt vmcnt(9)
    s_waitcnt lgkmcnt(7)
    v_mfma_f32_32x32x16_bf16 v[16:31], v[64:67], v[128:131], v[16:31]
    s_waitcnt lgkmcnt(6)
    v_mfma_f32_32x32x16_bf16 v[32:47], v[68:71], v[128:131], v[32:47]
    s_add_u32 s47, s47, 4096
    buffer_load_dwordx4 v[168:171], v1, s[8:11], s47 offen offset:0 sc1
    s_cmp_lg_u32 s12, 0
    s_cbranch_scc1 mega_kernel_c_w046
    buffer_load_dword v252, v2, s[8:11], s46 offen sc1
mega_kernel_c_w046:
    ds_read_b128 v[64:67], v4 offset:38912
    ds_read_b128 v[68:71], v7 offset:38912
    s_waitcnt vmcnt(9)
    s_waitcnt lgkmcnt(7)
    v_mfma_f32_32x32x16_bf16 v[16:31], v[72:75], v[132:135], v[16:31]
    s_waitcnt lgkmcnt(6)
    v_mfma_f32_32x32x16_bf16 v[32:47], v[76:79], v[132:135], v[32:47]
    buffer_load_dwordx4 v[172:175], v1, s[8:11], s47 offen offset:1024 sc1
    ds_read_b128 v[72:75], v4 offset:39936
    ds_read_b128 v[76:79], v7 offset:39936
    s_waitcnt vmcnt(9)
    s_waitcnt lgkmcnt(7)
    v_mfma_f32_32x32x16_bf16 v[16:31], v[80:83], v[136:139], v[16:31]
    s_waitcnt lgkmcnt(6)
    v_mfma_f32_32x32x16_bf16 v[32:47], v[84:87], v[136:139], v[32:47]
    s_add_u32 s47, s47, 4096
    buffer_load_dwordx4 v[176:179], v1, s[8:11], s47 offen offset:0 sc1
    ds_read_b128 v[80:83], v4 offset:47104
    ds_read_b128 v[84:87], v7 offset:47104
    s_waitcnt vmcnt(9)
    s_waitcnt lgkmcnt(7)
    v_mfma_f32_32x32x16_bf16 v[16:31], v[88:91], v[140:143], v[16:31]
    s_waitcnt lgkmcnt(6)
    v_mfma_f32_32x32x16_bf16 v[32:47], v[92:95], v[140:143], v[32:47]
    buffer_load_dwordx4 v[180:183], v1, s[8:11], s47 offen offset:1024 sc1
    ds_read_b128 v[88:91], v4 offset:48128
    ds_read_b128 v[92:95], v7 offset:48128
    s_waitcnt vmcnt(9)
    s_waitcnt lgkmcnt(7)
    v_mfma_f32_32x32x16_bf16 v[16:31], v[64:67], v[144:147], v[16:31]
    s_waitcnt lgkmcnt(6)
    v_mfma_f32_32x32x16_bf16 v[32:47], v[68:71], v[144:147], v[32:47]
    s_add_u32 s47, s47, 4096
    buffer_load_dwordx4 v[184:187], v1, s[8:11], s47 offen offset:0 sc1
    ds_read_b128 v[64:67], v4 offset:55296
    ds_read_b128 v[68:71], v7 offset:55296
    s_waitcnt vmcnt(9)
    s_waitcnt lgkmcnt(7)
    v_mfma_f32_32x32x16_bf16 v[16:31], v[72:75], v[148:151], v[16:31]
    s_waitcnt lgkmcnt(6)
    v_mfma_f32_32x32x16_bf16 v[32:47], v[76:79], v[148:151], v[32:47]
    buffer_load_dwordx4 v[188:191], v1, s[8:11], s47 offen offset:1024 sc1
    ds_read_b128 v[72:75], v4 offset:56320
    ds_read_b128 v[76:79], v7 offset:56320
    s_waitcnt vmcnt(9)
    s_waitcnt lgkmcnt(7)
    v_mfma_f32_32x32x16_bf16 v[16:31], v[80:83], v[152:155], v[16:31]
    s_waitcnt lgkmcnt(6)
    v_mfma_f32_32x32x16_bf16 v[32:47], v[84:87], v[152:155], v[32:47]
    s_add_u32 s47, s47, 4096
    buffer_load_dwordx4 v[96:99], v1, s[8:11], s47 offen offset:0 sc1
    ds_read_b128 v[80:83], v5 offset:2048
    ds_read_b128 v[84:87], v8 offset:2048
    s_waitcnt vmcnt(9)
    s_waitcnt lgkmcnt(7)
    v_mfma_f32_32x32x16_bf16 v[16:31], v[88:91], v[156:159], v[16:31]
    s_waitcnt lgkmcnt(6)
    v_mfma_f32_32x32x16_bf16 v[32:47], v[92:95], v[156:159], v[32:47]
    buffer_load_dwordx4 v[100:103], v1, s[8:11], s47 offen offset:1024 sc1
    ds_read_b128 v[88:91], v5 offset:3072
    ds_read_b128 v[92:95], v8 offset:3072
    s_waitcnt vmcnt(9)
    s_waitcnt lgkmcnt(7)
    v_mfma_f32_32x32x16_bf16 v[16:31], v[64:67], v[160:163], v[16:31]
    s_waitcnt lgkmcnt(6)
    v_mfma_f32_32x32x16_bf16 v[32:47], v[68:71], v[160:163], v[32:47]
    s_add_u32 s47, s47, 4096
    buffer_load_dwordx4 v[104:107], v1, s[8:11], s47 offen offset:0 sc1
    ds_read_b128 v[64:67], v5 offset:10240
    ds_read_b128 v[68:71], v8 offset:10240
    s_waitcnt vmcnt(9)
    s_waitcnt lgkmcnt(7)
    v_mfma_f32_32x32x16_bf16 v[16:31], v[72:75], v[164:167], v[16:31]
    s_waitcnt lgkmcnt(6)
    v_mfma_f32_32x32x16_bf16 v[32:47], v[76:79], v[164:167], v[32:47]
    buffer_load_dwordx4 v[108:111], v1, s[8:11], s47 offen offset:1024 sc1
    ds_read_b128 v[72:75], v5 offset:11264
    ds_read_b128 v[76:79], v8 offset:11264
    s_waitcnt vmcnt(9)
    s_waitcnt lgkmcnt(7)
    v_mfma_f32_32x32x16_bf16 v[16:31], v[80:83], v[168:171], v[16:31]
    s_waitcnt lgkmcnt(6)
    v_mfma_f32_32x32x16_bf16 v[32:47], v[84:87], v[168:171], v[32:47]
    s_add_u32 s47, s47, 4096
    buffer_load_dwordx4 v[112:115], v1, s[8:11], s47 offen offset:0 sc1
    s_barrier
    ds_read_b128 v[80:83], v5 offset:18432
    ds_read_b128 v[84:87], v8 offset:18432
    s_waitcnt vmcnt(9)
    s_waitcnt lgkmcnt(7)
    v_mfma_f32_32x32x16_bf16 v[16:31], v[88:91], v[172:175], v[16:31]
    s_waitcnt lgkmcnt(6)
    v_mfma_f32_32x32x16_bf16 v[32:47], v[92:95], v[172:175], v[32:47]
    buffer_load_dwordx4 v[116:119], v1, s[8:11], s47 offen offset:1024 sc1
    ds_read_b128 v[88:91], v5 offset:19456
    ds_read_b128 v[92:95], v8 offset:19456
    s_waitcnt vmcnt(9)
    s_waitcnt lgkmcnt(7)
    v_mfma_f32_32x32x16_bf16 v[16:31], v[64:67], v[176:179], v[16:31]
    s_waitcnt lgkmcnt(6)
    v_mfma_f32_32x32x16_bf16 v[32:47], v[68:71], v[176:179], v[32:47]
    s_add_u32 s47, s47, 4096
    buffer_load_dwordx4 v[120:123], v1, s[8:11], s47 offen offset:0 sc1
    ds_read_b128 v[64:67], v3 offset:0
    ds_read_b128 v[68:71], v6 offset:0
    s_waitcnt vmcnt(9)
    s_waitcnt lgkmcnt(7)
    v_mfma_f32_32x32x16_bf16 v[16:31], v[72:75], v[180:183], v[16:31]
    s_waitcnt lgkmcnt(6)
    v_mfma_f32_32x32x16_bf16 v[32:47], v[76:79], v[180:183], v[32:47]
    buffer_load_dwordx4 v[124:127], v1, s[8:11], s47 offen offset:1024 sc1
    ds_read_b128 v[72:75], v3 offset:1024
    ds_read_b128 v[76:79], v6 offset:1024
    s_waitcnt vmcnt(9)
    s_waitcnt lgkmcnt(7)
    v_mfma_f32_32x32x16_bf16 v[16:31], v[80:83], v[184:187], v[16:31]
    s_waitcnt lgkmcnt(6)
    v_mfma_f32_32x32x16_bf16 v[32:47], v[84:87], v[184:187], v[32:47]
    s_cmp_lg_u32 s12, 0
    s_cbranch_scc1 mega_kernel_c_dwo47
    v_cmp_eq_u32 vcc, 0, v252
    s_nop 1
    s_and_b64 vcc, vcc, s[60:61]
    s_cbranch_scc0 mega_kernel_c_mbd50
mega_kernel_c_mbw49:
    buffer_load_dword v252, v2, s[8:11], s46 offen sc1
    s_waitcnt vmcnt(0)
    v_cmp_eq_u32 vcc, 0, v252
    s_nop 1
    s_and_b64 vcc, vcc, s[60:61]
    s_cbranch_scc0 mega_kernel_c_mbd50
    s_sub_u32 s25, s25, 1
    s_cbranch_scc0 mega_kernel_c_mbw49
    s_mov_b32 s25, 0
mega_kernel_c_mbd50:
    s_mov_b64 exec, 1
    v_mov_b32 v253, 163792
    v_mov_b32 v254, 1
    ds_add_u32 v253, v254
    s_mov_b64 exec, -1
    s_branch mega_kernel_c_dwg48
mega_kernel_c_dwo47:
    v_mov_b32 v253, 163792
mega_kernel_c_lw51:
    ds_read_b32 v254, v253
    s_waitcnt lgkmcnt(0)
    v_readfirstlane_b32 s62, v254
    s_nop 1
    s_cmp_ge_u32 s62, 3
    s_cbranch_scc1 mega_kernel_c_lwd52
    s_sleep 1
    s_sub_u32 s25, s25, 1
    s_cbranch_scc0 mega_kernel_c_lw51
    s_mov_b32 s25, 0
mega_kernel_c_lwd52:
mega_kernel_c_dwg48:
    s_waitcnt lgkmcnt(0)
    s_add_u32 s47, s47, 4096
    buffer_load_dwordx4 v[128:131], v1, s[8:11], s47 offen offset:0 sc1
    ds_read_b128 v[80:83], v3 offset:8192
    ds_read_b128 v[84:87], v6 offset:8192
    s_waitcnt vmcnt(9)
    v_mfma_f32_32x32x16_bf16 v[16:31], v[88:91], v[188:191], v[16:31]
    v_mfma_f32_32x32x16_bf16 v[32:47], v[92:95], v[188:191], v[32:47]
    buffer_load_dwordx4 v[132:135], v1, s[8:11], s47 offen offset:1024 sc1
    ds_read_b128 v[88:91], v3 offset:9216
    ds_read_b128 v[92:95], v6 offset:9216
    s_waitcnt vmcnt(9)
    v_mfma_f32_32x32x16_bf16 v[16:31], v[64:67], v[96:99], v[16:31]
    v_mfma_f32_32x32x16_bf16 v[32:47], v[68:71], v[96:99], v[32:47]
    s_add_u32 s47, s47, 4096
    buffer_load_dwordx4 v[136:139], v1, s[8:11], s47 offen offset:0 sc1
    ds_read_b128 v[64:67], v3 offset:16384
    ds_read_b128 v[68:71], v6 offset:16384
    s_waitcnt vmcnt(9)
    v_mfma_f32_32x32x16_bf16 v[16:31], v[72:75], v[100:103], v[16:31]
    v_mfma_f32_32x32x16_bf16 v[32:47], v[76:79], v[100:103], v[32:47]
    buffer_load_dwordx4 v[140:143], v1, s[8:11], s47 offen offset:1024 sc1
    ds_read_b128 v[72:75], v3 offset:17408
    ds_read_b128 v[76:79], v6 offset:17408
    s_waitcnt vmcnt(9)
    s_waitcnt lgkmcnt(7)
    v_mfma_f32_32x32x16_bf16 v[16:31], v[80:83], v[104:107], v[16:31]
    s_waitcnt lgkmcnt(6)
    v_mfma_f32_32x32x16_bf16 v[32:47], v[84:87], v[104:107], v[32:47]
    s_add_u32 s47, s47, 4096
    buffer_load_dwordx4 v[144:147], v1, s[8:11], s47 offen offset:0 sc1
    ds_read_b128 v[80:83], v3 offset:24576
    ds_read_b128 v[84:87], v6 offset:24576
    s_waitcnt vmcnt(9)
    s_waitcnt lgkmcnt(7)
    v_mfma_f32_32x32x16_bf16 v[16:31], v[88:91], v[108:111], v[16:31]
    s_waitcnt lgkmcnt(6)
    v_mfma_f32_32x32x16_bf16 v[32:47], v[92:95], v[108:111], v[32:47]
    buffer_load_dwordx4 v[148:151], v1, s[8:11], s47 offen offset:1024 sc1
    ds_read_b128 v[88:91], v3 offset:25600
    ds_read_b128 v[92:95], v6 offset:25600
    s_waitcnt vmcnt(9)
    s_waitcnt lgkmcnt(7)
    v_mfma_f32_32x32x16_bf16 v[16:31], v[64:67], v[112:115], v[16:31]
    s_waitcnt lgkmcnt(6)
    v_mfma_f32_32x32x16_bf16 v[32:47], v[68:71], v[112:115], v[32:47]
    s_add_u32 s47, s47, 4096
    buffer_load_dwordx4 v[152:155], v1, s[8:11], s47 offen offset:0 sc1
    ds_read_b128 v[64:67], v3 offset:32768
    ds_read_b128 v[68:71], v6 offset:32768
    s_waitcnt vmcnt(9)
    s_waitcnt lgkmcnt(7)
    v_mfma_f32_32x32x16_bf16 v[16:31], v[72:75], v[116:119], v[16:31]
    s_waitcnt lgkmcnt(6)
    v_mfma_f32_32x32x16_bf16 v[32:47], v[76:79], v[116:119], v[32:47]
    buffer_load_dwordx4 v[156:159], v1, s[8:11], s47 offen offset:1024 sc1
    ds_read_b128 v[72:75], v3 offset:33792
    ds_read_b128 v[76:79], v6 offset:33792
    s_waitcnt vmcnt(9)
    s_waitcnt lgkmcnt(7)
    v_mfma_f32_32x32x16_bf16 v[16:31], v[80:83], v[120:123], v[16:31]
    s_waitcnt lgkmcnt(6)
    v_mfma_f32_32x32x16_bf16 v[32:47], v[84:87], v[120:123], v[32:47]
    s_add_u32 s47, s47, 4096
    buffer_load_dwordx4 v[160:163], v1, s[8:11], s47 offen offset:0 sc1
    ds_read_b128 v[80:83], v3 offset:40960
    ds_read_b128 v[84:87], v6 offset:40960
    s_waitcnt vmcnt(9)
    s_waitcnt lgkmcnt(7)
    v_mfma_f32_32x32x16_bf16 v[16:31], v[88:91], v[124:127], v[16:31]
    s_waitcnt lgkmcnt(6)
    v_mfma_f32_32x32x16_bf16 v[32:47], v[92:95], v[124:127], v[32:47]
    buffer_load_dwordx4 v[164:167], v1, s[8:11], s47 offen offset:1024 sc1
    ds_read_b128 v[88:91], v3 offset:41984
    ds_read_b128 v[92:95], v6 offset:41984
    s_waitcnt vmcnt(9)
    s_waitcnt lgkmcnt(7)
    v_mfma_f32_32x32x16_bf16 v[16:31], v[64:67], v[128:131], v[16:31]
    s_waitcnt lgkmcnt(6)
    v_mfma_f32_32x32x16_bf16 v[32:47], v[68:71], v[128:131], v[32:47]
    s_add_u32 s47, s47, 4096
    buffer_load_dwordx4 v[168:171], v1, s[8:11], s47 offen offset:0 sc1
    ds_read_b128 v[64:67], v3 offset:49152
    ds_read_b128 v[68:71], v6 offset:49152
    s_waitcnt vmcnt(9)
    s_waitcnt lgkmcnt(7)
    v_mfma_f32_32x32x16_bf16 v[16:31], v[72:75], v[132:135], v[16:31]
    s_waitcnt lgkmcnt(6)
    v_mfma_f32_32x32x16_bf16 v[32:47], v[76:79], v[132:135], v[32:47]
    buffer_load_dwordx4 v[172:175], v1, s[8:11], s47 offen offset:1024 sc1
    ds_read_b128 v[72:75], v3 offset:50176
    ds_read_b128 v[76:79], v6 offset:50176
    s_waitcnt vmcnt(9)
    s_waitcnt lgkmcnt(7)
    v_mfma_f32_32x32x16_bf16 v[16:31], v[80:83], v[136:139], v[16:31]
    s_waitcnt lgkmcnt(6)
    v_mfma_f32_32x32x16_bf16 v[32:47], v[84:87], v[136:139], v[32:47]
    s_add_u32 s47, s47, 4096
    buffer_load_dwordx4 v[176:179], v1, s[8:11], s47 offen offset:0 sc1
    s_barrier
    ds_read_b128 v[80:83], v5 offset:26624
    ds_read_b128 v[84:87], v8 offset:26624
    s_waitcnt vmcnt(9)
    s_waitcnt lgkmcnt(7)
    v_mfma_f32_32x32x16_bf16 v[16:31], v[88:91], v[140:143], v[16:31]
    s_waitcnt lgkmcnt(6)
    v_mfma_f32_32x32x16_bf16 v[32:47], v[92:95], v[140:143], v[32:47]
    buffer_load_dwordx4 v[180:183], v1, s[8:11], s47 offen offset:1024 sc1
    ds_read_b128 v[88:91], v5 offset:27648
    ds_read_b128 v[92:95], v8 offset:27648
    s_waitcnt vmcnt(9)
    s_waitcnt lgkmcnt(7)
    v_mfma_f32_32x32x16_bf16 v[16:31], v[64:67], v[144:147], v[16:31]
    s_waitcnt lgkmcnt(6)
    v_mfma_f32_32x32x16_bf16 v[32:47], v[68:71], v[144:147], v[32:47]
    s_add_u32 s47, s47, 4096
    buffer_load_dwordx4 v[184:187], v1, s[8:11], s47 offen offset:0 sc1
    ds_read_b128 v[64:67], v3 offset:59392
    ds_read_b128 v[68:71], v6 offset:59392
    s_waitcnt vmcnt(9)
    s_waitcnt lgkmcnt(7)
    v_mfma_f32_32x32x16_bf16 v[16:31], v[72:75], v[148:151], v[16:31]
    s_waitcnt lgkmcnt(6)
    v_mfma_f32_32x32x16_bf16 v[32:47], v[76:79], v[148:151], v[32:47]
    buffer_load_dwordx4 v[188:191], v1, s[8:11], s47 offen offset:1024 sc1
    ds_read_b128 v[72:75], v3 offset:60416
    ds_read_b128 v[76:79], v6 offset:60416
    s_waitcnt vmcnt(9)
    s_waitcnt lgkmcnt(7)
    v_mfma_f32_32x32x16_bf16 v[16:31], v[80:83], v[152:155], v[16:31]
    s_waitcnt lgkmcnt(6)
    v_mfma_f32_32x32x16_bf16 v[32:47], v[84:87], v[152:155], v[32:47]
    s_add_u32 s47, s47, 4096
    buffer_load_dwordx4 v[96:99], v1, s[8:11], s47 offen offset:0 sc1
    ds_read_b128 v[80:83], v4 offset:6144
    ds_read_b128 v[84:87], v7 offset:6144
    s_waitcnt vmcnt(9)
    s_waitcnt lgkmcnt(7)
    v_mfma_f32_32x32x16_bf16 v[16:31], v[88:91], v[156:159], v[16:31]
    s_waitcnt lgkmcnt(6)
    v_mfma_f32_32x32x16_bf16 v[32:47], v[92:95], v[156:159], v[32:47]
    buffer_load_dwordx4 v[100:103], v1, s[8:11], s47 offen offset:1024 sc1
    ds_read_b128 v[88:91], v4 offset:7168
    ds_read_b128 v[92:95], v7 offset:7168
    s_waitcnt vmcnt(9)
    s_waitcnt lgkmcnt(7)
    v_mfma_f32_32x32x16_bf16 v[16:31], v[64:67], v[160:163], v[16:31]
    s_waitcnt lgkmcnt(6)
    v_mfma_f32_32x32x16_bf16 v[32:47], v[68:71], v[160:163], v[32:47]
    s_add_u32 s47, s47, 4096
    buffer_load_dwordx4 v[104:107], v1, s[8:11], s47 offen offset:0 sc1
    ds_read_b128 v[64:67], v4 offset:14336
    ds_read_b128 v[68:71], v7 offset:14336
    s_waitcnt vmcnt(9)
    s_waitcnt lgkmcnt(7)
    v_mfma_f32_32x32x16_bf16 v[16:31], v[72:75], v[164:167], v[16:31]
    s_waitcnt lgkmcnt(6)
    v_mfma_f32_32x32x16_bf16 v[32:47], v[76:79], v[164:167], v[32:47]
    buffer_load_dwordx4 v[108:111], v1, s[8:11], s47 offen offset:1024 sc1
    ds_read_b128 v[72:75], v4 offset:15360
    ds_read_b128 v[76:79], v7 offset:15360
    s_waitcnt vmcnt(9)
    s_waitcnt lgkmcnt(7)
    v_mfma_f32_32x32x16_bf16 v[16:31], v[80:83], v[168:171], v[16:31]
    s_waitcnt lgkmcnt(6)
    v_mfma_f32_32x32x16_bf16 v[32:47], v[84:87], v[168:171], v[32:47]
    s_add_u32 s47, s47, 4096
    buffer_load_dwordx4 v[112:115], v1, s[8:11], s47 offen offset:0 sc1
    ds_read_b128 v[80:83], v4 offset:22528
    ds_read_b128 v[84:87], v7 offset:22528
    s_waitcnt vmcnt(9)
    s_waitcnt lgkmcnt(7)
    v_mfma_f32_32x32x16_bf16 v[16:31], v[88:91], v[172:175], v[16:31]
    s_waitcnt lgkmcnt(6)
    v_mfma_f32_32x32x16_bf16 v[32:47], v[92:95], v[172:175], v[32:47]
    buffer_load_dwordx4 v[116:119], v1, s[8:11], s47 offen offset:1024 sc1
    ds_read_b128 v[88:91], v4 offset:23552
    ds_read_b128 v[92:95], v7 offset:23552
    s_waitcnt vmcnt(9)
    s_waitcnt lgkmcnt(7)
    v_mfma_f32_32x32x16_bf16 v[16:31], v[64:67], v[176:179], v[16:31]
    s_waitcnt lgkmcnt(6)
    v_mfma_f32_32x32x16_bf16 v[32:47], v[68:71], v[176:179], v[32:47]
    s_add_u32 s47, s47, 4096
    buffer_load_dwordx4 v[120:123], v1, s[8:11], s47 offen offset:0 sc1
    ds_read_b128 v[64:67], v4 offset:30720
    ds_read_b128 v[68:71], v7 offset:30720
    s_waitcnt vmcnt(9)
    s_waitcnt lgkmcnt(7)
    v_mfma_f32_32x32x16_bf16 v[16:31], v[72:75], v[180:183], v[16:31]
    s_waitcnt lgkmcnt(6)
    v_mfma_f32_32x32x16_bf16 v[32:47], v[76:79], v[180:183], v[32:47]
    buffer_load_dwordx4 v[124:127], v1, s[8:11], s47 offen offset:1024 sc1
    ds_read_b128 v[72:75], v4 offset:31744
    ds_read_b128 v[76:79], v7 offset:31744
    s_waitcnt vmcnt(9)
    s_waitcnt lgkmcnt(7)
    v_mfma_f32_32x32x16_bf16 v[16:31], v[80:83], v[184:187], v[16:31]
    s_waitcnt lgkmcnt(6)
    v_mfma_f32_32x32x16_bf16 v[32:47], v[84:87], v[184:187], v[32:47]
    ds_read_b128 v[80:83], v4 offset:38912
    ds_read_b128 v[84:87], v7 offset:38912
    s_waitcnt vmcnt(8)
    s_waitcnt lgkmcnt(7)
    v_mfma_f32_32x32x16_bf16 v[16:31], v[88:91], v[188:191], v[16:31]
    s_waitcnt lgkmcnt(6)
    v_mfma_f32_32x32x16_bf16 v[32:47], v[92:95], v[188:191], v[32:47]
    ds_read_b128 v[88:91], v4 offset:39936
    ds_read_b128 v[92:95], v7 offset:39936
    s_waitcnt vmcnt(7)
    s_waitcnt lgkmcnt(7)
    v_mfma_f32_32x32x16_bf16 v[16:31], v[64:67], v[96:99], v[16:31]
    s_waitcnt lgkmcnt(6)
    v_mfma_f32_32x32x16_bf16 v[32:47], v[68:71], v[96:99], v[32:47]
    ds_read_b128 v[64:67], v4 offset:47104
    ds_read_b128 v[68:71], v7 offset:47104
    s_waitcnt vmcnt(6)
    s_waitcnt lgkmcnt(7)
    v_mfma_f32_32x32x16_bf16 v[16:31], v[72:75], v[100:103], v[16:31]
    s_waitcnt lgkmcnt(6)
    v_mfma_f32_32x32x16_bf16 v[32:47], v[76:79], v[100:103], v[32:47]
    ds_read_b128 v[72:75], v4 offset:48128
    ds_read_b128 v[76:79], v7 offset:48128
    s_waitcnt vmcnt(5)
    s_waitcnt lgkmcnt(7)
    v_mfma_f32_32x32x16_bf16 v[16:31], v[80:83], v[104:107], v[16:31]
    s_waitcnt lgkmcnt(6)
    v_mfma_f32_32x32x16_bf16 v[32:47], v[84:87], v[104:107], v[32:47]
    ds_read_b128 v[80:83], v4 offset:55296
    ds_read_b128 v[84:87], v7 offset:55296
    s_waitcnt vmcnt(4)
    s_waitcnt lgkmcnt(7)
    v_mfma_f32_32x32x16_bf16 v[16:31], v[88:91], v[108:111], v[16:31]
    s_waitcnt lgkmcnt(6)
    v_mfma_f32_32x32x16_bf16 v[32:47], v[92:95], v[108:111], v[32:47]
    ds_read_b128 v[88:91], v4 offset:56320
    ds_read_b128 v[92:95], v7 offset:56320
    s_waitcnt vmcnt(3)
    s_waitcnt lgkmcnt(7)
    v_mfma_f32_32x32x16_bf16 v[16:31], v[64:67], v[112:115], v[16:31]
    s_waitcnt lgkmcnt(6)
    v_mfma_f32_32x32x16_bf16 v[32:47], v[68:71], v[112:115], v[32:47]
    s_waitcnt vmcnt(2)
    s_waitcnt lgkmcnt(5)
    v_mfma_f32_32x32x16_bf16 v[16:31], v[72:75], v[116:119], v[16:31]
    s_waitcnt lgkmcnt(4)
    v_mfma_f32_32x32x16_bf16 v[32:47], v[76:79], v[116:119], v[32:47]
    s_waitcnt vmcnt(1)
    s_waitcnt lgkmcnt(3)
    v_mfma_f32_32x32x16_bf16 v[16:31], v[80:83], v[120:123], v[16:31]
    s_waitcnt lgkmcnt(2)
    v_mfma_f32_32x32x16_bf16 v[32:47], v[84:87], v[120:123], v[32:47]
    s_waitcnt vmcnt(0)
    s_waitcnt lgkmcnt(1)
    v_mfma_f32_32x32x16_bf16 v[16:31], v[88:91], v[124:127], v[16:31]
    s_waitcnt lgkmcnt(0)
    v_mfma_f32_32x32x16_bf16 v[32:47], v[92:95], v[124:127], v[32:47]
    s_nop 11
    ds_write_b128 v9, v[32:35] offset:0
    ds_write_b128 v9, v[36:39] offset:1024
    ds_write_b128 v9, v[40:43] offset:2048
    ds_write_b128 v9, v[44:47] offset:3072
    s_waitcnt lgkmcnt(0)
    s_barrier
    ds_read_b128 v[64:67], v10 offset:0
    ds_read_b128 v[68:71], v10 offset:1024
    ds_read_b128 v[72:75], v10 offset:2048
    ds_read_b128 v[76:79], v10 offset:3072
    s_waitcnt lgkmcnt(3)
    v_add_f32 v16, v16, v64
    v_add_f32 v17, v17, v65
    v_add_f32 v18, v18, v66
    v_add_f32 v19, v19, v67
    v_cvt_pk_bf16_f32 v96, v16, v17
    v_cvt_pk_bf16_f32 v97, v18, v19
    s_waitcnt lgkmcnt(2)
    v_add_f32 v20, v20, v68
    v_add_f32 v21, v21, v69
    v_add_f32 v22, v22, v70
    v_add_f32 v23, v23, v71
    v_cvt_pk_bf16_f32 v98, v20, v21
    v_cvt_pk_bf16_f32 v99, v22, v23
    s_waitcnt lgkmcnt(1)
    v_add_f32 v24, v24, v72
    v_add_f32 v25, v25, v73
    v_add_f32 v26, v26, v74
    v_add_f32 v27, v27, v75
    v_cvt_pk_bf16_f32 v100, v24, v25
    v_cvt_pk_bf16_f32 v101, v26, v27
    s_waitcnt lgkmcnt(0)
    v_add_f32 v28, v28, v76
    v_add_f32 v29, v29, v77
    v_add_f32 v30, v30, v78
    v_add_f32 v31, v31, v79
    v_cvt_pk_bf16_f32 v102, v28, v29
    v_cvt_pk_bf16_f32 v103, v30, v31
    s_add_u32 s45, s42, 14680064
    buffer_store_dwordx4 v[96:99], v1, s[8:11], s45 offen sc1
    buffer_store_dwordx4 v[100:103], v1, s[8:11], s45 offen offset:1024 sc1
    v_mov_b32 v56, 0
    v_mov_b32 v57, 0
    v_dot2c_f32_bf16 v56, v96, v48
    v_dot2c_f32_bf16 v57, v96, v96
    v_dot2c_f32_bf16 v56, v97, v48
    v_dot2c_f32_bf16 v57, v97, v97
    v_dot2c_f32_bf16 v56, v98, v48
    v_dot2c_f32_bf16 v57, v98, v98
    v_dot2c_f32_bf16 v56, v99, v48
    v_dot2c_f32_bf16 v57, v99, v99
    v_dot2c_f32_bf16 v56, v100, v48
    v_dot2c_f32_bf16 v57, v100, v100
    v_dot2c_f32_bf16 v56, v101, v48
    v_dot2c_f32_bf16 v57, v101, v101
    v_dot2c_f32_bf16 v56, v102, v48
    v_dot2c_f32_bf16 v57, v102, v102
    v_dot2c_f32_bf16 v56, v103, v48
    v_dot2c_f32_bf16 v57, v103, v103
    s_nop 1
    v_mov_b32 v58, v56
    v_mov_b32 v59, v57
    s_nop 0
    v_permlane32_swap_b32 v58, v56
    v_permlane32_swap_b32 v59, v57
    v_add_f32 v56, v56, v58
    v_add_f32 v57, v57, v59
    v_and_b32 v58, 31, v0
    v_lshlrev_b32 v58, 3, v58
    s_mul_i32 s45, s40, 14
    s_add_u32 s45, s45, s41
    s_lshl_b32 s45, s45, 8
    s_add_u32 s45, s45, 36175872
    buffer_store_dwordx2 v[56:57], v58, s[8:11], s45 offen sc1
    s_lshr_b32 s46, s56, 4
    s_and_b32 s63, s56, 15
    s_lshl_b32 s46, s46, 12
    s_lshl_b32 s63, s63, 2
    s_add_u32 s46, s46, s63
    s_add_u32 s46, s46, 70664192
    v_mul_u32_u24 v255, 256, v0
    v_mov_b32 v254, 1
    v_mov_b32 v253, 163776
    s_waitcnt vmcnt(0)
    s_mov_b64 exec, 1
    ds_add_rtn_u32 v253, v253, v254
    s_waitcnt lgkmcnt(0)
    v_readfirstlane_b32 s62, v253
    s_mov_b64 exec, 65535
    s_and_b32 s62, s62, 3
    s_cmp_lg_u32 s62, 3
    s_cbranch_scc1 mega_kernel_c_sig53
    buffer_store_dword v254, v255, s[8:11], s46 offen sc1
mega_kernel_c_sig53:
    s_mov_b64 exec, -1
mega_kernel_c_skip39:
    s_nop 7
    s_nop 7
    s_lshl_b32 s40, s18, 2
    s_add_u32 s40, s40, s13
    s_mul_i32 s41, s40, 28672
    s_add_u32 s41, s41, 14680064
    s_mul_i32 s42, s40, 3584
    s_add_u32 s42, s42, 36175872
    v_mov_b32 v5, 0x3f803f80
    v_lshrrev_b32 v228, 5, v0
    v_mul_u32_u24 v228, 1792, v228
    v_and_b32 v229, 31, v0
    v_lshl_add_u32 v228, v229, 3, v228
    v_mov_b32 v10, v1
    v_add_u32 v11, 59392, v1
    v_add_u32 v12, 118784, v1
    s_lshl_b32 s46, s19, 6
    s_add_u32 s46, s46, s40
    s_lshl_b32 s46, s46, 12
    s_add_u32 s46, s46, 42991616
    s_lshl_b32 s47, s13, 12
    s_add_u32 s47, s47, 89088
    v_add_u32 v13, s47, v1
    s_lshl_b32 s48, s18, 4
    s_add_u32 s48, s48, s19
    s_lshl_b32 s48, s48, 8
    s_add_u32 s48, s48, 70746112
    s_add_u32 s48, s48, 4096
    s_lshl_b32 s47, s18, 4
    s_add_u32 s47, s47, s19
    s_lshl_b32 s47, s47, 8
    s_add_u32 s47, s47, 70664192
    s_cmp_lg_u32 s12, 0
    s_cbranch_scc1 mega_kernel_c_dwo54
mega_kernel_c_mbw56:
    buffer_load_dword v252, v2, s[8:11], s47 offen sc1
    s_waitcnt vmcnt(0)
    v_cmp_eq_u32 vcc, 0, v252
    s_nop 1
    s_and_b64 vcc, vcc, s[58:59]
    s_cbranch_scc0 mega_kernel_c_mbd57
    s_sub_u32 s25, s25, 1
    s_cbranch_scc0 mega_kernel_c_mbw56
    s_mov_b32 s25, 0
mega_kernel_c_mbd57:
    s_mov_b64 exec, 1
    v_mov_b32 v253, 163788
    v_mov_b32 v254, 1
    ds_add_u32 v253, v254
    s_mov_b64 exec, -1
    s_branch mega_kernel_c_dwg55
mega_kernel_c_dwo54:
    v_mov_b32 v253, 163788
mega_kernel_c_lw58:
    ds_read_b32 v254, v253
    s_waitcnt lgkmcnt(0)
    v_readfirstlane_b32 s62, v254
    s_nop 1
    s_cmp_ge_u32 s62, 2
    s_cbranch_scc1 mega_kernel_c_lwd59
    s_sleep 1
    s_sub_u32 s25, s25, 1
    s_cbranch_scc0 mega_kernel_c_lw58
    s_mov_b32 s25, 0
mega_kernel_c_lwd59:
mega_kernel_c_dwg55:
    s_waitcnt lgkmcnt(0)
    s_add_u32 s43, s41, s26
    buffer_load_dwordx4 v[16:19], v1, s[8:11], s43 offen offset:0 sc1
    buffer_load_dwordx4 v[20:23], v1, s[8:11], s43 offen offset:1024 sc1
    buffer_load_dwordx4 v[24:27], v1, s[8:11], s43 offen offset:2048 sc1
    buffer_load_dwordx4 v[28:31], v1, s[8:11], s43 offen offset:3072 sc1
    s_add_u32 s43, s41, s27
    buffer_load_dwordx4 v[32:35], v1, s[8:11], s43 offen offset:0 sc1
    buffer_load_dwordx4 v[36:39], v1, s[8:11], s43 offen offset:1024 sc1
    buffer_load_dwordx4 v[40:43], v1, s[8:11], s43 offen offset:2048 sc1
    buffer_load_dwordx4 v[44:47], v1, s[8:11], s43 offen offset:3072 sc1
    s_add_u32 s43, s41, s28
    buffer_load_dwordx4 v[48:51], v1, s[8:11], s43 offen offset:0 sc1
    buffer_load_dwordx4 v[52:55], v1, s[8:11], s43 offen offset:1024 sc1
    buffer_load_dwordx4 v[56:59], v1, s[8:11], s43 offen offset:2048 sc1
    buffer_load_dwordx4 v[60:63], v1, s[8:11], s43 offen offset:3072 sc1
    buffer_load_dwordx2 v[212:213], v228, s[8:11], s42 offen offset:0 sc1
    buffer_load_dwordx2 v[214:215], v228, s[8:11], s42 offen offset:256 sc1
    buffer_load_dwordx2 v[216:217], v228, s[8:11], s42 offen offset:512 sc1
    buffer_load_dwordx2 v[218:219], v228, s[8:11], s42 offen offset:768 sc1
    buffer_load_dwordx2 v[220:221], v228, s[8:11], s42 offen offset:1024 sc1
    buffer_load_dwordx2 v[222:223], v228, s[8:11], s42 offen offset:1280 sc1
    buffer_load_dwordx2 v[224:225], v228, s[8:11], s42 offen offset:1536 sc1
    s_barrier
    ds_read_b128 v[132:135], v10 offset:29696
    ds_read_b128 v[136:139], v11 offset:0
    ds_read_b128 v[140:143], v10 offset:30720
    ds_read_b128 v[144:147], v11 offset:1024
    ds_read_b128 v[148:151], v10 offset:31744
    ds_read_b128 v[152:155], v11 offset:2048
    ds_read_b128 v[156:159], v10 offset:32768
    s_waitcnt vmcnt(15)
    s_waitcnt lgkmcnt(5)
    v_mfma_f32_32x32x16_bf16 v[164:179], v[132:135], v[16:19], 0
    s_add_u32 s43, s41, s29
    buffer_load_dwordx4 v[64:67], v1, s[8:11], s43 offen offset:0 sc1
    buffer_load_dwordx4 v[68:71], v1, s[8:11], s43 offen offset:1024 sc1
    ds_read_b128 v[160:163], v11 offset:3072
    v_mfma_f32_32x32x16_bf16 v[180:195], v[16:19], v[136:139], 0
    buffer_load_dwordx4 v[72:75], v1, s[8:11], s43 offen offset:2048 sc1
    buffer_load_dwordx4 v[76:79], v1, s[8:11], s43 offen offset:3072 sc1
    ds_read_b128 v[132:135], v10 offset:33792
    s_waitcnt lgkmcnt(5)
    v_mfma_f32_32x32x16_bf16 v[164:179], v[140:143], v[20:23], v[164:179]
    s_add_u32 s43, s41, s30
    buffer_load_dwordx4 v[80:83], v1, s[8:11], s43 offen offset:0 sc1
    buffer_load_dwordx4 v[84:87], v1, s[8:11], s43 offen offset:1024 sc1
    ds_read_b128 v[136:139], v11 offset:4096
    v_mfma_f32_32x32x16_bf16 v[180:195], v[20:23], v[144:147], v[180:195]
    buffer_load_dwordx4 v[88:91], v1, s[8:11], s43 offen offset:2048 sc1
    buffer_load_dwordx4 v[92:95], v1, s[8:11], s43 offen offset:3072 sc1
    ds_read_b128 v[140:143], v10 offset:34816
    s_waitcnt lgkmcnt(5)
    v_mfma_f32_32x32x16_bf16 v[164:179], v[148:151], v[24:27], v[164:179]
    s_add_u32 s43, s41, s31
    buffer_load_dwordx4 v[96:99], v1, s[8:11], s43 offen offset:0 sc1
    buffer_load_dwordx4 v[100:103], v1, s[8:11], s43 offen offset:1024 sc1
    ds_read_b128 v[144:147], v11 offset:5120
    v_mfma_f32_32x32x16_bf16 v[180:195], v[24:27], v[152:155], v[180:195]
    buffer_load_dwordx4 v[104:107], v1, s[8:11], s43 offen offset:2048 sc1
    buffer_load_dwordx4 v[108:111], v1, s[8:11], s43 offen offset:3072 sc1
    ds_read_b128 v[148:151], v10 offset:35840
    s_waitcnt lgkmcnt(5)
    v_mfma_f32_32x32x16_bf16 v[164:179], v[156:159], v[28:31], v[164:179]
    s_add_u32 s43, s41, s32
    buffer_load_dwordx4 v[112:115], v1, s[8:11], s43 offen offset:0 sc1
    ds_read_b128 v[152:155], v11 offset:6144
    v_mfma_f32_32x32x16_bf16 v[180:195], v[28:31], v[160:163], v[180:195]
    buffer_load_dwordx4 v[116:119], v1, s[8:11], s43 offen offset:1024 sc1
    ds_read_b128 v[156:159], v10 offset:36864
    s_waitcnt vmcnt(25)
    s_waitcnt lgkmcnt(5)
    v_mfma_f32_32x32x16_bf16 v[164:179], v[132:135], v[32:35], v[164:179]
    buffer_load_dwordx4 v[120:123], v1, s[8:11], s43 offen offset:2048 sc1
    ds_read_b128 v[160:163], v11 offset:7168
    v_mfma_f32_32x32x16_bf16 v[180:195], v[32:35], v[136:139], v[180:195]
    buffer_load_dwordx4 v[124:127], v1, s[8:11], s43 offen offset:3072 sc1
    ds_read_b128 v[132:135], v10 offset:37888
    s_waitcnt lgkmcnt(5)
    v_mfma_f32_32x32x16_bf16 v[164:179], v[140:143], v[36:39], v[164:179]
    ds_read_b128 v[136:139], v11 offset:8192
    v_mfma_f32_32x32x16_bf16 v[180:195], v[36:39], v[144:147], v[180:195]
    ds_read_b128 v[140:143], v10 offset:38912
    s_waitcnt lgkmcnt(5)
    v_mfma_f32_32x32x16_bf16 v[164:179], v[148:151], v[40:43], v[164:179]
    ds_read_b128 v[144:147], v11 offset:9216
    v_mfma_f32_32x32x16_bf16 v[180:195], v[40:43], v[152:155], v[180:195]
    ds_read_b128 v[148:151], v10 offset:39936
    s_waitcnt lgkmcnt(5)
    v_mfma_f32_32x32x16_bf16 v[164:179], v[156:159], v[44:47], v[164:179]
    ds_read_b128 v[152:155], v11 offset:10240
    v_mfma_f32_32x32x16_bf16 v[180:195], v[44:47], v[160:163], v[180:195]
    ds_read_b128 v[156:159], v10 offset:40960
    s_waitcnt vmcnt(23)
    s_waitcnt lgkmcnt(5)
    v_mfma_f32_32x32x16_bf16 v[164:179], v[132:135], v[48:51], v[164:179]
    s_waitcnt vmcnt(16)
    v_add_f32 v3, v212, v214
    v_add_f32 v4, v213, v215
    ds_read_b128 v[160:163], v11 offset:11264
    v_mfma_f32_32x32x16_bf16 v[180:195], v[48:51], v[136:139], v[180:195]
    v_add_f32 v3, v3, v216
    v_add_f32 v4, v4, v217
    v_add_f32 v3, v3, v218
    ds_read_b128 v[132:135], v10 offset:41984
    s_waitcnt lgkmcnt(5)
    v_mfma_f32_32x32x16_bf16 v[164:179], v[140:143], v[52:55], v[164:179]
    v_add_f32 v4, v4, v219
    v_add_f32 v3, v3, v220
    v_add_f32 v4, v4, v221
    ds_read_b128 v[136:139], v11 offset:12288
    v_mfma_f32_32x32x16_bf16 v[180:195], v[52:55], v[144:147], v[180:195]
    v_add_f32 v3, v3, v222
    v_add_f32 v4, v4, v223
    v_add_f32 v3, v3, v224
    ds_read_b128 v[140:143], v10 offset:43008
    s_waitcnt lgkmcnt(5)
    v_mfma_f32_32x32x16_bf16 v[164:179], v[148:151], v[56:59], v[164:179]
    v_add_f32 v4, v4, v225
    v_mov_b32 v228, v3
    v_mov_b32 v229, v4
    ds_read_b128 v[144:147], v11 offset:13312
    v_mfma_f32_32x32x16_bf16 v[180:195], v[56:59], v[152:155], v[180:195]
    v_permlane32_swap_b32 v228, v3
    v_permlane32_swap_b32 v229, v4
    v_add_f32 v3, v228, v3
    ds_read_b128 v[148:151], v10 offset:44032
    s_waitcnt lgkmcnt(5)
    v_mfma_f32_32x32x16_bf16 v[164:179], v[156:159], v[60:63], v[164:179]
    v_add_f32 v4, v229, v4
    v_mul_f32 v3, 0xbb124925, v3
    v_mul_f32 v4, 0x3b124925, v4
    ds_read_b128 v[152:155], v11 offset:14336
    v_mfma_f32_32x32x16_bf16 v[180:195], v[60:63], v[160:163], v[180:195]
    v_fma_f32 v4, -v3, v3, v4
    v_max_f32 v4, 0, v4
    v_add_f32 v9, 0x3727c5ac, v4
    ds_read_b128 v[156:159], v10 offset:45056
    s_waitcnt vmcnt(12)
    s_waitcnt lgkmcnt(5)
    v_mfma_f32_32x32x16_bf16 v[164:179], v[132:135], v[64:67], v[164:179]
    v_cvt_pk_bf16_f32 v128, v3, v3
    v_rsq_f32 v6, v9
    v_lshlrev_b32 v228, 16, v128
    ds_read_b128 v[160:163], v11 offset:15360
    v_mfma_f32_32x32x16_bf16 v[180:195], v[64:67], v[136:139], v[180:195]
    v_sub_f32 v228, v3, v228
    v_cvt_pk_bf16_f32 v129, v228, v228
    v_mov_b32 v130, v128
    ds_read_b128 v[132:135], v10 offset:46080
    s_waitcnt lgkmcnt(5)
    v_mfma_f32_32x32x16_bf16 v[164:179], v[140:143], v[68:71], v[164:179]
    v_mov_b32 v131, v129
    v_mul_f32 v7, 0x3e8b97f6, v6
    s_lshl_b32 s45, s13, 7
    ds_read_b128 v[136:139], v11 offset:16384
    v_mfma_f32_32x32x16_bf16 v[180:195], v[68:71], v[144:147], v[180:195]
    s_add_u32 s45, s45, 138240
    v_and_b32 v228, 31, v0
    v_lshlrev_b32 v228, 2, v228
    ds_read_b128 v[140:143], v10 offset:47104
    s_waitcnt lgkmcnt(5)
    v_mfma_f32_32x32x16_bf16 v[164:179], v[148:151], v[72:75], v[164:179]
    v_add_u32 v228, s45, v228
    ds_write_b32 v228, v6
    v_lshrrev_b32 v229, 5, v0
    ds_read_b128 v[144:147], v11 offset:17408
    v_mfma_f32_32x32x16_bf16 v[180:195], v[72:75], v[152:155], v[180:195]
    v_lshlrev_b32 v229, 4, v229
    v_add_u32 v229, s45, v229
    ds_read_b128 v[212:215], v229 offset:0
    ds_read_b128 v[148:151], v10 offset:48128
    s_waitcnt lgkmcnt(7)
    v_mfma_f32_32x32x16_bf16 v[164:179], v[156:159], v[76:79], v[164:179]
    ds_read_b128 v[216:219], v229 offset:32
    ds_read_b128 v[220:223], v229 offset:64
    ds_read_b128 v[224:227], v229 offset:96
    ds_read_b128 v[152:155], v11 offset:18432
    v_mfma_f32_32x32x16_bf16 v[180:195], v[76:79], v[160:163], v[180:195]
    ds_read_b128 v[156:159], v10 offset:49152
    s_waitcnt vmcnt(8)
    s_waitcnt lgkmcnt(10)
    v_mfma_f32_32x32x16_bf16 v[164:179], v[132:135], v[80:83], v[164:179]
    ds_read_b128 v[160:163], v11 offset:19456
    v_mfma_f32_32x32x16_bf16 v[180:195], v[80:83], v[136:139], v[180:195]
    ds_read_b128 v[132:135], v10 offset:50176
    s_waitcnt lgkmcnt(9)
    v_mfma_f32_32x32x16_bf16 v[164:179], v[140:143], v[84:87], v[164:179]
    ds_read_b128 v[136:139], v11 offset:20480
    v_mfma_f32_32x32x16_bf16 v[180:195], v[84:87], v[144:147], v[180:195]
    ds_read_b128 v[140:143], v10 offset:51200
    s_waitcnt lgkmcnt(5)
    v_mfma_f32_32x32x16_bf16 v[164:179], v[148:151], v[88:91], v[164:179]
    ds_read_b128 v[144:147], v11 offset:21504
    v_mfma_f32_32x32x16_bf16 v[180:195], v[88:91], v[152:155], v[180:195]
    ds_read_b128 v[148:151], v10 offset:52224
    s_waitcnt lgkmcnt(5)
    v_mfma_f32_32x32x16_bf16 v[164:179], v[156:159], v[92:95], v[164:179]
    ds_read_b128 v[152:155], v11 offset:22528
    v_mfma_f32_32x32x16_bf16 v[180:195], v[92:95], v[160:163], v[180:195]
    ds_read_b128 v[156:159], v10 offset:53248
    s_waitcnt vmcnt(4)
    s_waitcnt lgkmcnt(5)
    v_mfma_f32_32x32x16_bf16 v[164:179], v[132:135], v[96:99], v[164:179]
    ds_read_b128 v[160:163], v11 offset:23552
    v_mfma_f32_32x32x16_bf16 v[180:195], v[96:99], v[136:139], v[180:195]
    ds_read_b128 v[132:135], v10 offset:54272
    s_waitcnt lgkmcnt(5)
    v_mfma_f32_32x32x16_bf16 v[164:179], v[140:143], v[100:103], v[164:179]
    ds_read_b128 v[136:139], v11 offset:24576
    v_mfma_f32_32x32x16_bf16 v[180:195], v[100:103], v[144:147], v[180:195]
    ds_read_b128 v[140:143], v10 offset:55296
    s_waitcnt lgkmcnt(5)
    v_mfma_f32_32x32x16_bf16 v[164:179], v[148:151], v[104:107], v[164:179]
    ds_read_b128 v[144:147], v11 offset:25600
    v_mfma_f32_32x32x16_bf16 v[180:195], v[104:107], v[152:155], v[180:195]
    ds_read_b128 v[148:151], v10 offset:56320
    s_waitcnt lgkmcnt(5)
    v_mfma_f32_32x32x16_bf16 v[164:179], v[156:159], v[108:111], v[164:179]
    ds_read_b128 v[152:155], v11 offset:26624
    v_mfma_f32_32x32x16_bf16 v[180:195], v[108:111], v[160:163], v[180:195]
    ds_read_b128 v[156:159], v10 offset:57344
    s_waitcnt vmcnt(0)
    s_waitcnt lgkmcnt(5)
    v_mfma_f32_32x32x16_bf16 v[164:179], v[132:135], v[112:115], v[164:179]
    ds_read_b128 v[160:163], v11 offset:27648
    v_mfma_f32_32x32x16_bf16 v[180:195], v[112:115], v[136:139], v[180:195]
    ds_read_b128 v[132:135], v10 offset:58368
    s_waitcnt lgkmcnt(5)
    v_mfma_f32_32x32x16_bf16 v[164:179], v[140:143], v[116:119], v[164:179]
    ds_read_b128 v[136:139], v11 offset:28672
    v_mfma_f32_32x32x16_bf16 v[180:195], v[116:119], v[144:147], v[180:195]
    ds_read_b128 v[140:143], v10 offset:0
    s_waitcnt lgkmcnt(5)
    v_mfma_f32_32x32x16_bf16 v[164:179], v[148:151], v[120:123], v[164:179]
    ds_read_b128 v[144:147], v10 offset:1024
    v_mfma_f32_32x32x16_bf16 v[180:195], v[120:123], v[152:155], v[180:195]
    ds_read_b128 v[148:151], v10 offset:2048
    s_waitcnt lgkmcnt(5)
    v_mfma_f32_32x32x16_bf16 v[164:179], v[156:159], v[124:127], v[164:179]
    ds_read_b128 v[152:155], v10 offset:3072
    v_mfma_f32_32x32x16_bf16 v[180:195], v[124:127], v[160:163], v[180:195]
    ds_read_b128 v[156:159], v10 offset:4096
    s_waitcnt lgkmcnt(5)
    v_mfma_f32_32x32x16_bf16 v[164:179], v[132:135], v[128:131], v[164:179]
    ds_read_b128 v[160:163], v10 offset:5120
    v_mfma_f32_32x32x16_bf16 v[180:195], v[128:131], v[136:139], v[180:195]
    ds_read_b128 v[132:135], v10 offset:6144
    s_waitcnt lgkmcnt(5)
    v_mfma_f32_32x32x16_bf16 v[196:211], v[140:143], v[16:19], 0
    ds_read_b128 v[136:139], v10 offset:7168
    v_mfma_f32_32x32x16_bf16 v[196:211], v[144:147], v[20:23], v[196:211]
    v_and_b32 v229, 31, v0
    v_cmp_eq_u32 vcc, 28, v229
    s_nop 2
    v_mul_f32 v164, v164, v6
    v_mul_f32 v165, v165, v6
    v_mul_f32 v166, v166, v6
    v_mul_f32 v167, v167, v6
    v_mul_f32 v168, v168, v6
    v_mul_f32 v169, v169, v6
    ds_read_b128 v[140:143], v10 offset:8192
    s_waitcnt lgkmcnt(5)
    v_mfma_f32_32x32x16_bf16 v[196:211], v[148:151], v[24:27], v[196:211]
    v_mul_f32 v170, v170, v6
    v_mul_f32 v171, v171, v6
    v_mul_f32 v172, v172, v6
    v_mul_f32 v173, v173, v6
    v_mul_f32 v174, v174, v6
    v_mul_f32 v175, v175, v6
    v_mul_f32 v176, v176, v6
    v_mul_f32 v177, v177, v6
    ds_read_b128 v[144:147], v10 offset:9216
    v_mfma_f32_32x32x16_bf16 v[196:211], v[152:155], v[28:31], v[196:211]
    v_mul_f32 v178, v178, v6
    v_mul_f32 v179, v179, v6
    v_cvt_pk_bf16_f32 v164, v164, v165
    v_cvt_pk_bf16_f32 v165, v166, v167
    v_cvt_pk_bf16_f32 v166, v168, v169
    v_cvt_pk_bf16_f32 v167, v170, v171
    v_cvt_pk_bf16_f32 v168, v172, v173
    v_cvt_pk_bf16_f32 v169, v174, v175
    ds_read_b128 v[148:151], v10 offset:10240
    s_waitcnt lgkmcnt(5)
    v_mfma_f32_32x32x16_bf16 v[196:211], v[156:159], v[32:35], v[196:211]
    v_cvt_pk_bf16_f32 v170, v176, v177
    v_cvt_pk_bf16_f32 v171, v178, v179
    buffer_store_dwordx4 v[164:167], v1, s[8:11], s46 offen offset:0 sc1
    buffer_store_dwordx4 v[168:171], v1, s[8:11], s46 offen offset:1024 sc1
    v_mul_f32 v180, v180, v212
    v_mul_f32 v181, v181, v213
    v_mul_f32 v182, v182, v214
    v_mul_f32 v183, v183, v215
    ds_read_b128 v[152:155], v10 offset:11264
    v_mfma_f32_32x32x16_bf16 v[196:211], v[160:163], v[36:39], v[196:211]
    v_mul_f32 v184, v184, v216
    v_mul_f32 v185, v185, v217
    v_mul_f32 v186, v186, v218
    v_mul_f32 v187, v187, v219
    v_mul_f32 v188, v188, v220
    v_mul_f32 v189, v189, v221
    v_mul_f32 v190, v190, v222
    v_mul_f32 v191, v191, v223
    ds_read_b128 v[156:159], v10 offset:12288
    s_waitcnt lgkmcnt(5)
    v_mfma_f32_32x32x16_bf16 v[196:211], v[132:135], v[40:43], v[196:211]
    v_mul_f32 v192, v192, v224
    v_mul_f32 v193, v193, v225
    v_mul_f32 v194, v194, v226
    v_mul_f32 v195, v195, v227
    v_cvt_pk_bf16_f32 v180, v180, v181
    v_cvt_pk_bf16_f32 v181, v182, v183
    v_cvt_pk_bf16_f32 v182, v184, v185
    v_cvt_pk_bf16_f32 v183, v186, v187
    ds_read_b128 v[160:163], v10 offset:13312
    v_mfma_f32_32x32x16_bf16 v[196:211], v[136:139], v[44:47], v[196:211]
    v_cvt_pk_bf16_f32 v184, v188, v189
    v_cvt_pk_bf16_f32 v185, v190, v191
    v_cvt_pk_bf16_f32 v186, v192, v193
    v_cvt_pk_bf16_f32 v187, v194, v195
    v_cndmask_b32 v180, v180, v5, vcc
    v_cndmask_b32 v181, v181, v5, vcc
    v_cndmask_b32 v182, v182, v5, vcc
    v_cndmask_b32 v183, v183, v5, vcc
    ds_read_b128 v[132:135], v10 offset:14336
    s_waitcnt lgkmcnt(5)
    v_mfma_f32_32x32x16_bf16 v[196:211], v[140:143], v[48:51], v[196:211]
    v_cndmask_b32 v184, v184, v5, vcc
    v_cndmask_b32 v185, v185, v5, vcc
    v_cndmask_b32 v186, v186, v5, vcc
    v_cndmask_b32 v187, v187, v5, vcc
    buffer_store_dwordx4 v[180:183], v1, s[8:11], s46 offen offset:2048 sc1
    buffer_store_dwordx4 v[184:187], v1, s[8:11], s46 offen offset:3072 sc1
    ds_write_b128 v13, v[164:167] offset:32768
    ds_write_b128 v13, v[168:171] offset:33792
    ds_read_b128 v[136:139], v10 offset:15360
    v_mfma_f32_32x32x16_bf16 v[196:211], v[144:147], v[52:55], v[196:211]
    ds_write_b128 v13, v[180:183] offset:34816
    ds_write_b128 v13, v[184:187] offset:35840
    ds_read_b128 v[140:143], v10 offset:16384
    s_waitcnt lgkmcnt(9)
    v_mfma_f32_32x32x16_bf16 v[196:211], v[148:151], v[56:59], v[196:211]
    ds_read_b128 v[144:147], v10 offset:17408
    v_mfma_f32_32x32x16_bf16 v[196:211], v[152:155], v[60:63], v[196:211]
    ds_read_b128 v[148:151], v10 offset:18432
    s_waitcnt lgkmcnt(9)
    v_mfma_f32_32x32x16_bf16 v[196:211], v[156:159], v[64:67], v[196:211]
    ds_read_b128 v[152:155], v10 offset:19456
    v_mfma_f32_32x32x16_bf16 v[196:211], v[160:163], v[68:71], v[196:211]
    ds_read_b128 v[156:159], v10 offset:20480
    s_waitcnt lgkmcnt(7)
    v_mfma_f32_32x32x16_bf16 v[196:211], v[132:135], v[72:75], v[196:211]
    ds_read_b128 v[160:163], v10 offset:21504
    v_mfma_f32_32x32x16_bf16 v[196:211], v[136:139], v[76:79], v[196:211]
    ds_read_b128 v[132:135], v10 offset:22528
    s_waitcnt lgkmcnt(5)
    v_mfma_f32_32x32x16_bf16 v[196:211], v[140:143], v[80:83], v[196:211]
    ds_read_b128 v[136:139], v10 offset:23552
    v_mfma_f32_32x32x16_bf16 v[196:211], v[144:147], v[84:87], v[196:211]
    ds_read_b128 v[140:143], v10 offset:24576
    s_waitcnt lgkmcnt(5)
    v_mfma_f32_32x32x16_bf16 v[196:211], v[148:151], v[88:91], v[196:211]
    ds_read_b128 v[144:147], v10 offset:25600
    v_mfma_f32_32x32x16_bf16 v[196:211], v[152:155], v[92:95], v[196:211]
    ds_read_b128 v[148:151], v10 offset:26624
    s_waitcnt lgkmcnt(5)
    v_mfma_f32_32x32x16_bf16 v[196:211], v[156:159], v[96:99], v[196:211]
    ds_read_b128 v[152:155], v10 offset:27648
    v_mfma_f32_32x32x16_bf16 v[196:211], v[160:163], v[100:103], v[196:211]
    v_mul_u32_u24 v255, 4100, v0
    v_mov_b32 v254, 1
    v_mov_b32 v253, 163776
    s_waitcnt vmcnt(0)
    s_mov_b64 exec, 1
    ds_add_rtn_u32 v253, v253, v254
    s_waitcnt lgkmcnt(0)
    v_readfirstlane_b32 s62, v253
    s_mov_b64 exec, 3
    s_and_b32 s62, s62, 3
    s_cmp_lg_u32 s62, 3
    s_cbranch_scc1 mega_kernel_c_sig60
    buffer_store_dword v254, v255, s[8:11], s48 offen sc1
mega_kernel_c_sig60:
    s_mov_b64 exec, -1
    s_mov_b64 exec, 1
    v_mov_b32 v253, 163780
    v_mov_b32 v254, 1
    ds_add_u32 v253, v254
    s_mov_b64 exec, -1
    ds_read_b128 v[156:159], v10 offset:28672
    v_mfma_f32_32x32x16_bf16 v[196:211], v[132:135], v[104:107], v[196:211]
    v_mfma_f32_32x32x16_bf16 v[196:211], v[136:139], v[108:111], v[196:211]
    v_mfma_f32_32x32x16_bf16 v[196:211], v[140:143], v[112:115], v[196:211]
    v_mfma_f32_32x32x16_bf16 v[196:211], v[144:147], v[116:119], v[196:211]
    v_mfma_f32_32x32x16_bf16 v[196:211], v[148:151], v[120:123], v[196:211]
    v_mfma_f32_32x32x16_bf16 v[196:211], v[152:155], v[124:127], v[196:211]
    s_waitcnt lgkmcnt(0)
    v_mfma_f32_32x32x16_bf16 v[196:211], v[156:159], v[128:131], v[196:211]
    s_nop 11
    v_mul_f32 v196, v196, v7
    v_mul_f32 v197, v197, v7
    v_mul_f32 v198, v198, v7
    v_mul_f32 v199, v199, v7
    v_mul_f32 v200, v200, v7
    v_mul_f32 v201, v201, v7
    v_mul_f32 v202, v202, v7
    v_mul_f32 v203, v203, v7
    v_mul_f32 v204, v204, v7
    v_mul_f32 v205, v205, v7
    v_mul_f32 v206, v206, v7
    v_mul_f32 v207, v207, v7
    v_mul_f32 v208, v208, v7
    v_mul_f32 v209, v209, v7
    v_mul_f32 v210, v210, v7
    v_mul_f32 v211, v211, v7
    v_cvt_pk_bf16_f32 v244, v196, v197
    v_cvt_pk_bf16_f32 v245, v198, v199
    v_cvt_pk_bf16_f32 v246, v200, v201
    v_cvt_pk_bf16_f32 v247, v202, v203
    v_cvt_pk_bf16_f32 v248, v204, v205
    v_cvt_pk_bf16_f32 v249, v206, v207
    v_cvt_pk_bf16_f32 v250, v208, v209
    v_cvt_pk_bf16_f32 v251, v210, v211
    s_waitcnt lgkmcnt(0)
    s_lshl_b32 s40, s18, 2
    s_add_u32 s40, s40, s13
    s_lshl_b32 s41, s40, 5
    s_lshl_b32 s42, s19, 1
    s_add_u32 s41, s41, s42
    s_lshl_b32 s41, s41, 10
    s_add_u32 s41, s41, 50331648
    ds_read_b128 v[80:83], v13 offset:32768
    ds_read_b128 v[84:87], v13 offset:33792
    v_and_b32 v3, 31, v0
    v_lshrrev_b32 v4, 5, v0
    v_lshlrev_b32 v4, 2, v4
    v_sub_u32 v3, v3, v4
    v_mov_b32 v5, 0xf149f2ca
    v_cmp_ge_i32 s[44:45], v3, 0
    v_cmp_ge_i32 s[46:47], v3, 1
    v_cmp_ge_i32 s[48:49], v3, 2
    v_cmp_ge_i32 s[50:51], v3, 3
    v_cndmask_b32 v152, v5, 0, s[44:45]
    v_cndmask_b32 v168, 0, v5, s[44:45]
    v_cndmask_b32 v153, v5, 0, s[46:47]
    v_cndmask_b32 v169, 0, v5, s[46:47]
    v_cndmask_b32 v154, v5, 0, s[48:49]
    v_cndmask_b32 v170, 0, v5, s[48:49]
    v_cndmask_b32 v155, v5, 0, s[50:51]
    v_cndmask_b32 v171, 0, v5, s[50:51]
    v_cmp_ge_i32 s[44:45], v3, 8
    v_cmp_ge_i32 s[46:47], v3, 9
    v_cmp_ge_i32 s[48:49], v3, 10
    v_cmp_ge_i32 s[50:51], v3, 11
    v_cndmask_b32 v156, v5, 0, s[44:45]
    v_cndmask_b32 v172, 0, v5, s[44:45]
    v_cndmask_b32 v157, v5, 0, s[46:47]
    v_cndmask_b32 v173, 0, v5, s[46:47]
    v_cndmask_b32 v158, v5, 0, s[48:49]
    v_cndmask_b32 v174, 0, v5, s[48:49]
    v_cndmask_b32 v159, v5, 0, s[50:51]
    v_cndmask_b32 v175, 0, v5, s[50:51]
    v_cmp_ge_i32 s[44:45], v3, 16
    v_cmp_ge_i32 s[46:47], v3, 17
    v_cmp_ge_i32 s[48:49], v3, 18
    v_cmp_ge_i32 s[50:51], v3, 19
    v_cndmask_b32 v160, v5, 0, s[44:45]
    v_cndmask_b32 v176, 0, v5, s[44:45]
    v_cndmask_b32 v161, v5, 0, s[46:47]
    v_cndmask_b32 v177, 0, v5, s[46:47]
    v_cndmask_b32 v162, v5, 0, s[48:49]
    v_cndmask_b32 v178, 0, v5, s[48:49]
    v_cndmask_b32 v163, v5, 0, s[50:51]
    v_cndmask_b32 v179, 0, v5, s[50:51]
    v_cmp_ge_i32 s[44:45], v3, 24
    v_cmp_ge_i32 s[46:47], v3, 25
    v_cmp_ge_i32 s[48:49], v3, 26
    v_cmp_ge_i32 s[50:51], v3, 27
    v_cndmask_b32 v164, v5, 0, s[44:45]
    v_cndmask_b32 v180, 0, v5, s[44:45]
    v_cndmask_b32 v165, v5, 0, s[46:47]
    v_cndmask_b32 v181, 0, v5, s[46:47]
    v_cndmask_b32 v166, v5, 0, s[48:49]
    v_cndmask_b32 v182, 0, v5, s[48:49]
    v_cndmask_b32 v167, v5, 0, s[50:51]
    v_cndmask_b32 v183, 0, v5, s[50:51]
    v_mov_b32 v184, 0
    v_mov_b32 v185, 0
    v_mov_b32 v186, 0
    v_mov_b32 v187, 0
    v_mov_b32 v188, 0
    v_mov_b32 v189, 0
    v_mov_b32 v190, 0
    v_mov_b32 v191, 0
    v_mov_b32 v192, 0
    v_mov_b32 v193, 0
    v_mov_b32 v194, 0
    v_mov_b32 v195, 0
    v_mov_b32 v196, 0
    v_mov_b32 v197, 0
    v_mov_b32 v198, 0
    v_mov_b32 v199, 0
    s_cmp_ge_u32 s40, 8
    s_cbranch_scc1 mega_kernel_c_b0ok61
    v_mov_b32 v168, v5
    v_mov_b32 v169, v5
    v_mov_b32 v170, v5
    v_mov_b32 v171, v5
    v_mov_b32 v172, v5
    v_mov_b32 v173, v5
    v_mov_b32 v174, v5
    v_mov_b32 v175, v5
    v_mov_b32 v176, v5
    v_mov_b32 v177, v5
    v_mov_b32 v178, v5
    v_mov_b32 v179, v5
    v_mov_b32 v180, v5
    v_mov_b32 v181, v5
    v_mov_b32 v182, v5
    v_mov_b32 v183, v5
mega_kernel_c_b0ok61:
    s_nop 1
    s_waitcnt lgkmcnt(1)
    v_mfma_f32_32x32x16_bf16 v[88:103], v[80:83], v[244:247], v[152:167]
    s_waitcnt lgkmcnt(0)
    v_mfma_f32_32x32x16_bf16 v[88:103], v[84:87], v[248:251], v[88:103]
    s_nop 11
    v_max3_f32 v6, v88, v89, v90
    v_max3_f32 v7, v91, v92, v93
    v_max3_f32 v6, v6, v94, v95
    v_max3_f32 v7, v7, v96, v97
    v_max3_f32 v6, v6, v98, v99
    v_max3_f32 v7, v7, v100, v101
    v_max3_f32 v6, v6, v102, v103
    s_barrier
    ds_read_b128 v[72:75], v13 offset:28672
    ds_read_b128 v[76:79], v13 offset:29696
    ds_read_b128 v[64:67], v13 offset:24576
    ds_read_b128 v[68:71], v13 offset:25600
    ds_read_b128 v[56:59], v13 offset:20480
    ds_read_b128 v[60:63], v13 offset:21504
    ds_read_b128 v[48:51], v13 offset:16384
    ds_read_b128 v[52:55], v13 offset:17408
    s_cmp_lg_u32 s40, 0
    s_cbranch_scc1 mega_kernel_c_inv62
    s_nop 7
    v_mov_b32 v184, v5
    v_mov_b32 v185, v5
    v_mov_b32 v186, v5
    v_mov_b32 v187, v5
    v_mov_b32 v188, v5
    v_mov_b32 v189, v5
    v_mov_b32 v190, v5
    v_mov_b32 v191, v5
    v_mov_b32 v192, v5
    v_mov_b32 v193, v5
    v_mov_b32 v194, v5
    v_mov_b32 v195, v5
    v_mov_b32 v196, v5
    v_mov_b32 v197, v5
    v_mov_b32 v198, v5
    v_mov_b32 v199, v5
    s_nop 1
mega_kernel_c_inv62:
    s_waitcnt lgkmcnt(7)
    v_mfma_f32_32x32x16_bf16 v[104:119], v[72:75], v[244:247], v[184:199]
    s_waitcnt lgkmcnt(6)
    v_mfma_f32_32x32x16_bf16 v[104:119], v[76:79], v[248:251], v[104:119]
    ds_read_b128 v[40:43], v13 offset:12288
    ds_read_b128 v[44:47], v13 offset:13312
    s_cmp_lg_u32 s40, 1
    s_cbranch_scc1 mega_kernel_c_inv63
    s_nop 7
    v_mov_b32 v184, v5
    v_mov_b32 v185, v5
    v_mov_b32 v186, v5
    v_mov_b32 v187, v5
    v_mov_b32 v188, v5
    v_mov_b32 v189, v5
    v_mov_b32 v190, v5
    v_mov_b32 v191, v5
    v_mov_b32 v192, v5
    v_mov_b32 v193, v5
    v_mov_b32 v194, v5
    v_mov_b32 v195, v5
    v_mov_b32 v196, v5
    v_mov_b32 v197, v5
    v_mov_b32 v198, v5
    v_mov_b32 v199, v5
    s_nop 1
mega_kernel_c_inv63:
    s_waitcnt lgkmcnt(7)
    v_mfma_f32_32x32x16_bf16 v[120:135], v[64:67], v[244:247], v[184:199]
    s_waitcnt lgkmcnt(6)
    v_mfma_f32_32x32x16_bf16 v[120:135], v[68:71], v[248:251], v[120:135]
    ds_read_b128 v[32:35], v13 offset:8192
    ds_read_b128 v[36:39], v13 offset:9216
    s_cmp_lg_u32 s40, 2
    s_cbranch_scc1 mega_kernel_c_inv64
    s_nop 7
    v_mov_b32 v184, v5
    v_mov_b32 v185, v5
    v_mov_b32 v186, v5
    v_mov_b32 v187, v5
    v_mov_b32 v188, v5
    v_mov_b32 v189, v5
    v_mov_b32 v190, v5
    v_mov_b32 v191, v5
    v_mov_b32 v192, v5
    v_mov_b32 v193, v5
    v_mov_b32 v194, v5
    v_mov_b32 v195, v5
    v_mov_b32 v196, v5
    v_mov_b32 v197, v5
    v_mov_b32 v198, v5
    v_mov_b32 v199, v5
    s_nop 1
mega_kernel_c_inv64:
    s_waitcnt lgkmcnt(7)
    v_mfma_f32_32x32x16_bf16 v[136:151], v[56:59], v[244:247], v[184:199]
    v_max3_f32 v6, v6, v104, v105
    v_max3_f32 v7, v7, v106, v107
    v_max3_f32 v6, v6, v108, v109
    v_max3_f32 v7, v7, v110, v111
    s_waitcnt lgkmcnt(6)
    v_mfma_f32_32x32x16_bf16 v[136:151], v[60:63], v[248:251], v[136:151]
    v_max3_f32 v6, v6, v112, v113
    v_max3_f32 v7, v7, v114, v115
    v_max3_f32 v6, v6, v116, v117
    v_max3_f32 v7, v7, v118, v119
    ds_read_b128 v[24:27], v13 offset:4096
    ds_read_b128 v[28:31], v13 offset:5120
    s_cmp_lg_u32 s40, 3
    s_cbranch_scc1 mega_kernel_c_inv65
    s_nop 7
    v_mov_b32 v184, v5
    v_mov_b32 v185, v5
    v_mov_b32 v186, v5
    v_mov_b32 v187, v5
    v_mov_b32 v188, v5
    v_mov_b32 v189, v5
    v_mov_b32 v190, v5
    v_mov_b32 v191, v5
    v_mov_b32 v192, v5
    v_mov_b32 v193, v5
    v_mov_b32 v194, v5
    v_mov_b32 v195, v5
    v_mov_b32 v196, v5
    v_mov_b32 v197, v5
    v_mov_b32 v198, v5
    v_mov_b32 v199, v5
    s_nop 1
mega_kernel_c_inv65:
    s_waitcnt lgkmcnt(7)
    v_mfma_f32_32x32x16_bf16 v[88:103], v[48:51], v[244:247], v[184:199]
    v_max3_f32 v6, v6, v120, v121
    v_max3_f32 v7, v7, v122, v123
    v_max3_f32 v6, v6, v124, v125
    v_max3_f32 v7, v7, v126, v127
    s_waitcnt lgkmcnt(6)
    v_mfma_f32_32x32x16_bf16 v[88:103], v[52:55], v[248:251], v[88:103]
    v_max3_f32 v6, v6, v128, v129
    v_max3_f32 v7, v7, v130, v131
    v_max3_f32 v6, v6, v132, v133
    v_max3_f32 v7, v7, v134, v135
    ds_read_b128 v[16:19], v13 offset:0
    ds_read_b128 v[20:23], v13 offset:1024
    s_cmp_lg_u32 s40, 4
    s_cbranch_scc1 mega_kernel_c_inv66
    s_nop 7
    v_mov_b32 v184, v5
    v_mov_b32 v185, v5
    v_mov_b32 v186, v5
    v_mov_b32 v187, v5
    v_mov_b32 v188, v5
    v_mov_b32 v189, v5
    v_mov_b32 v190, v5
    v_mov_b32 v191, v5
    v_mov_b32 v192, v5
    v_mov_b32 v193, v5
    v_mov_b32 v194, v5
    v_mov_b32 v195, v5
    v_mov_b32 v196, v5
    v_mov_b32 v197, v5
    v_mov_b32 v198, v5
    v_mov_b32 v199, v5
    s_nop 1
mega_kernel_c_inv66:
    s_waitcnt lgkmcnt(7)
    v_mfma_f32_32x32x16_bf16 v[104:119], v[40:43], v[244:247], v[184:199]
    v_max3_f32 v6, v6, v136, v137
    v_max3_f32 v7, v7, v138, v139
    v_max3_f32 v6, v6, v140, v141
    v_max3_f32 v7, v7, v142, v143
    s_waitcnt lgkmcnt(6)
    v_mfma_f32_32x32x16_bf16 v[104:119], v[44:47], v[248:251], v[104:119]
    v_max3_f32 v6, v6, v144, v145
    v_max3_f32 v7, v7, v146, v147
    v_max3_f32 v6, v6, v148, v149
    v_max3_f32 v7, v7, v150, v151
    s_cmp_lg_u32 s40, 5
    s_cbranch_scc1 mega_kernel_c_inv67
    s_nop 7
    v_mov_b32 v184, v5
    v_mov_b32 v185, v5
    v_mov_b32 v186, v5
    v_mov_b32 v187, v5
    v_mov_b32 v188, v5
    v_mov_b32 v189, v5
    v_mov_b32 v190, v5
    v_mov_b32 v191, v5
    v_mov_b32 v192, v5
    v_mov_b32 v193, v5
    v_mov_b32 v194, v5
    v_mov_b32 v195, v5
    v_mov_b32 v196, v5
    v_mov_b32 v197, v5
    v_mov_b32 v198, v5
    v_mov_b32 v199, v5
    s_nop 1
mega_kernel_c_inv67:
    s_waitcnt lgkmcnt(5)
    v_mfma_f32_32x32x16_bf16 v[120:135], v[32:35], v[244:247], v[184:199]
    v_max3_f32 v6, v6, v88, v89
    v_max3_f32 v7, v7, v90, v91
    v_max3_f32 v6, v6, v92, v93
    v_max3_f32 v7, v7, v94, v95
    s_waitcnt lgkmcnt(4)
    v_mfma_f32_32x32x16_bf16 v[120:135], v[36:39], v[248:251], v[120:135]
    v_max3_f32 v6, v6, v96, v97
    v_max3_f32 v7, v7, v98, v99
    v_max3_f32 v6, v6, v100, v101
    v_max3_f32 v7, v7, v102, v103
    s_cmp_lg_u32 s40, 6
    s_cbranch_scc1 mega_kernel_c_inv68
    s_nop 7
    v_mov_b32 v184, v5
    v_mov_b32 v185, v5
    v_mov_b32 v186, v5
    v_mov_b32 v187, v5
    v_mov_b32 v188, v5
    v_mov_b32 v189, v5
    v_mov_b32 v190, v5
    v_mov_b32 v191, v5
    v_mov_b32 v192, v5
    v_mov_b32 v193, v5
    v_mov_b32 v194, v5
    v_mov_b32 v195, v5
    v_mov_b32 v196, v5
    v_mov_b32 v197, v5
    v_mov_b32 v198, v5
    v_mov_b32 v199, v5
    s_nop 1
mega_kernel_c_inv68:
    s_waitcnt lgkmcnt(3)
    v_mfma_f32_32x32x16_bf16 v[136:151], v[24:27], v[244:247], v[184:199]
    v_max3_f32 v6, v6, v104, v105
    v_max3_f32 v7, v7, v106, v107
    v_max3_f32 v6, v6, v108, v109
    v_max3_f32 v7, v7, v110, v111
    s_waitcnt lgkmcnt(2)
    v_mfma_f32_32x32x16_bf16 v[136:151], v[28:31], v[248:251], v[136:151]
    v_max3_f32 v6, v6, v112, v113
    v_max3_f32 v7, v7, v114, v115
    v_max3_f32 v6, v6, v116, v117
    v_max3_f32 v7, v7, v118, v119
    s_waitcnt lgkmcnt(1)
    v_mfma_f32_32x32x16_bf16 v[88:103], v[16:19], v[244:247], v[168:183]
    v_max3_f32 v6, v6, v120, v121
    v_max3_f32 v7, v7, v122, v123
    v_max3_f32 v6, v6, v124, v125
    v_max3_f32 v7, v7, v126, v127
    s_waitcnt lgkmcnt(0)
    v_mfma_f32_32x32x16_bf16 v[88:103], v[20:23], v[248:251], v[88:103]
    v_max3_f32 v6, v6, v128, v129
    v_max3_f32 v7, v7, v130, v131
    v_max3_f32 v6, v6, v132, v133
    v_max3_f32 v7, v7, v134, v135
    ds_read_b128 v[216:219], v13 offset:34816
    ds_read_b128 v[220:223], v13 offset:35840
    v_max3_f32 v6, v6, v136, v137
    v_max3_f32 v7, v7, v138, v139
    v_max3_f32 v6, v6, v140, v141
    v_max3_f32 v7, v7, v142, v143
    v_max3_f32 v6, v6, v144, v145
    v_max3_f32 v7, v7, v146, v147
    v_max3_f32 v6, v6, v148, v149
    v_max3_f32 v7, v7, v150, v151
    v_max3_f32 v6, v6, v88, v89
    v_max3_f32 v7, v7, v90, v91
    v_max3_f32 v6, v6, v92, v93
    v_max3_f32 v7, v7, v94, v95
    v_max3_f32 v6, v6, v96, v97
    v_max3_f32 v7, v7, v98, v99
    v_max3_f32 v6, v6, v100, v101
    v_max3_f32 v7, v7, v102, v103
    v_max_f32 v6, v6, v7
    v_mov_b32 v7, v6
    s_nop 1
    v_permlane32_swap_b32 v7, v6
    v_max_f32 v6, v6, v7
    v_sub_f32 v152, v152, v6
    v_sub_f32 v153, v153, v6
    v_sub_f32 v154, v154, v6
    v_sub_f32 v155, v155, v6
    v_sub_f32 v156, v156, v6
    v_sub_f32 v157, v157, v6
    v_sub_f32 v158, v158, v6
    v_sub_f32 v159, v159, v6
    v_sub_f32 v160, v160, v6
    v_sub_f32 v161, v161, v6
    v_sub_f32 v162, v162, v6
    v_sub_f32 v163, v163, v6
    v_sub_f32 v164, v164, v6
    v_sub_f32 v165, v165, v6
    v_sub_f32 v166, v166, v6
    v_sub_f32 v167, v167, v6
    s_nop 1
    v_mfma_f32_32x32x16_bf16 v[88:103], v[80:83], v[244:247], v[152:167]
    v_mfma_f32_32x32x16_bf16 v[88:103], v[84:87], v[248:251], v[88:103]
    v_sub_f32 v184, 0, v6
    v_sub_f32 v185, 0, v6
    v_sub_f32 v186, 0, v6
    v_sub_f32 v187, 0, v6
    v_sub_f32 v188, 0, v6
    v_sub_f32 v189, 0, v6
    v_sub_f32 v190, 0, v6
    v_sub_f32 v191, 0, v6
    v_sub_f32 v192, 0, v6
    v_sub_f32 v193, 0, v6
    v_sub_f32 v194, 0, v6
    v_sub_f32 v195, 0, v6
    v_sub_f32 v196, 0, v6
    v_sub_f32 v197, 0, v6
    v_sub_f32 v198, 0, v6
    v_sub_f32 v199, 0, v6
    v_sub_f32 v168, v168, v6
    v_sub_f32 v169, v169, v6
    v_sub_f32 v170, v170, v6
    v_sub_f32 v171, v171, v6
    v_sub_f32 v172, v172, v6
    v_sub_f32 v173, v173, v6
    v_sub_f32 v174, v174, v6
    v_sub_f32 v175, v175, v6
    v_sub_f32 v176, v176, v6
    v_sub_f32 v177, v177, v6
    v_sub_f32 v178, v178, v6
    v_sub_f32 v179, v179, v6
    v_sub_f32 v180, v180, v6
    v_sub_f32 v181, v181, v6
    v_sub_f32 v182, v182, v6
    v_sub_f32 v183, v183, v6
    s_cmp_lg_u32 s40, 0
    s_cbranch_scc1 mega_kernel_c_inv69
    s_nop 7
    v_mov_b32 v184, v5
    v_mov_b32 v185, v5
    v_mov_b32 v186, v5
    v_mov_b32 v187, v5
    v_mov_b32 v188, v5
    v_mov_b32 v189, v5
    v_mov_b32 v190, v5
    v_mov_b32 v191, v5
    v_mov_b32 v192, v5
    v_mov_b32 v193, v5
    v_mov_b32 v194, v5
    v_mov_b32 v195, v5
    v_mov_b32 v196, v5
    v_mov_b32 v197, v5
    v_mov_b32 v198, v5
    v_mov_b32 v199, v5
    s_nop 1
mega_kernel_c_inv69:
    ds_read_b128 v[224:227], v13 offset:30720
    ds_read_b128 v[228:231], v13 offset:31744
    v_mfma_f32_32x32x16_bf16 v[104:119], v[72:75], v[244:247], v[184:199]
    v_exp_f32 v88, v88
    v_exp_f32 v89, v89
    v_exp_f32 v90, v90
    v_exp_f32 v91, v91
    v_mfma_f32_32x32x16_bf16 v[104:119], v[76:79], v[248:251], v[104:119]
    v_exp_f32 v92, v92
    v_exp_f32 v93, v93
    v_exp_f32 v94, v94
    v_exp_f32 v95, v95
    v_exp_f32 v96, v96
    v_exp_f32 v97, v97
    v_exp_f32 v98, v98
    v_exp_f32 v99, v99
    v_exp_f32 v100, v100
    v_exp_f32 v101, v101
    v_exp_f32 v102, v102
    v_exp_f32 v103, v103
    v_cvt_pk_bf16_f32 v88, v88, v89
    v_cvt_pk_bf16_f32 v89, v90, v91
    v_cvt_pk_bf16_f32 v90, v92, v93
    v_cvt_pk_bf16_f32 v91, v94, v95
    v_cvt_pk_bf16_f32 v92, v96, v97
    v_cvt_pk_bf16_f32 v93, v98, v99
    v_cvt_pk_bf16_f32 v94, v100, v101
    v_cvt_pk_bf16_f32 v95, v102, v103
    s_cmp_lg_u32 s40, 1
    s_cbranch_scc1 mega_kernel_c_inv70
    s_nop 7
    v_mov_b32 v184, v5
    v_mov_b32 v185, v5
    v_mov_b32 v186, v5
    v_mov_b32 v187, v5
    v_mov_b32 v188, v5
    v_mov_b32 v189, v5
    v_mov_b32 v190, v5
    v_mov_b32 v191, v5
    v_mov_b32 v192, v5
    v_mov_b32 v193, v5
    v_mov_b32 v194, v5
    v_mov_b32 v195, v5
    v_mov_b32 v196, v5
    v_mov_b32 v197, v5
    v_mov_b32 v198, v5
    v_mov_b32 v199, v5
    s_nop 1
mega_kernel_c_inv70:
    ds_read_b128 v[232:235], v13 offset:26624
    ds_read_b128 v[236:239], v13 offset:27648
    v_mfma_f32_32x32x16_bf16 v[120:135], v[64:67], v[244:247], v[184:199]
    v_exp_f32 v104, v104
    v_exp_f32 v105, v105
    v_exp_f32 v106, v106
    v_exp_f32 v107, v107
    v_mfma_f32_32x32x16_bf16 v[120:135], v[68:71], v[248:251], v[120:135]
    v_exp_f32 v108, v108
    v_exp_f32 v109, v109
    v_exp_f32 v110, v110
    v_exp_f32 v111, v111
    s_waitcnt lgkmcnt(5)
    v_mfma_f32_32x32x16_bf16 v[200:215], v[216:219], v[88:91], 0
    v_exp_f32 v112, v112
    v_exp_f32 v113, v113
    v_exp_f32 v114, v114
    v_exp_f32 v115, v115
    s_waitcnt lgkmcnt(4)
    v_mfma_f32_32x32x16_bf16 v[200:215], v[220:223], v[92:95], v[200:215]
    v_exp_f32 v116, v116
    v_exp_f32 v117, v117
    v_exp_f32 v118, v118
    v_exp_f32 v119, v119
    v_cvt_pk_bf16_f32 v104, v104, v105
    v_cvt_pk_bf16_f32 v105, v106, v107
    v_cvt_pk_bf16_f32 v106, v108, v109
    v_cvt_pk_bf16_f32 v107, v110, v111
    v_cvt_pk_bf16_f32 v108, v112, v113
    v_cvt_pk_bf16_f32 v109, v114, v115
    v_cvt_pk_bf16_f32 v110, v116, v117
    v_cvt_pk_bf16_f32 v111, v118, v119
    s_cmp_lg_u32 s40, 2
    s_cbranch_scc1 mega_kernel_c_inv71
    s_nop 7
    v_mov_b32 v184, v5
    v_mov_b32 v185, v5
    v_mov_b32 v186, v5
    v_mov_b32 v187, v5
    v_mov_b32 v188, v5
    v_mov_b32 v189, v5
    v_mov_b32 v190, v5
    v_mov_b32 v191, v5
    v_mov_b32 v192, v5
    v_mov_b32 v193, v5
    v_mov_b32 v194, v5
    v_mov_b32 v195, v5
    v_mov_b32 v196, v5
    v_mov_b32 v197, v5
    v_mov_b32 v198, v5
    v_mov_b32 v199, v5
    s_nop 1
mega_kernel_c_inv71:
    ds_read_b128 v[216:219], v13 offset:22528
    ds_read_b128 v[220:223], v13 offset:23552
    v_mfma_f32_32x32x16_bf16 v[136:151], v[56:59], v[244:247], v[184:199]
    v_exp_f32 v120, v120
    v_exp_f32 v121, v121
    v_exp_f32 v122, v122
    v_exp_f32 v123, v123
    v_mfma_f32_32x32x16_bf16 v[136:151], v[60:63], v[248:251], v[136:151]
    v_exp_f32 v124, v124
    v_exp_f32 v125, v125
    v_exp_f32 v126, v126
    v_exp_f32 v127, v127
    s_waitcnt lgkmcnt(5)
    v_mfma_f32_32x32x16_bf16 v[200:215], v[224:227], v[104:107], v[200:215]
    v_exp_f32 v128, v128
    v_exp_f32 v129, v129
    v_exp_f32 v130, v130
    v_exp_f32 v131, v131
    s_waitcnt lgkmcnt(4)
    v_mfma_f32_32x32x16_bf16 v[200:215], v[228:231], v[108:111], v[200:215]
    v_exp_f32 v132, v132
    v_exp_f32 v133, v133
    v_exp_f32 v134, v134
    v_exp_f32 v135, v135
    v_cvt_pk_bf16_f32 v120, v120, v121
    v_cvt_pk_bf16_f32 v121, v122, v123
    v_cvt_pk_bf16_f32 v122, v124, v125
    v_cvt_pk_bf16_f32 v123, v126, v127
    v_cvt_pk_bf16_f32 v124, v128, v129
    v_cvt_pk_bf16_f32 v125, v130, v131
    v_cvt_pk_bf16_f32 v126, v132, v133
    v_cvt_pk_bf16_f32 v127, v134, v135
    s_cmp_lg_u32 s40, 3
    s_cbranch_scc1 mega_kernel_c_inv72
    s_nop 7
    v_mov_b32 v184, v5
    v_mov_b32 v185, v5
    v_mov_b32 v186, v5
    v_mov_b32 v187, v5
    v_mov_b32 v188, v5
    v_mov_b32 v189, v5
    v_mov_b32 v190, v5
    v_mov_b32 v191, v5
    v_mov_b32 v192, v5
    v_mov_b32 v193, v5
    v_mov_b32 v194, v5
    v_mov_b32 v195, v5
    v_mov_b32 v196, v5
    v_mov_b32 v197, v5
    v_mov_b32 v198, v5
    v_mov_b32 v199, v5
    s_nop 1
mega_kernel_c_inv72:
    ds_read_b128 v[224:227], v13 offset:18432
    ds_read_b128 v[228:231], v13 offset:19456
    v_mfma_f32_32x32x16_bf16 v[88:103], v[48:51], v[244:247], v[184:199]
    v_exp_f32 v136, v136
    v_exp_f32 v137, v137
    v_exp_f32 v138, v138
    v_exp_f32 v139, v139
    v_mfma_f32_32x32x16_bf16 v[88:103], v[52:55], v[248:251], v[88:103]
    v_exp_f32 v140, v140
    v_exp_f32 v141, v141
    v_exp_f32 v142, v142
    v_exp_f32 v143, v143
    s_waitcnt lgkmcnt(5)
    v_mfma_f32_32x32x16_bf16 v[200:215], v[232:235], v[120:123], v[200:215]
    v_exp_f32 v144, v144
    v_exp_f32 v145, v145
    v_exp_f32 v146, v146
    v_exp_f32 v147, v147
    s_waitcnt lgkmcnt(4)
    v_mfma_f32_32x32x16_bf16 v[200:215], v[236:239], v[124:127], v[200:215]
    v_exp_f32 v148, v148
    v_exp_f32 v149, v149
    v_exp_f32 v150, v150
    v_exp_f32 v151, v151
    v_cvt_pk_bf16_f32 v136, v136, v137
    v_cvt_pk_bf16_f32 v137, v138, v139
    v_cvt_pk_bf16_f32 v138, v140, v141
    v_cvt_pk_bf16_f32 v139, v142, v143
    v_cvt_pk_bf16_f32 v140, v144, v145
    v_cvt_pk_bf16_f32 v141, v146, v147
    v_cvt_pk_bf16_f32 v142, v148, v149
    v_cvt_pk_bf16_f32 v143, v150, v151
    s_cmp_lg_u32 s40, 4
    s_cbranch_scc1 mega_kernel_c_inv73
    s_nop 7
    v_mov_b32 v184, v5
    v_mov_b32 v185, v5
    v_mov_b32 v186, v5
    v_mov_b32 v187, v5
    v_mov_b32 v188, v5
    v_mov_b32 v189, v5
    v_mov_b32 v190, v5
    v_mov_b32 v191, v5
    v_mov_b32 v192, v5
    v_mov_b32 v193, v5
    v_mov_b32 v194, v5
    v_mov_b32 v195, v5
    v_mov_b32 v196, v5
    v_mov_b32 v197, v5
    v_mov_b32 v198, v5
    v_mov_b32 v199, v5
    s_nop 1
mega_kernel_c_inv73:
    ds_read_b128 v[232:235], v13 offset:14336
    ds_read_b128 v[236:239], v13 offset:15360
    v_mfma_f32_32x32x16_bf16 v[104:119], v[40:43], v[244:247], v[184:199]
    v_exp_f32 v88, v88
    v_exp_f32 v89, v89
    v_exp_f32 v90, v90
    v_exp_f32 v91, v91
    v_mfma_f32_32x32x16_bf16 v[104:119], v[44:47], v[248:251], v[104:119]
    v_exp_f32 v92, v92
    v_exp_f32 v93, v93
    v_exp_f32 v94, v94
    v_exp_f32 v95, v95
    s_waitcnt lgkmcnt(5)
    v_mfma_f32_32x32x16_bf16 v[200:215], v[216:219], v[136:139], v[200:215]
    v_exp_f32 v96, v96
    v_exp_f32 v97, v97
    v_exp_f32 v98, v98
    v_exp_f32 v99, v99
    s_waitcnt lgkmcnt(4)
    v_mfma_f32_32x32x16_bf16 v[200:215], v[220:223], v[140:143], v[200:215]
    v_exp_f32 v100, v100
    v_exp_f32 v101, v101
    v_exp_f32 v102, v102
    v_exp_f32 v103, v103
    v_cvt_pk_bf16_f32 v88, v88, v89
    v_cvt_pk_bf16_f32 v89, v90, v91
    v_cvt_pk_bf16_f32 v90, v92, v93
    v_cvt_pk_bf16_f32 v91, v94, v95
    v_cvt_pk_bf16_f32 v92, v96, v97
    v_cvt_pk_bf16_f32 v93, v98, v99
    v_cvt_pk_bf16_f32 v94, v100, v101
    v_cvt_pk_bf16_f32 v95, v102, v103
    s_cmp_lg_u32 s40, 5
    s_cbranch_scc1 mega_kernel_c_inv74
    s_nop 7
    v_mov_b32 v184, v5
    v_mov_b32 v185, v5
    v_mov_b32 v186, v5
    v_mov_b32 v187, v5
    v_mov_b32 v188, v5
    v_mov_b32 v189, v5
    v_mov_b32 v190, v5
    v_mov_b32 v191, v5
    v_mov_b32 v192, v5
    v_mov_b32 v193, v5
    v_mov_b32 v194, v5
    v_mov_b32 v195, v5
    v_mov_b32 v196, v5
    v_mov_b32 v197, v5
    v_mov_b32 v198, v5
    v_mov_b32 v199, v5
    s_nop 1
mega_kernel_c_inv74:
    ds_read_b128 v[216:219], v13 offset:10240
    ds_read_b128 v[220:223], v13 offset:11264
    v_mfma_f32_32x32x16_bf16 v[120:135], v[32:35], v[244:247], v[184:199]
    v_exp_f32 v104, v104
    v_exp_f32 v105, v105
    v_exp_f32 v106, v106
    v_exp_f32 v107, v107
    v_mfma_f32_32x32x16_bf16 v[120:135], v[36:39], v[248:251], v[120:135]
    v_exp_f32 v108, v108
    v_exp_f32 v109, v109
    v_exp_f32 v110, v110
    v_exp_f32 v111, v111
    s_waitcnt lgkmcnt(5)
    v_mfma_f32_32x32x16_bf16 v[200:215], v[224:227], v[88:91], v[200:215]
    v_exp_f32 v112, v112
    v_exp_f32 v113, v113
    v_exp_f32 v114, v114
    v_exp_f32 v115, v115
    s_waitcnt lgkmcnt(4)
    v_mfma_f32_32x32x16_bf16 v[200:215], v[228:231], v[92:95], v[200:215]
    v_exp_f32 v116, v116
    v_exp_f32 v117, v117
    v_exp_f32 v118, v118
    v_exp_f32 v119, v119
    v_cvt_pk_bf16_f32 v104, v104, v105
    v_cvt_pk_bf16_f32 v105, v106, v107
    v_cvt_pk_bf16_f32 v106, v108, v109
    v_cvt_pk_bf16_f32 v107, v110, v111
    v_cvt_pk_bf16_f32 v108, v112, v113
    v_cvt_pk_bf16_f32 v109, v114, v115
    v_cvt_pk_bf16_f32 v110, v116, v117
    v_cvt_pk_bf16_f32 v111, v118, v119
    s_cmp_lg_u32 s40, 6
    s_cbranch_scc1 mega_kernel_c_inv75
    s_nop 7
    v_mov_b32 v184, v5
    v_mov_b32 v185, v5
    v_mov_b32 v186, v5
    v_mov_b32 v187, v5
    v_mov_b32 v188, v5
    v_mov_b32 v189, v5
    v_mov_b32 v190, v5
    v_mov_b32 v191, v5
    v_mov_b32 v192, v5
    v_mov_b32 v193, v5
    v_mov_b32 v194, v5
    v_mov_b32 v195, v5
    v_mov_b32 v196, v5
    v_mov_b32 v197, v5
    v_mov_b32 v198, v5
    v_mov_b32 v199, v5
    s_nop 1
mega_kernel_c_inv75:
    ds_read_b128 v[224:227], v13 offset:6144
    ds_read_b128 v[228:231], v13 offset:7168
    v_mfma_f32_32x32x16_bf16 v[136:151], v[24:27], v[244:247], v[184:199]
    v_exp_f32 v120, v120
    v_exp_f32 v121, v121
    v_exp_f32 v122, v122
    v_exp_f32 v123, v123
    v_mfma_f32_32x32x16_bf16 v[136:151], v[28:31], v[248:251], v[136:151]
    v_exp_f32 v124, v124
    v_exp_f32 v125, v125
    v_exp_f32 v126, v126
    v_exp_f32 v127, v127
    s_waitcnt lgkmcnt(5)
    v_mfma_f32_32x32x16_bf16 v[200:215], v[232:235], v[104:107], v[200:215]
    v_exp_f32 v128, v128
    v_exp_f32 v129, v129
    v_exp_f32 v130, v130
    v_exp_f32 v131, v131
    s_waitcnt lgkmcnt(4)
    v_mfma_f32_32x32x16_bf16 v[200:215], v[236:239], v[108:111], v[200:215]
    v_exp_f32 v132, v132
    v_exp_f32 v133, v133
    v_exp_f32 v134, v134
    v_exp_f32 v135, v135
    v_cvt_pk_bf16_f32 v120, v120, v121
    v_cvt_pk_bf16_f32 v121, v122, v123
    v_cvt_pk_bf16_f32 v122, v124, v125
    v_cvt_pk_bf16_f32 v123, v126, v127
    v_cvt_pk_bf16_f32 v124, v128, v129
    v_cvt_pk_bf16_f32 v125, v130, v131
    v_cvt_pk_bf16_f32 v126, v132, v133
    v_cvt_pk_bf16_f32 v127, v134, v135
    ds_read_b128 v[232:235], v13 offset:2048
    ds_read_b128 v[236:239], v13 offset:3072
    v_mfma_f32_32x32x16_bf16 v[88:103], v[16:19], v[244:247], v[168:183]
    v_exp_f32 v136, v136
    v_exp_f32 v137, v137
    v_exp_f32 v138, v138
    v_exp_f32 v139, v139
    v_mfma_f32_32x32x16_bf16 v[88:103], v[20:23], v[248:251], v[88:103]
    v_exp_f32 v140, v140
    v_exp_f32 v141, v141
    v_exp_f32 v142, v142
    v_exp_f32 v143, v143
    s_waitcnt lgkmcnt(5)
    v_mfma_f32_32x32x16_bf16 v[200:215], v[216:219], v[120:123], v[200:215]
    v_exp_f32 v144, v144
    v_exp_f32 v145, v145
    v_exp_f32 v146, v146
    v_exp_f32 v147, v147
    s_waitcnt lgkmcnt(4)
    v_mfma_f32_32x32x16_bf16 v[200:215], v[220:223], v[124:127], v[200:215]
    v_exp_f32 v148, v148
    v_exp_f32 v149, v149
    v_exp_f32 v150, v150
    v_exp_f32 v151, v151
    v_cvt_pk_bf16_f32 v136, v136, v137
    v_cvt_pk_bf16_f32 v137, v138, v139
    v_cvt_pk_bf16_f32 v138, v140, v141
    v_cvt_pk_bf16_f32 v139, v142, v143
    v_cvt_pk_bf16_f32 v140, v144, v145
    v_cvt_pk_bf16_f32 v141, v146, v147
    v_cvt_pk_bf16_f32 v142, v148, v149
    v_cvt_pk_bf16_f32 v143, v150, v151
    s_waitcnt lgkmcnt(3)
    v_mfma_f32_32x32x16_bf16 v[200:215], v[224:227], v[136:139], v[200:215]
    v_exp_f32 v88, v88
    v_exp_f32 v89, v89
    v_exp_f32 v90, v90
    v_exp_f32 v91, v91
    s_waitcnt lgkmcnt(2)
    v_mfma_f32_32x32x16_bf16 v[200:215], v[228:231], v[140:143], v[200:215]
    v_exp_f32 v92, v92
    v_exp_f32 v93, v93
    v_exp_f32 v94, v94
    v_exp_f32 v95, v95
    v_exp_f32 v96, v96
    v_exp_f32 v97, v97
    v_exp_f32 v98, v98
    v_exp_f32 v99, v99
    v_exp_f32 v100, v100
    v_exp_f32 v101, v101
    v_exp_f32 v102, v102
    v_exp_f32 v103, v103
    v_cvt_pk_bf16_f32 v88, v88, v89
    v_cvt_pk_bf16_f32 v89, v90, v91
    v_cvt_pk_bf16_f32 v90, v92, v93
    v_cvt_pk_bf16_f32 v91, v94, v95
    v_cvt_pk_bf16_f32 v92, v96, v97
    v_cvt_pk_bf16_f32 v93, v98, v99
    v_cvt_pk_bf16_f32 v94, v100, v101
    v_cvt_pk_bf16_f32 v95, v102, v103
    s_waitcnt lgkmcnt(1)
    v_mfma_f32_32x32x16_bf16 v[200:215], v[232:235], v[88:91], v[200:215]
    s_waitcnt lgkmcnt(0)
    v_mfma_f32_32x32x16_bf16 v[200:215], v[236:239], v[92:95], v[200:215]
    s_nop 11
    v_mov_b32 v3, v212
    v_mov_b32 v4, v212
    s_nop 1
    v_permlane32_swap_b32 v3, v4
    v_rcp_f32 v4, v4
    s_nop 0
    v_mul_f32 v200, v200, v4
    v_mul_f32 v201, v201, v4
    v_mul_f32 v202, v202, v4
    v_mul_f32 v203, v203, v4
    v_mul_f32 v204, v204, v4
    v_mul_f32 v205, v205, v4
    v_mul_f32 v206, v206, v4
    v_mul_f32 v207, v207, v4
    v_mul_f32 v208, v208, v4
    v_mul_f32 v209, v209, v4
    v_mul_f32 v210, v210, v4
    v_mul_f32 v211, v211, v4
    v_mul_f32 v212, v212, v4
    v_mul_f32 v213, v213, v4
    v_mul_f32 v214, v214, v4
    v_mul_f32 v215, v215, v4
    v_cvt_pk_bf16_f32 v200, v200, v201
    v_cvt_pk_bf16_f32 v201, v202, v203
    v_cvt_pk_bf16_f32 v202, v204, v205
    v_cvt_pk_bf16_f32 v203, v206, v207
    v_cvt_pk_bf16_f32 v204, v208, v209
    v_cvt_pk_bf16_f32 v205, v210, v211
    v_cvt_pk_bf16_f32 v206, v212, v213
    v_cvt_pk_bf16_f32 v207, v214, v215
    buffer_store_dwordx4 v[200:203], v1, s[8:11], s41 offen sc1
    buffer_store_dwordx4 v[204:207], v1, s[8:11], s41 offen offset:1024 sc1
    s_mov_b32 s42, s18
    s_mov_b32 s63, s19
    s_lshl_b32 s42, s42, 12
    s_lshl_b32 s63, s63, 2
    s_add_u32 s42, s42, s63
    s_add_u32 s42, s42, 70828032
    v_mul_u32_u24 v255, 256, v0
    v_mov_b32 v254, 1
    v_mov_b32 v253, 163776
    s_waitcnt vmcnt(0)
    s_mov_b64 exec, 1
    ds_add_rtn_u32 v253, v253, v254
    s_waitcnt lgkmcnt(0)
    v_readfirstlane_b32 s62, v253
    s_mov_b64 exec, 16383
    s_and_b32 s62, s62, 3
    s_cmp_lg_u32 s62, 3
    s_cbranch_scc1 mega_kernel_c_sig76
    buffer_store_dword v254, v255, s[8:11], s42 offen sc1
mega_kernel_c_sig76:
    s_mov_b64 exec, -1
    s_barrier
    s_cmp_eq_u32 s24, 0
    s_cbranch_scc1 mega_kernel_c_skip77
    s_and_b32 s43, s13, 1
    s_lshr_b32 s44, s13, 1
    s_lshl_b32 s40, s22, 1
    s_add_u32 s40, s40, s43
    s_lshl_b32 s41, s23, 1
    s_add_u32 s41, s41, s44
    s_mul_i32 s42, s40, 28
    s_lshl_b32 s45, s41, 1
    s_add_u32 s42, s42, s45
    s_lshl_b32 s42, s42, 10
    s_add_u32 s45, s42, 14680064
    buffer_load_dwordx4 v[48:51], v1, s[8:11], s45 offen offset:0 sc1
    buffer_load_dwordx4 v[52:55], v1, s[8:11], s45 offen offset:1024 sc1
    s_mul_i32 s47, s40, 32768
    s_lshl_b32 s45, s44, 11
    s_add_u32 s47, s47, s45
    s_add_u32 s47, s47, 50331648
    s_mul_i32 s48, s44, 32768
    s_add_u32 s48, s48, s45
    s_xor_b32 s49, s44, 1
    s_mul_i32 s49, s49, 32768
    s_add_u32 s49, s49, s45
    v_add_u32 v3, s48, v1
    v_add_u32 v6, s49, v1
    v_add_u32 v4, s48, v1
    v_add_u32 v7, s49, v1
    v_add_u32 v4, 61440, v4
    v_add_u32 v7, 61440, v7
    v_add_u32 v5, s48, v1
    v_add_u32 v8, s49, v1
    v_add_u32 v5, 122880, v5
    v_add_u32 v8, 122880, v8
    s_lshl_b32 s48, s13, 12
    s_add_u32 s48, s48, 65536
    v_add_u32 v9, s48, v1
    s_xor_b32 s48, s13, 2
    s_lshl_b32 s48, s48, 12
    s_add_u32 s48, s48, 65536
    v_add_u32 v10, s48, v1
    s_waitcnt vmcnt(0)
    v_lshlrev_b32 v16, 16, v48
    v_and_b32 v17, 0xffff0000, v48
    v_lshlrev_b32 v18, 16, v49
    v_and_b32 v19, 0xffff0000, v49
    v_lshlrev_b32 v20, 16, v50
    v_and_b32 v21, 0xffff0000, v50
    v_lshlrev_b32 v22, 16, v51
    v_and_b32 v23, 0xffff0000, v51
    v_lshlrev_b32 v24, 16, v52
    v_and_b32 v25, 0xffff0000, v52
    v_lshlrev_b32 v26, 16, v53
    v_and_b32 v27, 0xffff0000, v53
    v_lshlrev_b32 v28, 16, v54
    v_and_b32 v29, 0xffff0000, v54
    v_lshlrev_b32 v30, 16, v55
    v_and_b32 v31, 0xffff0000, v55
    v_mov_b32 v48, 0x3f803f80
    s_lshl_b32 s46, s56, 8
    s_add_u32 s46, s46, 70828032
    s_cmp_lg_u32 s12, 0
    s_cbranch_scc1 mega_kernel_c_dwo78
mega_kernel_c_mbw80:
    buffer_load_dword v252, v2, s[8:11], s46 offen sc1
    s_waitcnt vmcnt(0)
    v_cmp_eq_u32 vcc, 0, v252
    s_nop 1
    s_and_b64 vcc, vcc, s[60:61]
    s_cbranch_scc0 mega_kernel_c_mbd81
    s_sub_u32 s25, s25, 1
    s_cbranch_scc0 mega_kernel_c_mbw80
    s_mov_b32 s25, 0
mega_kernel_c_mbd81:
    s_mov_b64 exec, 1
    v_mov_b32 v253, 163792
    v_mov_b32 v254, 1
    ds_add_u32 v253, v254
    s_mov_b64 exec, -1
    s_branch mega_kernel_c_dwg79
mega_kernel_c_dwo78:
    v_mov_b32 v253, 163792
mega_kernel_c_lw82:
    ds_read_b32 v254, v253
    s_waitcnt lgkmcnt(0)
    v_readfirstlane_b32 s62, v254
    s_nop 1
    s_cmp_ge_u32 s62, 4
    s_cbranch_scc1 mega_kernel_c_lwd83
    s_sleep 1
    s_sub_u32 s25, s25, 1
    s_cbranch_scc0 mega_kernel_c_lw82
    s_mov_b32 s25, 0
mega_kernel_c_lwd83:
mega_kernel_c_dwg79:
    s_waitcnt lgkmcnt(0)
    buffer_load_dwordx4 v[96:99], v1, s[8:11], s47 offen offset:0 sc1
    buffer_load_dwordx4 v[100:103], v1, s[8:11], s47 offen offset:1024 sc1
    s_add_u32 s47, s47, 4096
    buffer_load_dwordx4 v[104:107], v1, s[8:11], s47 offen offset:0 sc1
    buffer_load_dwordx4 v[108:111], v1, s[8:11], s47 offen offset:1024 sc1
    s_add_u32 s47, s47, 4096
    buffer_load_dwordx4 v[112:115], v1, s[8:11], s47 offen offset:0 sc1
    buffer_load_dwordx4 v[116:119], v1, s[8:11], s47 offen offset:1024 sc1
    s_add_u32 s47, s47, 4096
    buffer_load_dwordx4 v[120:123], v1, s[8:11], s47 offen offset:0 sc1
    buffer_load_dwordx4 v[124:127], v1, s[8:11], s47 offen offset:1024 sc1
    s_add_u32 s47, s47, 4096
    buffer_load_dwordx4 v[128:131], v1, s[8:11], s47 offen offset:0 sc1
    buffer_load_dwordx4 v[132:135], v1, s[8:11], s47 offen offset:1024 sc1
    ds_read_b128 v[64:67], v3 offset:0
    ds_read_b128 v[68:71], v6 offset:0
    ds_read_b128 v[72:75], v3 offset:1024
    ds_read_b128 v[76:79], v6 offset:1024
    ds_read_b128 v[80:83], v3 offset:4096
    ds_read_b128 v[84:87], v6 offset:4096
    ds_read_b128 v[88:91], v3 offset:5120
    ds_read_b128 v[92:95], v6 offset:5120
    s_waitcnt vmcnt(9)
    s_waitcnt lgkmcnt(7)
    v_mfma_f32_32x32x16_bf16 v[16:31], v[64:67], v[96:99], v[16:31]
    s_waitcnt lgkmcnt(6)
    v_mfma_f32_32x32x16_bf16 v[32:47], v[68:71], v[96:99], 0
    s_add_u32 s47, s47, 4096
    buffer_load_dwordx4 v[136:139], v1, s[8:11], s47 offen offset:0 sc1
    ds_read_b128 v[64:67], v3 offset:8192
    ds_read_b128 v[68:71], v6 offset:8192
    s_waitcnt vmcnt(9)
    s_waitcnt lgkmcnt(7)
    v_mfma_f32_32x32x16_bf16 v[16:31], v[72:75], v[100:103], v[16:31]
    s_waitcnt lgkmcnt(6)
    v_mfma_f32_32x32x16_bf16 v[32:47], v[76:79], v[100:103], v[32:47]
    buffer_load_dwordx4 v[140:143], v1, s[8:11], s47 offen offset:1024 sc1
    ds_read_b128 v[72:75], v3 offset:9216
    ds_read_b128 v[76:79], v6 offset:9216
    s_waitcnt vmcnt(9)
    s_waitcnt lgkmcnt(7)
    v_mfma_f32_32x32x16_bf16 v[16:31], v[80:83], v[104:107], v[16:31]
    s_waitcnt lgkmcnt(6)
    v_mfma_f32_32x32x16_bf16 v[32:47], v[84:87], v[104:107], v[32:47]
    s_add_u32 s47, s47, 4096
    buffer_load_dwordx4 v[144:147], v1, s[8:11], s47 offen offset:0 sc1
    ds_read_b128 v[80:83], v3 offset:12288
    ds_read_b128 v[84:87], v6 offset:12288
    s_waitcnt vmcnt(9)
    s_waitcnt lgkmcnt(7)
    v_mfma_f32_32x32x16_bf16 v[16:31], v[88:91], v[108:111], v[16:31]
    s_waitcnt lgkmcnt(6)
    v_mfma_f32_32x32x16_bf16 v[32:47], v[92:95], v[108:111], v[32:47]
    buffer_load_dwordx4 v[148:151], v1, s[8:11], s47 offen offset:1024 sc1
    ds_read_b128 v[88:91], v3 offset:13312
    ds_read_b128 v[92:95], v6 offset:13312
    s_waitcnt vmcnt(9)
    s_waitcnt lgkmcnt(7)
    v_mfma_f32_32x32x16_bf16 v[16:31], v[64:67], v[112:115], v[16:31]
    s_waitcnt lgkmcnt(6)
    v_mfma_f32_32x32x16_bf16 v[32:47], v[68:71], v[112:115], v[32:47]
    s_add_u32 s47, s47, 4096
    buffer_load_dwordx4 v[152:155], v1, s[8:11], s47 offen offset:0 sc1
    ds_read_b128 v[64:67], v3 offset:16384
    ds_read_b128 v[68:71], v6 offset:16384
    s_waitcnt vmcnt(9)
    s_waitcnt lgkmcnt(7)
    v_mfma_f32_32x32x16_bf16 v[16:31], v[72:75], v[116:119], v[16:31]
    s_waitcnt lgkmcnt(6)
    v_mfma_f32_32x32x16_bf16 v[32:47], v[76:79], v[116:119], v[32:47]
    buffer_load_dwordx4 v[156:159], v1, s[8:11], s47 offen offset:1024 sc1
    ds_read_b128 v[72:75], v3 offset:17408
    ds_read_b128 v[76:79], v6 offset:17408
    s_waitcnt vmcnt(9)
    s_waitcnt lgkmcnt(7)
    v_mfma_f32_32x32x16_bf16 v[16:31], v[80:83], v[120:123], v[16:31]
    s_waitcnt lgkmcnt(6)
    v_mfma_f32_32x32x16_bf16 v[32:47], v[84:87], v[120:123], v[32:47]
    ds_read_b128 v[80:83], v3 offset:20480
    ds_read_b128 v[84:87], v6 offset:20480
    s_waitcnt vmcnt(8)
    s_waitcnt lgkmcnt(7)
    v_mfma_f32_32x32x16_bf16 v[16:31], v[88:91], v[124:127], v[16:31]
    s_waitcnt lgkmcnt(6)
    v_mfma_f32_32x32x16_bf16 v[32:47], v[92:95], v[124:127], v[32:47]
    ds_read_b128 v[88:91], v3 offset:21504
    ds_read_b128 v[92:95], v6 offset:21504
    s_waitcnt vmcnt(7)
    s_waitcnt lgkmcnt(7)
    v_mfma_f32_32x32x16_bf16 v[16:31], v[64:67], v[128:131], v[16:31]
    s_waitcnt lgkmcnt(6)
    v_mfma_f32_32x32x16_bf16 v[32:47], v[68:71], v[128:131], v[32:47]
    ds_read_b128 v[64:67], v3 offset:24576
    ds_read_b128 v[68:71], v6 offset:24576
    s_waitcnt vmcnt(6)
    s_waitcnt lgkmcnt(7)
    v_mfma_f32_32x32x16_bf16 v[16:31], v[72:75], v[132:135], v[16:31]
    s_waitcnt lgkmcnt(6)
    v_mfma_f32_32x32x16_bf16 v[32:47], v[76:79], v[132:135], v[32:47]
    ds_read_b128 v[72:75], v3 offset:25600
    ds_read_b128 v[76:79], v6 offset:25600
    s_waitcnt vmcnt(5)
    s_waitcnt lgkmcnt(7)
    v_mfma_f32_32x32x16_bf16 v[16:31], v[80:83], v[136:139], v[16:31]
    s_waitcnt lgkmcnt(6)
    v_mfma_f32_32x32x16_bf16 v[32:47], v[84:87], v[136:139], v[32:47]
    ds_read_b128 v[80:83], v3 offset:28672
    ds_read_b128 v[84:87], v6 offset:28672
    s_waitcnt vmcnt(4)
    s_waitcnt lgkmcnt(7)
    v_mfma_f32_32x32x16_bf16 v[16:31], v[88:91], v[140:143], v[16:31]
    s_waitcnt lgkmcnt(6)
    v_mfma_f32_32x32x16_bf16 v[32:47], v[92:95], v[140:143], v[32:47]
    ds_read_b128 v[88:91], v3 offset:29696
    ds_read_b128 v[92:95], v6 offset:29696
    s_waitcnt vmcnt(3)
    s_waitcnt lgkmcnt(7)
    v_mfma_f32_32x32x16_bf16 v[16:31], v[64:67], v[144:147], v[16:31]
    s_waitcnt lgkmcnt(6)
    v_mfma_f32_32x32x16_bf16 v[32:47], v[68:71], v[144:147], v[32:47]
    s_waitcnt vmcnt(2)
    s_waitcnt lgkmcnt(5)
    v_mfma_f32_32x32x16_bf16 v[16:31], v[72:75], v[148:151], v[16:31]
    s_waitcnt lgkmcnt(4)
    v_mfma_f32_32x32x16_bf16 v[32:47], v[76:79], v[148:151], v[32:47]
    s_waitcnt vmcnt(1)
    s_waitcnt lgkmcnt(3)
    v_mfma_f32_32x32x16_bf16 v[16:31], v[80:83], v[152:155], v[16:31]
    s_waitcnt lgkmcnt(2)
    v_mfma_f32_32x32x16_bf16 v[32:47], v[84:87], v[152:155], v[32:47]
    s_waitcnt vmcnt(0)
    s_waitcnt lgkmcnt(1)
    v_mfma_f32_32x32x16_bf16 v[16:31], v[88:91], v[156:159], v[16:31]
    s_waitcnt lgkmcnt(0)
    v_mfma_f32_32x32x16_bf16 v[32:47], v[92:95], v[156:159], v[32:47]
    s_nop 11
    ds_write_b128 v9, v[32:35] offset:0
    ds_write_b128 v9, v[36:39] offset:1024
    ds_write_b128 v9, v[40:43] offset:2048
    ds_write_b128 v9, v[44:47] offset:3072
    s_waitcnt lgkmcnt(0)
    s_barrier
    ds_read_b128 v[64:67], v10 offset:0
    ds_read_b128 v[68:71], v10 offset:1024
    ds_read_b128 v[72:75], v10 offset:2048
    ds_read_b128 v[76:79], v10 offset:3072
    s_waitcnt lgkmcnt(3)
    v_add_f32 v16, v16, v64
    v_add_f32 v17, v17, v65
    v_add_f32 v18, v18, v66
    v_add_f32 v19, v19, v67
    v_cvt_pk_bf16_f32 v96, v16, v17
    v_cvt_pk_bf16_f32 v97, v18, v19
    s_waitcnt lgkmcnt(2)
    v_add_f32 v20, v20, v68
    v_add_f32 v21, v21, v69
    v_add_f32 v22, v22, v70
    v_add_f32 v23, v23, v71
    v_cvt_pk_bf16_f32 v98, v20, v21
    v_cvt_pk_bf16_f32 v99, v22, v23
    s_waitcnt lgkmcnt(1)
    v_add_f32 v24, v24, v72
    v_add_f32 v25, v25, v73
    v_add_f32 v26, v26, v74
    v_add_f32 v27, v27, v75
    v_cvt_pk_bf16_f32 v100, v24, v25
    v_cvt_pk_bf16_f32 v101, v26, v27
    s_waitcnt lgkmcnt(0)
    v_add_f32 v28, v28, v76
    v_add_f32 v29, v29, v77
    v_add_f32 v30, v30, v78
    v_add_f32 v31, v31, v79
    v_cvt_pk_bf16_f32 v102, v28, v29
    v_cvt_pk_bf16_f32 v103, v30, v31
    s_add_u32 s45, s42, 16777216
    buffer_store_dwordx4 v[96:99], v1, s[8:11], s45 offen sc1
    buffer_store_dwordx4 v[100:103], v1, s[8:11], s45 offen offset:1024 sc1
    v_mov_b32 v56, 0
    v_mov_b32 v57, 0
    v_dot2c_f32_bf16 v56, v96, v48
    v_dot2c_f32_bf16 v57, v96, v96
    v_dot2c_f32_bf16 v56, v97, v48
    v_dot2c_f32_bf16 v57, v97, v97
    v_dot2c_f32_bf16 v56, v98, v48
    v_dot2c_f32_bf16 v57, v98, v98
    v_dot2c_f32_bf16 v56, v99, v48
    v_dot2c_f32_bf16 v57, v99, v99
    v_dot2c_f32_bf16 v56, v100, v48
    v_dot2c_f32_bf16 v57, v100, v100
    v_dot2c_f32_bf16 v56, v101, v48
    v_dot2c_f32_bf16 v57, v101, v101
    v_dot2c_f32_bf16 v56, v102, v48
    v_dot2c_f32_bf16 v57, v102, v102
    v_dot2c_f32_bf16 v56, v103, v48
    v_dot2c_f32_bf16 v57, v103, v103
    s_nop 1
    v_mov_b32 v58, v56
    v_mov_b32 v59, v57
    s_nop 0
    v_permlane32_swap_b32 v58, v56
    v_permlane32_swap_b32 v59, v57
    v_add_f32 v56, v56, v58
    v_add_f32 v57, v57, v59
    v_and_b32 v58, 31, v0
    v_lshlrev_b32 v58, 3, v58
    s_mul_i32 s45, s40, 14
    s_add_u32 s45, s45, s41
    s_lshl_b32 s45, s45, 8
    s_add_u32 s45, s45, 36438016
    buffer_store_dwordx2 v[56:57], v58, s[8:11], s45 offen sc1
    s_lshr_b32 s46, s56, 4
    s_and_b32 s63, s56, 15
    s_lshl_b32 s46, s46, 12
    s_lshl_b32 s63, s63, 2
    s_add_u32 s46, s46, s63
    s_add_u32 s46, s46, 70909952
    v_mul_u32_u24 v255, 256, v0
    v_mov_b32 v254, 1
    v_mov_b32 v253, 163776
    s_waitcnt vmcnt(0)
    s_mov_b64 exec, 1
    ds_add_rtn_u32 v253, v253, v254
    s_waitcnt lgkmcnt(0)
    v_readfirstlane_b32 s62, v253
    s_mov_b64 exec, 65535
    s_and_b32 s62, s62, 3
    s_cmp_lg_u32 s62, 3
    s_cbranch_scc1 mega_kernel_c_sig84
    buffer_store_dword v254, v255, s[8:11], s46 offen sc1
mega_kernel_c_sig84:
    s_mov_b64 exec, -1
mega_kernel_c_skip77:
    s_nop 7
    s_nop 7
    s_lshl_b32 s40, s20, 2
    s_add_u32 s40, s40, s13
    s_mul_i32 s41, s40, 28672
    s_add_u32 s41, s41, 16777216
    s_mul_i32 s42, s40, 3584
    s_add_u32 s42, s42, 36438016
    v_mov_b32 v5, 0x3f803f80
    v_lshrrev_b32 v228, 5, v0
    v_mul_u32_u24 v228, 1792, v228
    v_and_b32 v229, 31, v0
    v_lshl_add_u32 v228, v229, 3, v228
    v_mov_b32 v10, v1
    v_add_u32 v11, 59392, v1
    v_add_u32 v12, 118784, v1
    s_mul_i32 s44, s40, 114688
    s_add_u32 s44, s44, 60817408
    s_mul_i32 s46, s21, 3072
    s_add_u32 s45, s44, s46
    s_add_u32 s45, s45, 65536
    s_lshl_b32 s46, s21, 12
    s_add_u32 s44, s44, s46
    s_mov_b32 s47, s20
    s_mov_b32 s63, s21
    s_lshl_b32 s47, s47, 12
    s_lshl_b32 s63, s63, 2
    s_add_u32 s47, s47, s63
    s_add_u32 s47, s47, 70991872
    s_mov_b32 s48, s20
    s_mov_b32 s63, s21
    s_lshl_b32 s48, s48, 12
    s_lshl_b32 s63, s63, 2
    s_add_u32 s48, s48, s63
    s_add_u32 s48, s48, 71073792
    s_lshl_b32 s46, s20, 4
    s_add_u32 s46, s46, s21
    s_lshl_b32 s46, s46, 8
    s_add_u32 s46, s46, 70909952
    s_cmp_lg_u32 s12, 0
    s_cbranch_scc1 mega_kernel_c_dwo85
mega_kernel_c_mbw87:
    buffer_load_dword v252, v2, s[8:11], s46 offen sc1
    s_waitcnt vmcnt(0)
    v_cmp_eq_u32 vcc, 0, v252
    s_nop 1
    s_and_b64 vcc, vcc, s[58:59]
    s_cbranch_scc0 mega_kernel_c_mbd88
    s_sub_u32 s25, s25, 1
    s_cbranch_scc0 mega_kernel_c_mbw87
    s_mov_b32 s25, 0
mega_kernel_c_mbd88:
    s_mov_b64 exec, 1
    v_mov_b32 v253, 163788
    v_mov_b32 v254, 1
    ds_add_u32 v253, v254
    s_mov_b64 exec, -1
    s_branch mega_kernel_c_dwg86
mega_kernel_c_dwo85:
    v_mov_b32 v253, 163788
mega_kernel_c_lw89:
    ds_read_b32 v254, v253
    s_waitcnt lgkmcnt(0)
    v_readfirstlane_b32 s62, v254
    s_nop 1
    s_cmp_ge_u32 s62, 3
    s_cbranch_scc1 mega_kernel_c_lwd90
    s_sleep 1
    s_sub_u32 s25, s25, 1
    s_cbranch_scc0 mega_kernel_c_lw89
    s_mov_b32 s25, 0
mega_kernel_c_lwd90:
mega_kernel_c_dwg86:
    s_waitcnt lgkmcnt(0)
    s_add_u32 s43, s41, s33
    buffer_load_dwordx4 v[16:19], v1, s[8:11], s43 offen offset:0 sc1
    buffer_load_dwordx4 v[20:23], v1, s[8:11], s43 offen offset:1024 sc1
    buffer_load_dwordx4 v[24:27], v1, s[8:11], s43 offen offset:2048 sc1
    buffer_load_dwordx4 v[28:31], v1, s[8:11], s43 offen offset:3072 sc1
    s_add_u32 s43, s41, s34
    buffer_load_dwordx4 v[32:35], v1, s[8:11], s43 offen offset:0 sc1
    buffer_load_dwordx4 v[36:39], v1, s[8:11], s43 offen offset:1024 sc1
    buffer_load_dwordx4 v[40:43], v1, s[8:11], s43 offen offset:2048 sc1
    buffer_load_dwordx4 v[44:47], v1, s[8:11], s43 offen offset:3072 sc1
    s_add_u32 s43, s41, s35
    buffer_load_dwordx4 v[48:51], v1, s[8:11], s43 offen offset:0 sc1
    buffer_load_dwordx4 v[52:55], v1, s[8:11], s43 offen offset:1024 sc1
    buffer_load_dwordx4 v[56:59], v1, s[8:11], s43 offen offset:2048 sc1
    buffer_load_dwordx4 v[60:63], v1, s[8:11], s43 offen offset:3072 sc1
    buffer_load_dwordx2 v[212:213], v228, s[8:11], s42 offen offset:0 sc1
    buffer_load_dwordx2 v[214:215], v228, s[8:11], s42 offen offset:256 sc1
    buffer_load_dwordx2 v[216:217], v228, s[8:11], s42 offen offset:512 sc1
    buffer_load_dwordx2 v[218:219], v228, s[8:11], s42 offen offset:768 sc1
    buffer_load_dwordx2 v[220:221], v228, s[8:11], s42 offen offset:1024 sc1
    buffer_load_dwordx2 v[222:223], v228, s[8:11], s42 offen offset:1280 sc1
    buffer_load_dwordx2 v[224:225], v228, s[8:11], s42 offen offset:1536 sc1
    v_mov_b32 v253, 163804
mega_kernel_c_lw91:
    ds_read_b32 v254, v253
    s_waitcnt lgkmcnt(0)
    v_readfirstlane_b32 s62, v254
    s_nop 1
    s_cmp_ge_u32 s62, 8
    s_cbranch_scc1 mega_kernel_c_lwd92
    s_sleep 1
    s_sub_u32 s25, s25, 1
    s_cbranch_scc0 mega_kernel_c_lw91
    s_mov_b32 s25, 0
mega_kernel_c_lwd92:
    ds_read_b128 v[132:135], v10 offset:0
    ds_read_b128 v[136:139], v10 offset:29696
    ds_read_b128 v[140:143], v10 offset:1024
    ds_read_b128 v[144:147], v10 offset:30720
    ds_read_b128 v[148:151], v10 offset:2048
    ds_read_b128 v[152:155], v10 offset:31744
    ds_read_b128 v[156:159], v10 offset:3072
    s_waitcnt vmcnt(15)
    s_waitcnt lgkmcnt(5)
    v_mfma_f32_32x32x16_bf16 v[164:179], v[132:135], v[16:19], 0
    s_add_u32 s43, s41, s36
    buffer_load_dwordx4 v[64:67], v1, s[8:11], s43 offen offset:0 sc1
    buffer_load_dwordx4 v[68:71], v1, s[8:11], s43 offen offset:1024 sc1
    ds_read_b128 v[160:163], v10 offset:32768
    v_mfma_f32_32x32x16_bf16 v[180:195], v[136:139], v[16:19], 0
    buffer_load_dwordx4 v[72:75], v1, s[8:11], s43 offen offset:2048 sc1
    buffer_load_dwordx4 v[76:79], v1, s[8:11], s43 offen offset:3072 sc1
    ds_read_b128 v[132:135], v10 offset:4096
    s_waitcnt lgkmcnt(5)
    v_mfma_f32_32x32x16_bf16 v[164:179], v[140:143], v[20:23], v[164:179]
    s_add_u32 s43, s41, s37
    buffer_load_dwordx4 v[80:83], v1, s[8:11], s43 offen offset:0 sc1
    buffer_load_dwordx4 v[84:87], v1, s[8:11], s43 offen offset:1024 sc1
    ds_read_b128 v[136:139], v10 offset:33792
    v_mfma_f32_32x32x16_bf16 v[180:195], v[144:147], v[20:23], v[180:195]
    buffer_load_dwordx4 v[88:91], v1, s[8:11], s43 offen offset:2048 sc1
    buffer_load_dwordx4 v[92:95], v1, s[8:11], s43 offen offset:3072 sc1
    ds_read_b128 v[140:143], v10 offset:5120
    s_waitcnt lgkmcnt(5)
    v_mfma_f32_32x32x16_bf16 v[164:179], v[148:151], v[24:27], v[164:179]
    s_add_u32 s43, s41, s38
    buffer_load_dwordx4 v[96:99], v1, s[8:11], s43 offen offset:0 sc1
    buffer_load_dwordx4 v[100:103], v1, s[8:11], s43 offen offset:1024 sc1
    ds_read_b128 v[144:147], v10 offset:34816
    v_mfma_f32_32x32x16_bf16 v[180:195], v[152:155], v[24:27], v[180:195]
    buffer_load_dwordx4 v[104:107], v1, s[8:11], s43 offen offset:2048 sc1
    buffer_load_dwordx4 v[108:111], v1, s[8:11], s43 offen offset:3072 sc1
    ds_read_b128 v[148:151], v10 offset:6144
    s_waitcnt lgkmcnt(5)
    v_mfma_f32_32x32x16_bf16 v[164:179], v[156:159], v[28:31], v[164:179]
    s_add_u32 s43, s41, s39
    buffer_load_dwordx4 v[112:115], v1, s[8:11], s43 offen offset:0 sc1
    ds_read_b128 v[152:155], v10 offset:35840
    v_mfma_f32_32x32x16_bf16 v[180:195], v[160:163], v[28:31], v[180:195]
    buffer_load_dwordx4 v[116:119], v1, s[8:11], s43 offen offset:1024 sc1
    ds_read_b128 v[156:159], v10 offset:7168
    s_waitcnt vmcnt(25)
    s_waitcnt lgkmcnt(5)
    v_mfma_f32_32x32x16_bf16 v[164:179], v[132:135], v[32:35], v[164:179]
    buffer_load_dwordx4 v[120:123], v1, s[8:11], s43 offen offset:2048 sc1
    ds_read_b128 v[160:163], v10 offset:36864
    v_mfma_f32_32x32x16_bf16 v[180:195], v[136:139], v[32:35], v[180:195]
    buffer_load_dwordx4 v[124:127], v1, s[8:11], s43 offen offset:3072 sc1
    ds_read_b128 v[132:135], v10 offset:8192
    s_waitcnt lgkmcnt(5)
    v_mfma_f32_32x32x16_bf16 v[164:179], v[140:143], v[36:39], v[164:179]
    ds_read_b128 v[136:139], v10 offset:37888
    v_mfma_f32_32x32x16_bf16 v[180:195], v[144:147], v[36:39], v[180:195]
    ds_read_b128 v[140:143], v10 offset:9216
    s_waitcnt lgkmcnt(5)
    v_mfma_f32_32x32x16_bf16 v[164:179], v[148:151], v[40:43], v[164:179]
    ds_read_b128 v[144:147], v10 offset:38912
    v_mfma_f32_32x32x16_bf16 v[180:195], v[152:155], v[40:43], v[180:195]
    ds_read_b128 v[148:151], v10 offset:10240
    s_waitcnt lgkmcnt(5)
    v_mfma_f32_32x32x16_bf16 v[164:179], v[156:159], v[44:47], v[164:179]
    ds_read_b128 v[152:155], v10 offset:39936
    v_mfma_f32_32x32x16_bf16 v[180:195], v[160:163], v[44:47], v[180:195]
    ds_read_b128 v[156:159], v10 offset:11264
    s_waitcnt vmcnt(23)
    s_waitcnt lgkmcnt(5)
    v_mfma_f32_32x32x16_bf16 v[164:179], v[132:135], v[48:51], v[164:179]
    s_waitcnt vmcnt(16)
    v_add_f32 v3, v212, v214
    v_add_f32 v4, v213, v215
    ds_read_b128 v[160:163], v10 offset:40960
    v_mfma_f32_32x32x16_bf16 v[180:195], v[136:139], v[48:51], v[180:195]
    v_add_f32 v3, v3, v216
    v_add_f32 v4, v4, v217
    v_add_f32 v3, v3, v218
    ds_read_b128 v[132:135], v10 offset:12288
    s_waitcnt lgkmcnt(5)
    v_mfma_f32_32x32x16_bf16 v[164:179], v[140:143], v[52:55], v[164:179]
    v_add_f32 v4, v4, v219
    v_add_f32 v3, v3, v220
    v_add_f32 v4, v4, v221
    ds_read_b128 v[136:139], v10 offset:41984
    v_mfma_f32_32x32x16_bf16 v[180:195], v[144:147], v[52:55], v[180:195]
    v_add_f32 v3, v3, v222
    v_add_f32 v4, v4, v223
    v_add_f32 v3, v3, v224
    ds_read_b128 v[140:143], v10 offset:13312
    s_waitcnt lgkmcnt(5)
    v_mfma_f32_32x32x16_bf16 v[164:179], v[148:151], v[56:59], v[164:179]
    v_add_f32 v4, v4, v225
    v_mov_b32 v228, v3
    v_mov_b32 v229, v4
    ds_read_b128 v[144:147], v10 offset:43008
    v_mfma_f32_32x32x16_bf16 v[180:195], v[152:155], v[56:59], v[180:195]
    v_permlane32_swap_b32 v228, v3
    v_permlane32_swap_b32 v229, v4
    v_add_f32 v3, v228, v3
    ds_read_b128 v[148:151], v10 offset:14336
    s_waitcnt lgkmcnt(5)
    v_mfma_f32_32x32x16_bf16 v[164:179], v[156:159], v[60:63], v[164:179]
    v_add_f32 v4, v229, v4
    v_mul_f32 v3, 0xbb124925, v3
    v_mul_f32 v4, 0x3b124925, v4
    ds_read_b128 v[152:155], v10 offset:44032
    v_mfma_f32_32x32x16_bf16 v[180:195], v[160:163], v[60:63], v[180:195]
    v_fma_f32 v4, -v3, v3, v4
    v_max_f32 v4, 0, v4
    v_add_f32 v9, 0x3727c5ac, v4
    ds_read_b128 v[156:159], v10 offset:15360
    s_waitcnt vmcnt(12)
    s_waitcnt lgkmcnt(5)
    v_mfma_f32_32x32x16_bf16 v[164:179], v[132:135], v[64:67], v[164:179]
    v_cvt_pk_bf16_f32 v128, v3, v3
    v_rsq_f32 v6, v9
    v_lshlrev_b32 v228, 16, v128
    ds_read_b128 v[160:163], v10 offset:45056
    v_mfma_f32_32x32x16_bf16 v[180:195], v[136:139], v[64:67], v[180:195]
    v_sub_f32 v228, v3, v228
    v_cvt_pk_bf16_f32 v129, v228, v228
    v_mov_b32 v130, v128
    ds_read_b128 v[132:135], v10 offset:16384
    s_waitcnt lgkmcnt(5)
    v_mfma_f32_32x32x16_bf16 v[164:179], v[140:143], v[68:71], v[164:179]
    v_mov_b32 v131, v129
    v_mul_f32 v7, 0xc0135761, v6
    v_mul_f32 v228, v6, v6
    ds_read_b128 v[136:139], v10 offset:46080
    v_mfma_f32_32x32x16_bf16 v[180:195], v[144:147], v[68:71], v[180:195]
    v_mul_f32 v228, v228, v6
    v_mul_f32 v8, 0xbdd2d3e8, v228
    v_mov_b32 v14, v7
    ds_read_b128 v[140:143], v10 offset:17408
    s_waitcnt lgkmcnt(5)
    v_mfma_f32_32x32x16_bf16 v[164:179], v[148:151], v[72:75], v[164:179]
    ds_read_b128 v[144:147], v10 offset:47104
    v_mfma_f32_32x32x16_bf16 v[180:195], v[152:155], v[72:75], v[180:195]
    ds_read_b128 v[148:151], v10 offset:18432
    s_waitcnt lgkmcnt(5)
    v_mfma_f32_32x32x16_bf16 v[164:179], v[156:159], v[76:79], v[164:179]
    ds_read_b128 v[152:155], v10 offset:48128
    v_mfma_f32_32x32x16_bf16 v[180:195], v[160:163], v[76:79], v[180:195]
    ds_read_b128 v[156:159], v10 offset:19456
    s_waitcnt vmcnt(8)
    s_waitcnt lgkmcnt(5)
    v_mfma_f32_32x32x16_bf16 v[164:179], v[132:135], v[80:83], v[164:179]
    ds_read_b128 v[160:163], v10 offset:49152
    v_mfma_f32_32x32x16_bf16 v[180:195], v[136:139], v[80:83], v[180:195]
    ds_read_b128 v[132:135], v10 offset:20480
    s_waitcnt lgkmcnt(5)
    v_mfma_f32_32x32x16_bf16 v[164:179], v[140:143], v[84:87], v[164:179]
    ds_read_b128 v[136:139], v10 offset:50176
    v_mfma_f32_32x32x16_bf16 v[180:195], v[144:147], v[84:87], v[180:195]
    ds_read_b128 v[140:143], v10 offset:21504
    s_waitcnt lgkmcnt(5)
    v_mfma_f32_32x32x16_bf16 v[164:179], v[148:151], v[88:91], v[164:179]
    ds_read_b128 v[144:147], v10 offset:51200
    v_mfma_f32_32x32x16_bf16 v[180:195], v[152:155], v[88:91], v[180:195]
    ds_read_b128 v[148:151], v10 offset:22528
    s_waitcnt lgkmcnt(5)
    v_mfma_f32_32x32x16_bf16 v[164:179], v[156:159], v[92:95], v[164:179]
    ds_read_b128 v[152:155], v10 offset:52224
    v_mfma_f32_32x32x16_bf16 v[180:195], v[160:163], v[92:95], v[180:195]
    ds_read_b128 v[156:159], v10 offset:23552
    s_waitcnt vmcnt(4)
    s_waitcnt lgkmcnt(5)
    v_mfma_f32_32x32x16_bf16 v[164:179], v[132:135], v[96:99], v[164:179]
    ds_read_b128 v[160:163], v10 offset:53248
    v_mfma_f32_32x32x16_bf16 v[180:195], v[136:139], v[96:99], v[180:195]
    ds_read_b128 v[132:135], v10 offset:24576
    s_waitcnt lgkmcnt(5)
    v_mfma_f32_32x32x16_bf16 v[164:179], v[140:143], v[100:103], v[164:179]
    ds_read_b128 v[136:139], v10 offset:54272
    v_mfma_f32_32x32x16_bf16 v[180:195], v[144:147], v[100:103], v[180:195]
    ds_read_b128 v[140:143], v10 offset:25600
    s_waitcnt lgkmcnt(5)
    v_mfma_f32_32x32x16_bf16 v[164:179], v[148:151], v[104:107], v[164:179]
    ds_read_b128 v[144:147], v10 offset:55296
    v_mfma_f32_32x32x16_bf16 v[180:195], v[152:155], v[104:107], v[180:195]
    ds_read_b128 v[148:151], v10 offset:26624
    s_waitcnt lgkmcnt(5)
    v_mfma_f32_32x32x16_bf16 v[164:179], v[156:159], v[108:111], v[164:179]
    ds_read_b128 v[152:155], v10 offset:56320
    v_mfma_f32_32x32x16_bf16 v[180:195], v[160:163], v[108:111], v[180:195]
    ds_read_b128 v[156:159], v10 offset:27648
    s_waitcnt vmcnt(0)
    s_waitcnt lgkmcnt(5)
    v_mfma_f32_32x32x16_bf16 v[164:179], v[132:135], v[112:115], v[164:179]
    ds_read_b128 v[160:163], v10 offset:57344
    v_mfma_f32_32x32x16_bf16 v[180:195], v[136:139], v[112:115], v[180:195]
    ds_read_b128 v[132:135], v10 offset:28672
    s_waitcnt lgkmcnt(5)
    v_mfma_f32_32x32x16_bf16 v[164:179], v[140:143], v[116:119], v[164:179]
    ds_read_b128 v[136:139], v10 offset:58368
    v_mfma_f32_32x32x16_bf16 v[180:195], v[144:147], v[116:119], v[180:195]
    s_barrier
    ds_read_b128 v[140:143], v11 offset:0
    s_waitcnt lgkmcnt(5)
    v_mfma_f32_32x32x16_bf16 v[164:179], v[148:151], v[120:123], v[164:179]
    ds_read_b128 v[144:147], v11 offset:1024
    v_mfma_f32_32x32x16_bf16 v[180:195], v[152:155], v[120:123], v[180:195]
    ds_read_b128 v[148:151], v11 offset:2048
    s_waitcnt lgkmcnt(5)
    v_mfma_f32_32x32x16_bf16 v[164:179], v[156:159], v[124:127], v[164:179]
    ds_read_b128 v[152:155], v11 offset:3072
    v_mfma_f32_32x32x16_bf16 v[180:195], v[160:163], v[124:127], v[180:195]
    ds_read_b128 v[156:159], v11 offset:4096
    s_waitcnt lgkmcnt(5)
    v_mfma_f32_32x32x16_bf16 v[164:179], v[132:135], v[128:131], v[164:179]
    ds_read_b128 v[160:163], v11 offset:5120
    v_mfma_f32_32x32x16_bf16 v[180:195], v[136:139], v[128:131], v[180:195]
    ds_read_b128 v[132:135], v11 offset:6144
    s_waitcnt lgkmcnt(5)
    v_mfma_f32_32x32x16_bf16 v[196:211], v[140:143], v[16:19], 0
    s_barrier
    ds_read_b128 v[136:139], v11 offset:7168
    v_mfma_f32_32x32x16_bf16 v[196:211], v[144:147], v[20:23], v[196:211]
    s_nop 3
    v_mul_f32 v228, v164, v164
    v_mul_f32 v229, v165, v165
    v_mul_f32 v230, v166, v166
    v_mul_f32 v231, v167, v167
    ds_read_b128 v[140:143], v11 offset:8192
    s_waitcnt lgkmcnt(5)
    v_mfma_f32_32x32x16_bf16 v[196:211], v[148:151], v[24:27], v[196:211]
    v_fma_f32 v228, v228, v8, v7
    v_fma_f32 v229, v229, v8, v7
    v_fma_f32 v230, v230, v8, v7
    v_fma_f32 v231, v231, v8, v7
    ds_read_b128 v[144:147], v11 offset:9216
    v_mfma_f32_32x32x16_bf16 v[196:211], v[152:155], v[28:31], v[196:211]
    v_mul_f32 v228, v164, v228
    v_mul_f32 v229, v165, v229
    v_mul_f32 v230, v166, v230
    v_mul_f32 v231, v167, v231
    ds_read_b128 v[148:151], v11 offset:10240
    s_waitcnt lgkmcnt(5)
    v_mfma_f32_32x32x16_bf16 v[196:211], v[156:159], v[32:35], v[196:211]
    v_exp_f32 v228, v228
    v_mul_f32 v164, v164, v172
    v_exp_f32 v229, v229
    ds_read_b128 v[152:155], v11 offset:11264
    v_mfma_f32_32x32x16_bf16 v[196:211], v[160:163], v[36:39], v[196:211]
    v_mul_f32 v165, v165, v173
    v_exp_f32 v230, v230
    v_mul_f32 v166, v166, v174
    ds_read_b128 v[156:159], v11 offset:12288
    s_waitcnt lgkmcnt(5)
    v_mfma_f32_32x32x16_bf16 v[196:211], v[132:135], v[40:43], v[196:211]
    v_exp_f32 v231, v231
    v_mul_f32 v167, v167, v175
    v_fma_f32 v228, v228, v9, v9
    ds_read_b128 v[160:163], v11 offset:13312
    v_mfma_f32_32x32x16_bf16 v[196:211], v[136:139], v[44:47], v[196:211]
    v_fma_f32 v229, v229, v9, v9
    v_fma_f32 v230, v230, v9, v9
    v_fma_f32 v231, v231, v9, v9
    v_rcp_f32 v228, v228
    ds_read_b128 v[132:135], v11 offset:14336
    s_waitcnt lgkmcnt(5)
    v_mfma_f32_32x32x16_bf16 v[196:211], v[140:143], v[48:51], v[196:211]
    v_rcp_f32 v229, v229
    v_rcp_f32 v230, v230
    ds_read_b128 v[136:139], v11 offset:15360
    v_mfma_f32_32x32x16_bf16 v[196:211], v[144:147], v[52:55], v[196:211]
    v_rcp_f32 v231, v231
    v_mul_f32 v164, v164, v228
    v_mul_f32 v165, v165, v229
    ds_read_b128 v[140:143], v11 offset:16384
    s_waitcnt lgkmcnt(5)
    v_mfma_f32_32x32x16_bf16 v[196:211], v[148:151], v[56:59], v[196:211]
    v_mul_f32 v166, v166, v230
    v_mul_f32 v167, v167, v231
    v_mul_f32 v232, v168, v168
    v_mul_f32 v233, v169, v169
    ds_read_b128 v[144:147], v11 offset:17408
    v_mfma_f32_32x32x16_bf16 v[196:211], v[152:155], v[60:63], v[196:211]
    v_mul_f32 v234, v170, v170
    v_mul_f32 v235, v171, v171
    v_fma_f32 v232, v232, v8, v7
    v_fma_f32 v233, v233, v8, v7
    ds_read_b128 v[148:151], v11 offset:18432
    s_waitcnt lgkmcnt(5)
    v_mfma_f32_32x32x16_bf16 v[196:211], v[156:159], v[64:67], v[196:211]
    v_fma_f32 v234, v234, v8, v7
    v_fma_f32 v235, v235, v8, v7
    v_mul_f32 v232, v168, v232
    v_mul_f32 v233, v169, v233
    ds_read_b128 v[152:155], v11 offset:19456
    v_mfma_f32_32x32x16_bf16 v[196:211], v[160:163], v[68:71], v[196:211]
    v_mul_f32 v234, v170, v234
    v_mul_f32 v235, v171, v235
    v_exp_f32 v232, v232
    ds_read_b128 v[156:159], v11 offset:20480
    s_waitcnt lgkmcnt(5)
    v_mfma_f32_32x32x16_bf16 v[196:211], v[132:135], v[72:75], v[196:211]
    v_mul_f32 v168, v168, v176
    v_exp_f32 v233, v233
    v_mul_f32 v169, v169, v177
    ds_read_b128 v[160:163], v11 offset:21504
    v_mfma_f32_32x32x16_bf16 v[196:211], v[136:139], v[76:79], v[196:211]
    v_exp_f32 v234, v234
    v_mul_f32 v170, v170, v178
    v_exp_f32 v235, v235
    ds_read_b128 v[132:135], v11 offset:22528
    s_waitcnt lgkmcnt(5)
    v_mfma_f32_32x32x16_bf16 v[196:211], v[140:143], v[80:83], v[196:211]
    v_mul_f32 v171, v171, v179
    v_fma_f32 v232, v232, v9, v9
    v_fma_f32 v233, v233, v9, v9
    v_fma_f32 v234, v234, v9, v9
    ds_read_b128 v[136:139], v11 offset:23552
    v_mfma_f32_32x32x16_bf16 v[196:211], v[144:147], v[84:87], v[196:211]
    v_fma_f32 v235, v235, v9, v9
    v_rcp_f32 v232, v232
    v_rcp_f32 v233, v233
    ds_read_b128 v[140:143], v11 offset:24576
    s_waitcnt lgkmcnt(5)
    v_mfma_f32_32x32x16_bf16 v[196:211], v[148:151], v[88:91], v[196:211]
    v_rcp_f32 v234, v234
    v_rcp_f32 v235, v235
    ds_read_b128 v[144:147], v11 offset:25600
    v_mfma_f32_32x32x16_bf16 v[196:211], v[152:155], v[92:95], v[196:211]
    v_mul_f32 v168, v168, v232
    v_mul_f32 v169, v169, v233
    v_mul_f32 v170, v170, v234
    v_mul_f32 v171, v171, v235
    ds_read_b128 v[148:151], v11 offset:26624
    s_waitcnt lgkmcnt(5)
    v_mfma_f32_32x32x16_bf16 v[196:211], v[156:159], v[96:99], v[196:211]
    v_cvt_pk_bf16_f32 v236, v164, v165
    v_cvt_pk_bf16_f32 v237, v166, v167
    v_cvt_pk_bf16_f32 v238, v168, v169
    v_cvt_pk_bf16_f32 v239, v170, v171
    ds_read_b128 v[152:155], v11 offset:27648
    v_mfma_f32_32x32x16_bf16 v[196:211], v[160:163], v[100:103], v[196:211]
    buffer_store_dwordx4 v[236:239], v1, s[8:11], s44 offen offset:0 sc1
    v_mul_f32 v228, v180, v180
    v_mul_f32 v229, v181, v181
    v_mul_f32 v230, v182, v182
    ds_read_b128 v[156:159], v11 offset:28672
    s_waitcnt lgkmcnt(5)
    v_mfma_f32_32x32x16_bf16 v[196:211], v[132:135], v[104:107], v[196:211]
    v_mul_f32 v231, v183, v183
    v_fma_f32 v228, v228, v8, v7
    v_fma_f32 v229, v229, v8, v7
    v_fma_f32 v230, v230, v8, v7
    ds_read_b128 v[160:163], v11 offset:29696
    v_mfma_f32_32x32x16_bf16 v[196:211], v[136:139], v[108:111], v[196:211]
    v_fma_f32 v231, v231, v8, v7
    v_mul_f32 v228, v180, v228
    v_mul_f32 v229, v181, v229
    v_mul_f32 v230, v182, v230
    ds_read_b128 v[132:135], v11 offset:30720
    s_waitcnt lgkmcnt(5)
    v_mfma_f32_32x32x16_bf16 v[196:211], v[140:143], v[112:115], v[196:211]
    v_mul_f32 v231, v183, v231
    v_exp_f32 v228, v228
    v_mul_f32 v180, v180, v188
    ds_read_b128 v[136:139], v11 offset:31744
    v_mfma_f32_32x32x16_bf16 v[196:211], v[144:147], v[116:119], v[196:211]
    v_exp_f32 v229, v229
    v_mul_f32 v181, v181, v189
    v_exp_f32 v230, v230
    ds_read_b128 v[140:143], v11 offset:32768
    s_waitcnt lgkmcnt(5)
    v_mfma_f32_32x32x16_bf16 v[196:211], v[148:151], v[120:123], v[196:211]
    v_mul_f32 v182, v182, v190
    v_exp_f32 v231, v231
    v_mul_f32 v183, v183, v191
    ds_read_b128 v[144:147], v11 offset:33792
    v_mfma_f32_32x32x16_bf16 v[196:211], v[152:155], v[124:127], v[196:211]
    v_fma_f32 v228, v228, v9, v9
    v_fma_f32 v229, v229, v9, v9
    v_fma_f32 v230, v230, v9, v9
    v_fma_f32 v231, v231, v9, v9
    ds_read_b128 v[148:151], v11 offset:34816
    s_waitcnt lgkmcnt(5)
    v_mfma_f32_32x32x16_bf16 v[196:211], v[156:159], v[128:131], v[196:211]
    v_rcp_f32 v228, v228
    v_rcp_f32 v229, v229
    ds_read_b128 v[152:155], v11 offset:35840
    v_mfma_f32_32x32x16_bf16 v[212:227], v[160:163], v[16:19], 0
    v_rcp_f32 v230, v230
    v_rcp_f32 v231, v231
    s_mov_b64 exec, 1
    v_mov_b32 v253, 163796
    v_mov_b32 v254, 1
    ds_add_u32 v253, v254
    s_mov_b64 exec, -1
    ds_read_b128 v[156:159], v11 offset:36864
    s_waitcnt lgkmcnt(6)
    v_mfma_f32_32x32x16_bf16 v[212:227], v[132:135], v[20:23], v[212:227]
    v_mul_f32 v180, v180, v228
    v_mul_f32 v181, v181, v229
    v_mul_f32 v182, v182, v230
    v_mul_f32 v183, v183, v231
    ds_read_b128 v[160:163], v11 offset:37888
    v_mfma_f32_32x32x16_bf16 v[212:227], v[136:139], v[24:27], v[212:227]
    v_mul_f32 v232, v184, v184
    v_mul_f32 v233, v185, v185
    v_mul_f32 v234, v186, v186
    v_mul_f32 v235, v187, v187
    ds_read_b128 v[132:135], v11 offset:38912
    s_waitcnt lgkmcnt(6)
    v_mfma_f32_32x32x16_bf16 v[212:227], v[140:143], v[28:31], v[212:227]
    v_fma_f32 v232, v232, v8, v7
    v_fma_f32 v233, v233, v8, v7
    v_fma_f32 v234, v234, v8, v7
    v_fma_f32 v235, v235, v8, v7
    ds_read_b128 v[136:139], v11 offset:39936
    v_mfma_f32_32x32x16_bf16 v[212:227], v[144:147], v[32:35], v[212:227]
    v_mul_f32 v232, v184, v232
    v_mul_f32 v233, v185, v233
    v_mul_f32 v234, v186, v234
    v_mul_f32 v235, v187, v235
    ds_read_b128 v[140:143], v11 offset:40960
    s_waitcnt lgkmcnt(6)
    v_mfma_f32_32x32x16_bf16 v[212:227], v[148:151], v[36:39], v[212:227]
    v_exp_f32 v232, v232
    v_mul_f32 v184, v184, v192
    v_exp_f32 v233, v233
    ds_read_b128 v[144:147], v11 offset:41984
    v_mfma_f32_32x32x16_bf16 v[212:227], v[152:155], v[40:43], v[212:227]
    v_mul_f32 v185, v185, v193
    v_exp_f32 v234, v234
    v_mul_f32 v186, v186, v194
    ds_read_b128 v[148:151], v11 offset:43008
    s_waitcnt lgkmcnt(5)
    v_mfma_f32_32x32x16_bf16 v[212:227], v[156:159], v[44:47], v[212:227]
    v_exp_f32 v235, v235
    v_mul_f32 v187, v187, v195
    v_fma_f32 v232, v232, v9, v9
    ds_read_b128 v[152:155], v11 offset:44032
    v_mfma_f32_32x32x16_bf16 v[212:227], v[160:163], v[48:51], v[212:227]
    v_fma_f32 v233, v233, v9, v9
    v_fma_f32 v234, v234, v9, v9
    v_fma_f32 v235, v235, v9, v9
    v_rcp_f32 v232, v232
    ds_read_b128 v[156:159], v11 offset:45056
    s_waitcnt lgkmcnt(5)
    v_mfma_f32_32x32x16_bf16 v[212:227], v[132:135], v[52:55], v[212:227]
    v_rcp_f32 v233, v233
    v_rcp_f32 v234, v234
    ds_read_b128 v[160:163], v11 offset:46080
    v_mfma_f32_32x32x16_bf16 v[212:227], v[136:139], v[56:59], v[212:227]
    v_rcp_f32 v235, v235
    v_mul_f32 v184, v184, v232
    v_mul_f32 v185, v185, v233
    ds_read_b128 v[132:135], v11 offset:47104
    s_waitcnt lgkmcnt(5)
    v_mfma_f32_32x32x16_bf16 v[212:227], v[140:143], v[60:63], v[212:227]
    v_mul_f32 v186, v186, v234
    v_mul_f32 v187, v187, v235
    v_cvt_pk_bf16_f32 v240, v180, v181
    v_cvt_pk_bf16_f32 v241, v182, v183
    ds_read_b128 v[136:139], v11 offset:48128
    v_mfma_f32_32x32x16_bf16 v[212:227], v[144:147], v[64:67], v[212:227]
    v_cvt_pk_bf16_f32 v242, v184, v185
    v_cvt_pk_bf16_f32 v243, v186, v187
    buffer_store_dwordx4 v[240:243], v1, s[8:11], s44 offen offset:1024 sc1
    v_mul_f32 v228, v196, v196
    ds_read_b128 v[140:143], v11 offset:49152
    s_waitcnt lgkmcnt(5)
    v_mfma_f32_32x32x16_bf16 v[212:227], v[148:151], v[68:71], v[212:227]
    v_mul_f32 v229, v197, v197
    v_mul_f32 v230, v198, v198
    v_mul_f32 v231, v199, v199
    v_fma_f32 v228, v228, v8, v7
    ds_read_b128 v[144:147], v11 offset:50176
    v_mfma_f32_32x32x16_bf16 v[212:227], v[152:155], v[72:75], v[212:227]
    v_fma_f32 v229, v229, v8, v7
    v_fma_f32 v230, v230, v8, v7
    v_fma_f32 v231, v231, v8, v7
    v_mul_f32 v228, v196, v228
    ds_read_b128 v[148:151], v11 offset:51200
    s_waitcnt lgkmcnt(5)
    v_mfma_f32_32x32x16_bf16 v[212:227], v[156:159], v[76:79], v[212:227]
    v_mul_f32 v229, v197, v229
    v_mul_f32 v230, v198, v230
    v_mul_f32 v231, v199, v231
    v_exp_f32 v228, v228
    ds_read_b128 v[152:155], v11 offset:52224
    v_mfma_f32_32x32x16_bf16 v[212:227], v[160:163], v[80:83], v[212:227]
    v_mul_f32 v196, v196, v204
    v_exp_f32 v229, v229
    v_mul_f32 v197, v197, v205
    ds_read_b128 v[156:159], v11 offset:53248
    s_waitcnt lgkmcnt(5)
    v_mfma_f32_32x32x16_bf16 v[212:227], v[132:135], v[84:87], v[212:227]
    v_exp_f32 v230, v230
    v_mul_f32 v198, v198, v206
    v_exp_f32 v231, v231
    ds_read_b128 v[160:163], v11 offset:54272
    v_mfma_f32_32x32x16_bf16 v[212:227], v[136:139], v[88:91], v[212:227]
    v_mul_f32 v199, v199, v207
    v_fma_f32 v228, v228, v9, v9
    v_fma_f32 v229, v229, v9, v9
    v_fma_f32 v230, v230, v9, v9
    ds_read_b128 v[132:135], v11 offset:55296
    s_waitcnt lgkmcnt(5)
    v_mfma_f32_32x32x16_bf16 v[212:227], v[140:143], v[92:95], v[212:227]
    v_fma_f32 v231, v231, v9, v9
    v_rcp_f32 v228, v228
    v_rcp_f32 v229, v229
    ds_read_b128 v[136:139], v11 offset:56320
    v_mfma_f32_32x32x16_bf16 v[212:227], v[144:147], v[96:99], v[212:227]
    v_rcp_f32 v230, v230
    v_rcp_f32 v231, v231
    ds_read_b128 v[140:143], v11 offset:57344
    s_waitcnt lgkmcnt(5)
    v_mfma_f32_32x32x16_bf16 v[212:227], v[148:151], v[100:103], v[212:227]
    v_mul_f32 v196, v196, v228
    v_mul_f32 v197, v197, v229
    v_mul_f32 v198, v198, v230
    v_mul_f32 v199, v199, v231
    ds_read_b128 v[144:147], v11 offset:58368
    v_mfma_f32_32x32x16_bf16 v[212:227], v[152:155], v[104:107], v[212:227]
    v_mul_f32 v232, v200, v200
    v_mul_f32 v233, v201, v201
    v_mul_f32 v234, v202, v202
    v_mul_f32 v235, v203, v203
    ds_read_b128 v[148:151], v12 offset:0
    s_waitcnt lgkmcnt(5)
    v_mfma_f32_32x32x16_bf16 v[212:227], v[156:159], v[108:111], v[212:227]
    v_fma_f32 v232, v232, v8, v7
    v_fma_f32 v233, v233, v8, v7
    v_fma_f32 v234, v234, v8, v7
    v_fma_f32 v235, v235, v8, v7
    ds_read_b128 v[152:155], v12 offset:1024
    v_mfma_f32_32x32x16_bf16 v[212:227], v[160:163], v[112:115], v[212:227]
    v_mul_f32 v232, v200, v232
    v_mul_f32 v233, v201, v233
    v_mul_f32 v234, v202, v234
    v_mul_f32 v235, v203, v235
    ds_read_b128 v[156:159], v12 offset:2048
    s_waitcnt lgkmcnt(5)
    v_mfma_f32_32x32x16_bf16 v[212:227], v[132:135], v[116:119], v[212:227]
    v_exp_f32 v232, v232
    v_mul_f32 v200, v200, v208
    v_exp_f32 v233, v233
    ds_read_b128 v[160:163], v12 offset:3072
    v_mfma_f32_32x32x16_bf16 v[212:227], v[136:139], v[120:123], v[212:227]
    v_mul_f32 v201, v201, v209
    v_exp_f32 v234, v234
    v_mul_f32 v202, v202, v210
    ds_read_b128 v[132:135], v12 offset:4096
    s_waitcnt lgkmcnt(5)
    v_mfma_f32_32x32x16_bf16 v[212:227], v[140:143], v[124:127], v[212:227]
    v_exp_f32 v235, v235
    v_mul_f32 v203, v203, v211
    v_fma_f32 v232, v232, v9, v9
    ds_read_b128 v[136:139], v12 offset:5120
    v_mfma_f32_32x32x16_bf16 v[212:227], v[144:147], v[128:131], v[212:227]
    v_fma_f32 v233, v233, v9, v9
    v_fma_f32 v234, v234, v9, v9
    v_fma_f32 v235, v235, v9, v9
    v_rcp_f32 v232, v232
    ds_read_b128 v[140:143], v12 offset:6144
    s_waitcnt lgkmcnt(5)
    v_mfma_f32_32x32x16_bf16 v[164:179], v[148:151], v[16:19], 0
    v_rcp_f32 v233, v233
    v_rcp_f32 v234, v234
    s_mov_b64 exec, 1
    v_mov_b32 v253, 163796
    v_mov_b32 v254, 1
    ds_add_u32 v253, v254
    s_mov_b64 exec, -1
    ds_read_b128 v[144:147], v12 offset:7168
    v_mfma_f32_32x32x16_bf16 v[164:179], v[152:155], v[20:23], v[164:179]
    v_rcp_f32 v235, v235
    v_mul_f32 v200, v200, v232
    v_mul_f32 v201, v201, v233
    ds_read_b128 v[148:151], v12 offset:8192
    s_waitcnt lgkmcnt(6)
    v_mfma_f32_32x32x16_bf16 v[164:179], v[156:159], v[24:27], v[164:179]
    v_mul_f32 v202, v202, v234
    v_mul_f32 v203, v203, v235
    v_cvt_pk_bf16_f32 v236, v196, v197
    v_cvt_pk_bf16_f32 v237, v198, v199
    ds_read_b128 v[152:155], v12 offset:9216
    v_mfma_f32_32x32x16_bf16 v[164:179], v[160:163], v[28:31], v[164:179]
    v_cvt_pk_bf16_f32 v238, v200, v201
    v_cvt_pk_bf16_f32 v239, v202, v203
    buffer_store_dwordx4 v[236:239], v1, s[8:11], s44 offen offset:2048 sc1
    v_mul_f32 v228, v212, v212
    ds_read_b128 v[156:159], v12 offset:10240
    s_waitcnt lgkmcnt(6)
    v_mfma_f32_32x32x16_bf16 v[164:179], v[132:135], v[32:35], v[164:179]
    v_mul_f32 v229, v213, v213
    v_mul_f32 v230, v214, v214
    v_mul_f32 v231, v215, v215
    v_fma_f32 v228, v228, v8, v7
    ds_read_b128 v[160:163], v12 offset:11264
    v_mfma_f32_32x32x16_bf16 v[164:179], v[136:139], v[36:39], v[164:179]
    v_fma_f32 v229, v229, v8, v7
    v_fma_f32 v230, v230, v8, v7
    v_fma_f32 v231, v231, v8, v7
    v_mul_f32 v228, v212, v228
    ds_read_b128 v[132:135], v12 offset:12288
    s_waitcnt lgkmcnt(5)
    v_mfma_f32_32x32x16_bf16 v[164:179], v[140:143], v[40:43], v[164:179]
    v_mul_f32 v229, v213, v229
    v_mul_f32 v230, v214, v230
    v_mul_f32 v231, v215, v231
    v_exp_f32 v228, v228
    ds_read_b128 v[136:139], v12 offset:13312
    v_mfma_f32_32x32x16_bf16 v[164:179], v[144:147], v[44:47], v[164:179]
    v_mul_f32 v212, v212, v220
    v_exp_f32 v229, v229
    v_mul_f32 v213, v213, v221
    ds_read_b128 v[140:143], v12 offset:14336
    s_waitcnt lgkmcnt(5)
    v_mfma_f32_32x32x16_bf16 v[164:179], v[148:151], v[48:51], v[164:179]
    v_exp_f32 v230, v230
    v_mul_f32 v214, v214, v222
    v_exp_f32 v231, v231
    ds_read_b128 v[144:147], v12 offset:15360
    v_mfma_f32_32x32x16_bf16 v[164:179], v[152:155], v[52:55], v[164:179]
    v_mul_f32 v215, v215, v223
    v_fma_f32 v228, v228, v9, v9
    v_fma_f32 v229, v229, v9, v9
    v_fma_f32 v230, v230, v9, v9
    ds_read_b128 v[148:151], v12 offset:16384
    s_waitcnt lgkmcnt(5)
    v_mfma_f32_32x32x16_bf16 v[164:179], v[156:159], v[56:59], v[164:179]
    v_fma_f32 v231, v231, v9, v9
    v_rcp_f32 v228, v228
    v_rcp_f32 v229, v229
    ds_read_b128 v[152:155], v12 offset:17408
    v_mfma_f32_32x32x16_bf16 v[164:179], v[160:163], v[60:63], v[164:179]
    v_rcp_f32 v230, v230
    v_rcp_f32 v231, v231
    ds_read_b128 v[156:159], v12 offset:18432
    s_waitcnt lgkmcnt(5)
    v_mfma_f32_32x32x16_bf16 v[164:179], v[132:135], v[64:67], v[164:179]
    v_mul_f32 v212, v212, v228
    v_mul_f32 v213, v213, v229
    v_mul_f32 v214, v214, v230
    v_mul_f32 v215, v215, v231
    ds_read_b128 v[160:163], v12 offset:19456
    v_mfma_f32_32x32x16_bf16 v[164:179], v[136:139], v[68:71], v[164:179]
    v_mul_f32 v232, v216, v216
    v_mul_f32 v233, v217, v217
    v_mul_f32 v234, v218, v218
    v_mul_f32 v235, v219, v219
    ds_read_b128 v[132:135], v12 offset:20480
    s_waitcnt lgkmcnt(5)
    v_mfma_f32_32x32x16_bf16 v[164:179], v[140:143], v[72:75], v[164:179]
    v_fma_f32 v232, v232, v8, v7
    v_fma_f32 v233, v233, v8, v7
    v_fma_f32 v234, v234, v8, v7
    v_fma_f32 v235, v235, v8, v7
    ds_read_b128 v[136:139], v12 offset:21504
    v_mfma_f32_32x32x16_bf16 v[164:179], v[144:147], v[76:79], v[164:179]
    v_mul_f32 v232, v216, v232
    v_mul_f32 v233, v217, v233
    v_mul_f32 v234, v218, v234
    v_mul_f32 v235, v219, v235
    ds_read_b128 v[140:143], v12 offset:22528
    s_waitcnt lgkmcnt(5)
    v_mfma_f32_32x32x16_bf16 v[164:179], v[148:151], v[80:83], v[164:179]
    v_exp_f32 v232, v232
    v_mul_f32 v216, v216, v224
    v_exp_f32 v233, v233
    ds_read_b128 v[144:147], v12 offset:23552
    v_mfma_f32_32x32x16_bf16 v[164:179], v[152:155], v[84:87], v[164:179]
    v_mul_f32 v217, v217, v225
    v_exp_f32 v234, v234
    v_mul_f32 v218, v218, v226
    ds_read_b128 v[148:151], v12 offset:24576
    s_waitcnt lgkmcnt(5)
    v_mfma_f32_32x32x16_bf16 v[164:179], v[156:159], v[88:91], v[164:179]
    v_exp_f32 v235, v235
    v_mul_f32 v219, v219, v227
    v_fma_f32 v232, v232, v9, v9
    ds_read_b128 v[152:155], v12 offset:25600
    v_mfma_f32_32x32x16_bf16 v[164:179], v[160:163], v[92:95], v[164:179]
    v_fma_f32 v233, v233, v9, v9
    v_fma_f32 v234, v234, v9, v9
    v_fma_f32 v235, v235, v9, v9
    v_rcp_f32 v232, v232
    ds_read_b128 v[156:159], v12 offset:26624
    s_waitcnt lgkmcnt(5)
    v_mfma_f32_32x32x16_bf16 v[164:179], v[132:135], v[96:99], v[164:179]
    v_rcp_f32 v233, v233
    v_rcp_f32 v234, v234
    ds_read_b128 v[160:163], v12 offset:27648
    v_mfma_f32_32x32x16_bf16 v[164:179], v[136:139], v[100:103], v[164:179]
    v_rcp_f32 v235, v235
    v_mul_f32 v216, v216, v232
    v_mul_f32 v217, v217, v233
    ds_read_b128 v[132:135], v12 offset:28672
    s_waitcnt lgkmcnt(5)
    v_mfma_f32_32x32x16_bf16 v[164:179], v[140:143], v[104:107], v[164:179]
    v_mul_f32 v218, v218, v234
    v_mul_f32 v219, v219, v235
    v_cvt_pk_bf16_f32 v240, v212, v213
    v_cvt_pk_bf16_f32 v241, v214, v215
    v_mov_b32 v253, 163800
mega_kernel_c_lw93:
    ds_read_b32 v254, v253
    s_waitcnt lgkmcnt(0)
    v_readfirstlane_b32 s62, v254
    s_nop 1
    s_cmp_ge_u32 s62, 8
    s_cbranch_scc1 mega_kernel_c_lwd94
    s_sleep 1
    s_sub_u32 s25, s25, 1
    s_cbranch_scc0 mega_kernel_c_lw93
    s_mov_b32 s25, 0
mega_kernel_c_lwd94:
    ds_read_b128 v[136:139], v10 offset:0
    v_mfma_f32_32x32x16_bf16 v[164:179], v[144:147], v[108:111], v[164:179]
    v_cvt_pk_bf16_f32 v242, v216, v217
    v_cvt_pk_bf16_f32 v243, v218, v219
    buffer_store_dwordx4 v[240:243], v1, s[8:11], s44 offen offset:3072 sc1
    ds_read_b128 v[140:143], v10 offset:1024
    v_mfma_f32_32x32x16_bf16 v[164:179], v[148:151], v[112:115], v[164:179]
    ds_read_b128 v[144:147], v10 offset:2048
    v_mfma_f32_32x32x16_bf16 v[164:179], v[152:155], v[116:119], v[164:179]
    ds_read_b128 v[148:151], v10 offset:3072
    v_mfma_f32_32x32x16_bf16 v[164:179], v[156:159], v[120:123], v[164:179]
    ds_read_b128 v[152:155], v10 offset:4096
    v_mfma_f32_32x32x16_bf16 v[164:179], v[160:163], v[124:127], v[164:179]
    ds_read_b128 v[156:159], v10 offset:5120
    s_waitcnt lgkmcnt(5)
    v_mfma_f32_32x32x16_bf16 v[164:179], v[132:135], v[128:131], v[164:179]
    ds_read_b128 v[160:163], v10 offset:6144
    v_mfma_f32_32x32x16_bf16 v[180:195], v[136:139], v[16:19], 0
    s_mov_b64 exec, 1
    v_mov_b32 v253, 163796
    v_mov_b32 v254, 1
    ds_add_u32 v253, v254
    s_mov_b64 exec, -1
    ds_read_b128 v[132:135], v10 offset:7168
    s_waitcnt lgkmcnt(6)
    v_mfma_f32_32x32x16_bf16 v[180:195], v[140:143], v[20:23], v[180:195]
    s_nop 1
    v_mul_f32 v228, v164, v164
    v_mul_f32 v229, v165, v165
    v_mul_f32 v230, v166, v166
    v_mul_f32 v231, v167, v167
    ds_read_b128 v[136:139], v10 offset:8192
    v_mfma_f32_32x32x16_bf16 v[180:195], v[144:147], v[24:27], v[180:195]
    v_fma_f32 v228, v228, v8, v7
    v_fma_f32 v229, v229, v8, v7
    v_fma_f32 v230, v230, v8, v7
    v_fma_f32 v231, v231, v8, v7
    ds_read_b128 v[140:143], v10 offset:9216
    s_waitcnt lgkmcnt(6)
    v_mfma_f32_32x32x16_bf16 v[180:195], v[148:151], v[28:31], v[180:195]
    v_mul_f32 v228, v164, v228
    v_mul_f32 v229, v165, v229
    v_mul_f32 v230, v166, v230
    v_mul_f32 v231, v167, v231
    ds_read_b128 v[144:147], v10 offset:10240
    v_mfma_f32_32x32x16_bf16 v[180:195], v[152:155], v[32:35], v[180:195]
    v_exp_f32 v228, v228
    v_mul_f32 v164, v164, v172
    v_exp_f32 v229, v229
    ds_read_b128 v[148:151], v10 offset:11264
    s_waitcnt lgkmcnt(6)
    v_mfma_f32_32x32x16_bf16 v[180:195], v[156:159], v[36:39], v[180:195]
    v_mul_f32 v165, v165, v173
    v_exp_f32 v230, v230
    v_mul_f32 v166, v166, v174
    ds_read_b128 v[152:155], v10 offset:12288
    v_mfma_f32_32x32x16_bf16 v[180:195], v[160:163], v[40:43], v[180:195]
    v_exp_f32 v231, v231
    v_mul_f32 v167, v167, v175
    v_fma_f32 v228, v228, v9, v9
    ds_read_b128 v[156:159], v10 offset:13312
    s_waitcnt lgkmcnt(5)
    v_mfma_f32_32x32x16_bf16 v[180:195], v[132:135], v[44:47], v[180:195]
    v_fma_f32 v229, v229, v9, v9
    v_fma_f32 v230, v230, v9, v9
    v_fma_f32 v231, v231, v9, v9
    v_rcp_f32 v228, v228
    ds_read_b128 v[160:163], v10 offset:14336
    v_mfma_f32_32x32x16_bf16 v[180:195], v[136:139], v[48:51], v[180:195]
    v_rcp_f32 v229, v229
    v_rcp_f32 v230, v230
    ds_read_b128 v[132:135], v10 offset:15360
    s_waitcnt lgkmcnt(5)
    v_mfma_f32_32x32x16_bf16 v[180:195], v[140:143], v[52:55], v[180:195]
    v_rcp_f32 v231, v231
    v_mul_f32 v164, v164, v228
    v_mul_f32 v165, v165, v229
    ds_read_b128 v[136:139], v10 offset:16384
    v_mfma_f32_32x32x16_bf16 v[180:195], v[144:147], v[56:59], v[180:195]
    v_mul_f32 v166, v166, v230
    v_mul_f32 v167, v167, v231
    v_mul_f32 v232, v168, v168
    v_mul_f32 v233, v169, v169
    ds_read_b128 v[140:143], v10 offset:17408
    s_waitcnt lgkmcnt(5)
    v_mfma_f32_32x32x16_bf16 v[180:195], v[148:151], v[60:63], v[180:195]
    v_mul_f32 v234, v170, v170
    v_mul_f32 v235, v171, v171
    v_fma_f32 v232, v232, v8, v7
    v_fma_f32 v233, v233, v8, v7
    ds_read_b128 v[144:147], v10 offset:18432
    v_mfma_f32_32x32x16_bf16 v[180:195], v[152:155], v[64:67], v[180:195]
    v_fma_f32 v234, v234, v8, v7
    v_fma_f32 v235, v235, v8, v7
    v_mul_f32 v232, v168, v232
    v_mul_f32 v233, v169, v233
    ds_read_b128 v[148:151], v10 offset:19456
    s_waitcnt lgkmcnt(5)
    v_mfma_f32_32x32x16_bf16 v[180:195], v[156:159], v[68:71], v[180:195]
    v_mul_f32 v234, v170, v234
    v_mul_f32 v235, v171, v235
    v_exp_f32 v232, v232
    ds_read_b128 v[152:155], v10 offset:20480
    v_mfma_f32_32x32x16_bf16 v[180:195], v[160:163], v[72:75], v[180:195]
    v_mul_f32 v168, v168, v176
    v_exp_f32 v233, v233
    v_mul_f32 v169, v169, v177
    ds_read_b128 v[156:159], v10 offset:21504
    s_waitcnt lgkmcnt(5)
    v_mfma_f32_32x32x16_bf16 v[180:195], v[132:135], v[76:79], v[180:195]
    v_exp_f32 v234, v234
    v_mul_f32 v170, v170, v178
    v_exp_f32 v235, v235
    ds_read_b128 v[160:163], v10 offset:22528
    v_mfma_f32_32x32x16_bf16 v[180:195], v[136:139], v[80:83], v[180:195]
    v_mul_f32 v171, v171, v179
    v_fma_f32 v232, v232, v9, v9
    v_fma_f32 v233, v233, v9, v9
    v_fma_f32 v234, v234, v9, v9
    ds_read_b128 v[132:135], v10 offset:23552
    s_waitcnt lgkmcnt(5)
    v_mfma_f32_32x32x16_bf16 v[180:195], v[140:143], v[84:87], v[180:195]
    v_fma_f32 v235, v235, v9, v9
    v_rcp_f32 v232, v232
    v_rcp_f32 v233, v233
    ds_read_b128 v[136:139], v10 offset:24576
    v_mfma_f32_32x32x16_bf16 v[180:195], v[144:147], v[88:91], v[180:195]
    v_rcp_f32 v234, v234
    v_rcp_f32 v235, v235
    ds_read_b128 v[140:143], v10 offset:25600
    s_waitcnt lgkmcnt(5)
    v_mfma_f32_32x32x16_bf16 v[180:195], v[148:151], v[92:95], v[180:195]
    v_mul_f32 v168, v168, v232
    v_mul_f32 v169, v169, v233
    v_mul_f32 v170, v170, v234
    v_mul_f32 v171, v171, v235
    ds_read_b128 v[144:147], v10 offset:26624
    v_mfma_f32_32x32x16_bf16 v[180:195], v[152:155], v[96:99], v[180:195]
    v_cvt_pk_bf16_f32 v236, v164, v165
    v_cvt_pk_bf16_f32 v237, v166, v167
    v_cvt_pk_bf16_f32 v238, v168, v169
    v_cvt_pk_bf16_f32 v239, v170, v171
    ds_read_b128 v[148:151], v10 offset:27648
    s_waitcnt lgkmcnt(5)
    v_mfma_f32_32x32x16_bf16 v[180:195], v[156:159], v[100:103], v[180:195]
    buffer_store_dwordx4 v[236:239], v1, s[8:11], s45 offen offset:0 sc1
    v_mul_u32_u24 v255, 256, v0
    v_mov_b32 v254, 1
    v_mov_b32 v253, 163776
    s_waitcnt vmcnt(1)
    s_mov_b64 exec, 1
    ds_add_rtn_u32 v253, v253, v254
    s_waitcnt lgkmcnt(0)
    v_readfirstlane_b32 s62, v253
    s_mov_b64 exec, 16383
    s_and_b32 s62, s62, 3
    s_cmp_lg_u32 s62, 3
    s_cbranch_scc1 mega_kernel_c_sig95
    buffer_store_dword v254, v255, s[8:11], s47 offen sc1
mega_kernel_c_sig95:
    s_mov_b64 exec, -1
    ds_read_b128 v[152:155], v10 offset:28672
    v_mfma_f32_32x32x16_bf16 v[180:195], v[160:163], v[104:107], v[180:195]
    ds_read_b128 v[156:159], v10 offset:29696
    v_mfma_f32_32x32x16_bf16 v[180:195], v[132:135], v[108:111], v[180:195]
    ds_read_b128 v[160:163], v10 offset:30720
    v_mfma_f32_32x32x16_bf16 v[180:195], v[136:139], v[112:115], v[180:195]
    ds_read_b128 v[132:135], v10 offset:31744
    v_mfma_f32_32x32x16_bf16 v[180:195], v[140:143], v[116:119], v[180:195]
    ds_read_b128 v[136:139], v10 offset:32768
    v_mfma_f32_32x32x16_bf16 v[180:195], v[144:147], v[120:123], v[180:195]
    ds_read_b128 v[140:143], v10 offset:33792
    s_waitcnt lgkmcnt(5)
    v_mfma_f32_32x32x16_bf16 v[180:195], v[148:151], v[124:127], v[180:195]
    ds_read_b128 v[144:147], v10 offset:34816
    v_mfma_f32_32x32x16_bf16 v[180:195], v[152:155], v[128:131], v[180:195]
    ds_read_b128 v[148:151], v10 offset:35840
    s_waitcnt lgkmcnt(5)
    v_mfma_f32_32x32x16_bf16 v[196:211], v[156:159], v[16:19], 0
    ds_read_b128 v[152:155], v10 offset:36864
    v_mfma_f32_32x32x16_bf16 v[196:211], v[160:163], v[20:23], v[196:211]
    s_nop 6
    v_mul_f32 v228, v180, v180
    v_mul_f32 v229, v181, v181
    v_mul_f32 v230, v182, v182
    v_mul_f32 v231, v183, v183
    ds_read_b128 v[156:159], v10 offset:37888
    s_waitcnt lgkmcnt(5)
    v_mfma_f32_32x32x16_bf16 v[196:211], v[132:135], v[24:27], v[196:211]
    v_fma_f32 v228, v228, v8, v7
    v_fma_f32 v229, v229, v8, v7
    v_fma_f32 v230, v230, v8, v7
    v_fma_f32 v231, v231, v8, v7
    ds_read_b128 v[160:163], v10 offset:38912
    v_mfma_f32_32x32x16_bf16 v[196:211], v[136:139], v[28:31], v[196:211]
    v_mul_f32 v228, v180, v228
    v_mul_f32 v229, v181, v229
    v_mul_f32 v230, v182, v230
    v_mul_f32 v231, v183, v231
    ds_read_b128 v[132:135], v10 offset:39936
    s_waitcnt lgkmcnt(5)
    v_mfma_f32_32x32x16_bf16 v[196:211], v[140:143], v[32:35], v[196:211]
    v_exp_f32 v228, v228
    v_mul_f32 v180, v180, v188
    v_exp_f32 v229, v229
    ds_read_b128 v[136:139], v10 offset:40960
    v_mfma_f32_32x32x16_bf16 v[196:211], v[144:147], v[36:39], v[196:211]
    v_mul_f32 v181, v181, v189
    v_exp_f32 v230, v230
    v_mul_f32 v182, v182, v190
    ds_read_b128 v[140:143], v10 offset:41984
    s_waitcnt lgkmcnt(5)
    v_mfma_f32_32x32x16_bf16 v[196:211], v[148:151], v[40:43], v[196:211]
    v_exp_f32 v231, v231
    v_mul_f32 v183, v183, v191
    v_fma_f32 v228, v228, v9, v9
    ds_read_b128 v[144:147], v10 offset:43008
    v_mfma_f32_32x32x16_bf16 v[196:211], v[152:155], v[44:47], v[196:211]
    v_fma_f32 v229, v229, v9, v9
    v_fma_f32 v230, v230, v9, v9
    v_fma_f32 v231, v231, v9, v9
    v_rcp_f32 v228, v228
    ds_read_b128 v[148:151], v10 offset:44032
    s_waitcnt lgkmcnt(5)
    v_mfma_f32_32x32x16_bf16 v[196:211], v[156:159], v[48:51], v[196:211]
    v_rcp_f32 v229, v229
    v_rcp_f32 v230, v230
    ds_read_b128 v[152:155], v10 offset:45056
    v_mfma_f32_32x32x16_bf16 v[196:211], v[160:163], v[52:55], v[196:211]
    v_rcp_f32 v231, v231
    v_mul_f32 v180, v180, v228
    v_mul_f32 v181, v181, v229
    ds_read_b128 v[156:159], v10 offset:46080
    s_waitcnt lgkmcnt(5)
    v_mfma_f32_32x32x16_bf16 v[196:211], v[132:135], v[56:59], v[196:211]
    v_mul_f32 v182, v182, v230
    v_mul_f32 v183, v183, v231
    v_mul_f32 v232, v184, v184
    v_mul_f32 v233, v185, v185
    ds_read_b128 v[160:163], v10 offset:47104
    v_mfma_f32_32x32x16_bf16 v[196:211], v[136:139], v[60:63], v[196:211]
    v_mul_f32 v234, v186, v186
    v_mul_f32 v235, v187, v187
    v_fma_f32 v232, v232, v8, v7
    v_fma_f32 v233, v233, v8, v7
    ds_read_b128 v[132:135], v10 offset:48128
    s_waitcnt lgkmcnt(5)
    v_mfma_f32_32x32x16_bf16 v[196:211], v[140:143], v[64:67], v[196:211]
    v_fma_f32 v234, v234, v8, v7
    v_fma_f32 v235, v235, v8, v7
    v_mul_f32 v232, v184, v232
    v_mul_f32 v233, v185, v233
    ds_read_b128 v[136:139], v10 offset:49152
    v_mfma_f32_32x32x16_bf16 v[196:211], v[144:147], v[68:71], v[196:211]
    v_mul_f32 v234, v186, v234
    v_mul_f32 v235, v187, v235
    v_exp_f32 v232, v232
    s_lshl_b32 s49, s56, 8
    s_add_u32 s49, s49, 70991872
    s_cmp_lg_u32 s12, 0
    s_cbranch_scc1 mega_kernel_c_w096
    buffer_load_dword v252, v2, s[8:11], s49 offen sc1
mega_kernel_c_w096:
    ds_read_b128 v[140:143], v10 offset:50176
    s_waitcnt lgkmcnt(5)
    v_mfma_f32_32x32x16_bf16 v[196:211], v[148:151], v[72:75], v[196:211]
    v_mul_f32 v184, v184, v192
    v_exp_f32 v233, v233
    v_mul_f32 v185, v185, v193
    ds_read_b128 v[144:147], v10 offset:51200
    v_mfma_f32_32x32x16_bf16 v[196:211], v[152:155], v[76:79], v[196:211]
    v_exp_f32 v234, v234
    v_mul_f32 v186, v186, v194
    v_exp_f32 v235, v235
    ds_read_b128 v[148:151], v10 offset:52224
    s_waitcnt lgkmcnt(5)
    v_mfma_f32_32x32x16_bf16 v[196:211], v[156:159], v[80:83], v[196:211]
    v_mul_f32 v187, v187, v195
    v_fma_f32 v232, v232, v9, v9
    v_fma_f32 v233, v233, v9, v9
    v_fma_f32 v234, v234, v9, v9
    ds_read_b128 v[152:155], v10 offset:53248
    v_mfma_f32_32x32x16_bf16 v[196:211], v[160:163], v[84:87], v[196:211]
    v_fma_f32 v235, v235, v9, v9
    v_rcp_f32 v232, v232
    v_rcp_f32 v233, v233
    ds_read_b128 v[156:159], v10 offset:54272
    s_waitcnt lgkmcnt(5)
    v_mfma_f32_32x32x16_bf16 v[196:211], v[132:135], v[88:91], v[196:211]
    v_rcp_f32 v234, v234
    v_rcp_f32 v235, v235
    ds_read_b128 v[160:163], v10 offset:55296
    v_mfma_f32_32x32x16_bf16 v[196:211], v[136:139], v[92:95], v[196:211]
    v_mul_f32 v184, v184, v232
    v_mul_f32 v185, v185, v233
    v_mul_f32 v186, v186, v234
    v_mul_f32 v187, v187, v235
    ds_read_b128 v[132:135], v10 offset:56320
    s_waitcnt lgkmcnt(5)
    v_mfma_f32_32x32x16_bf16 v[196:211], v[140:143], v[96:99], v[196:211]
    v_cvt_pk_bf16_f32 v240, v180, v181
    v_cvt_pk_bf16_f32 v241, v182, v183
    v_cvt_pk_bf16_f32 v242, v184, v185
    v_cvt_pk_bf16_f32 v243, v186, v187
    ds_read_b128 v[136:139], v10 offset:57344
    v_mfma_f32_32x32x16_bf16 v[196:211], v[144:147], v[100:103], v[196:211]
    buffer_store_dwordx4 v[240:243], v1, s[8:11], s45 offen offset:1024 sc1
    ds_read_b128 v[140:143], v10 offset:58368
    s_waitcnt lgkmcnt(5)
    v_mfma_f32_32x32x16_bf16 v[196:211], v[148:151], v[104:107], v[196:211]
    v_mfma_f32_32x32x16_bf16 v[196:211], v[152:155], v[108:111], v[196:211]
    s_waitcnt lgkmcnt(3)
    v_mfma_f32_32x32x16_bf16 v[196:211], v[156:159], v[112:115], v[196:211]
    v_mfma_f32_32x32x16_bf16 v[196:211], v[160:163], v[116:119], v[196:211]
    s_waitcnt lgkmcnt(1)
    v_mfma_f32_32x32x16_bf16 v[196:211], v[132:135], v[120:123], v[196:211]
    v_mfma_f32_32x32x16_bf16 v[196:211], v[136:139], v[124:127], v[196:211]
    s_waitcnt lgkmcnt(0)
    v_mfma_f32_32x32x16_bf16 v[196:211], v[140:143], v[128:131], v[196:211]
    s_mov_b64 exec, 1
    v_mov_b32 v253, 163796
    v_mov_b32 v254, 1
    ds_add_u32 v253, v254
    s_mov_b64 exec, -1
    s_nop 6
    v_pk_mul_f32 v[228:229], v[196:197], v[196:197]
    v_pk_mul_f32 v[230:231], v[198:199], v[198:199]
    v_pk_fma_f32 v[228:229], v[228:229], v[8:9], v[14:15] op_sel_hi:[1,0,0]
    v_pk_fma_f32 v[230:231], v[230:231], v[8:9], v[14:15] op_sel_hi:[1,0,0]
    v_pk_mul_f32 v[228:229], v[196:197], v[228:229]
    v_pk_mul_f32 v[230:231], v[198:199], v[230:231]
    v_exp_f32 v228, v228
    v_pk_mul_f32 v[196:197], v[196:197], v[204:205]
    v_exp_f32 v229, v229
    v_exp_f32 v230, v230
    v_pk_mul_f32 v[198:199], v[198:199], v[206:207]
    v_exp_f32 v231, v231
    v_pk_fma_f32 v[228:229], v[228:229], v[8:9], v[8:9] op_sel:[0,1,1] op_sel_hi:[1,1,1]
    v_pk_fma_f32 v[230:231], v[230:231], v[8:9], v[8:9] op_sel:[0,1,1] op_sel_hi:[1,1,1]
    v_rcp_f32 v228, v228
    v_rcp_f32 v229, v229
    v_rcp_f32 v230, v230
    v_rcp_f32 v231, v231
    v_pk_mul_f32 v[196:197], v[196:197], v[228:229]
    v_pk_mul_f32 v[198:199], v[198:199], v[230:231]
    v_pk_mul_f32 v[232:233], v[200:201], v[200:201]
    v_pk_mul_f32 v[234:235], v[202:203], v[202:203]
    v_pk_fma_f32 v[232:233], v[232:233], v[8:9], v[14:15] op_sel_hi:[1,0,0]
    v_pk_fma_f32 v[234:235], v[234:235], v[8:9], v[14:15] op_sel_hi:[1,0,0]
    v_pk_mul_f32 v[232:233], v[200:201], v[232:233]
    v_pk_mul_f32 v[234:235], v[202:203], v[234:235]
    v_exp_f32 v232, v232
    v_pk_mul_f32 v[200:201], v[200:201], v[208:209]
    v_exp_f32 v233, v233
    v_exp_f32 v234, v234
    v_pk_mul_f32 v[202:203], v[202:203], v[210:211]
    v_exp_f32 v235, v235
    v_pk_fma_f32 v[232:233], v[232:233], v[8:9], v[8:9] op_sel:[0,1,1] op_sel_hi:[1,1,1]
    v_pk_fma_f32 v[234:235], v[234:235], v[8:9], v[8:9] op_sel:[0,1,1] op_sel_hi:[1,1,1]
    v_rcp_f32 v232, v232
    v_rcp_f32 v233, v233
    v_rcp_f32 v234, v234
    v_rcp_f32 v235, v235
    v_pk_mul_f32 v[200:201], v[200:201], v[232:233]
    v_pk_mul_f32 v[202:203], v[202:203], v[234:235]
    v_cvt_pk_bf16_f32 v236, v196, v197
    v_cvt_pk_bf16_f32 v237, v198, v199
    v_cvt_pk_bf16_f32 v238, v200, v201
    v_cvt_pk_bf16_f32 v239, v202, v203
    buffer_store_dwordx4 v[236:239], v1, s[8:11], s45 offen offset:2048 sc1
    v_mul_u32_u24 v255, 256, v0
    v_mov_b32 v254, 1
    v_mov_b32 v253, 163776
    s_waitcnt vmcnt(0)
    s_mov_b64 exec, 1
    ds_add_rtn_u32 v253, v253, v254
    s_waitcnt lgkmcnt(0)
    v_readfirstlane_b32 s62, v253
    s_mov_b64 exec, 16383
    s_and_b32 s62, s62, 3
    s_cmp_lg_u32 s62, 3
    s_cbranch_scc1 mega_kernel_c_sig97
    buffer_store_dword v254, v255, s[8:11], s48 offen sc1
mega_kernel_c_sig97:
    s_mov_b64 exec, -1
    s_cmp_eq_u32 s24, 0
    s_cbranch_scc1 mega_kernel_c_skip98
    s_and_b32 s43, s13, 1
    s_lshr_b32 s44, s13, 1
    s_lshl_b32 s40, s22, 1
    s_add_u32 s40, s40, s43
    s_lshl_b32 s41, s23, 1
    s_add_u32 s41, s41, s44
    s_mul_i32 s42, s40, 28
    s_lshl_b32 s45, s41, 1
    s_add_u32 s42, s42, s45
    s_lshl_b32 s42, s42, 10
    s_add_u32 s45, s42, 16777216
    buffer_load_dwordx4 v[48:51], v1, s[8:11], s45 offen offset:0 sc1
    buffer_load_dwordx4 v[52:55], v1, s[8:11], s45 offen offset:1024 sc1
    s_mul_i32 s47, s40, 114688
    s_lshl_b32 s45, s44, 11
    s_add_u32 s47, s47, s45
    s_add_u32 s47, s47, 60817408
    s_mul_i32 s48, s44, 4096
    s_add_u32 s48, s48, s45
    s_xor_b32 s49, s44, 1
    s_mul_i32 s49, s49, 4096
    s_add_u32 s49, s49, s45
    v_add_u32 v3, s48, v1
    v_add_u32 v6, s49, v1
    v_add_u32 v4, s48, v1
    v_add_u32 v7, s49, v1
    v_add_u32 v4, 61440, v4
    v_add_u32 v7, 61440, v7
    v_add_u32 v5, s48, v1
    v_add_u32 v8, s49, v1
    v_add_u32 v5, 122880, v5
    v_add_u32 v8, 122880, v8
    s_lshl_b32 s48, s13, 12
    s_add_u32 s48, s48, 0
    v_add_u32 v9, s48, v1
    s_xor_b32 s48, s13, 2
    s_lshl_b32 s48, s48, 12
    s_add_u32 s48, s48, 0
    v_add_u32 v10, s48, v1
    s_waitcnt vmcnt(0)
    v_lshlrev_b32 v16, 16, v48
    v_and_b32 v17, 0xffff0000, v48
    v_lshlrev_b32 v18, 16, v49
    v_and_b32 v19, 0xffff0000, v49
    v_lshlrev_b32 v20, 16, v50
    v_and_b32 v21, 0xffff0000, v50
    v_lshlrev_b32 v22, 16, v51
    v_and_b32 v23, 0xffff0000, v51
    v_lshlrev_b32 v24, 16, v52
    v_and_b32 v25, 0xffff0000, v52
    v_lshlrev_b32 v26, 16, v53
    v_and_b32 v27, 0xffff0000, v53
    v_lshlrev_b32 v28, 16, v54
    v_and_b32 v29, 0xffff0000, v54
    v_lshlrev_b32 v30, 16, v55
    v_and_b32 v31, 0xffff0000, v55
    v_mov_b32 v48, 0x3f803f80
    s_lshl_b32 s46, s56, 8
    s_add_u32 s46, s46, 70991872
    s_cmp_lg_u32 s12, 0
    s_cbranch_scc1 mega_kernel_c_dwo99
    v_cmp_eq_u32 vcc, 0, v252
    s_nop 1
    s_and_b64 vcc, vcc, s[60:61]
    s_cbranch_scc0 mega_kernel_c_mbd102
mega_kernel_c_mbw101:
    buffer_load_dword v252, v2, s[8:11], s46 offen sc1
    s_waitcnt vmcnt(0)
    v_cmp_eq_u32 vcc, 0, v252
    s_nop 1
    s_and_b64 vcc, vcc, s[60:61]
    s_cbranch_scc0 mega_kernel_c_mbd102
    s_sub_u32 s25, s25, 1
    s_cbranch_scc0 mega_kernel_c_mbw101
    s_mov_b32 s25, 0
mega_kernel_c_mbd102:
    s_mov_b64 exec, 1
    v_mov_b32 v253, 163792
    v_mov_b32 v254, 1
    ds_add_u32 v253, v254
    s_mov_b64 exec, -1
    s_branch mega_kernel_c_dwg100
mega_kernel_c_dwo99:
    v_mov_b32 v253, 163792
mega_kernel_c_lw103:
    ds_read_b32 v254, v253
    s_waitcnt lgkmcnt(0)
    v_readfirstlane_b32 s62, v254
    s_nop 1
    s_cmp_ge_u32 s62, 5
    s_cbranch_scc1 mega_kernel_c_lwd104
    s_sleep 1
    s_sub_u32 s25, s25, 1
    s_cbranch_scc0 mega_kernel_c_lw103
    s_mov_b32 s25, 0
mega_kernel_c_lwd104:
mega_kernel_c_dwg100:
    s_waitcnt lgkmcnt(0)
    s_lshl_b32 s46, s56, 8
    s_add_u32 s46, s46, 71073792
    buffer_load_dwordx4 v[96:99], v1, s[8:11], s47 offen offset:0 sc1
    buffer_load_dwordx4 v[100:103], v1, s[8:11], s47 offen offset:1024 sc1
    s_add_u32 s47, s47, 4096
    buffer_load_dwordx4 v[104:107], v1, s[8:11], s47 offen offset:0 sc1
    buffer_load_dwordx4 v[108:111], v1, s[8:11], s47 offen offset:1024 sc1
    s_add_u32 s47, s47, 4096
    buffer_load_dwordx4 v[112:115], v1, s[8:11], s47 offen offset:0 sc1
    buffer_load_dwordx4 v[116:119], v1, s[8:11], s47 offen offset:1024 sc1
    s_add_u32 s47, s47, 4096
    buffer_load_dwordx4 v[120:123], v1, s[8:11], s47 offen offset:0 sc1
    buffer_load_dwordx4 v[124:127], v1, s[8:11], s47 offen offset:1024 sc1
    s_add_u32 s47, s47, 4096
    buffer_load_dwordx4 v[128:131], v1, s[8:11], s47 offen offset:0 sc1
    buffer_load_dwordx4 v[132:135], v1, s[8:11], s47 offen offset:1024 sc1
    s_barrier
    ds_read_b128 v[64:67], v5 offset:26624
    ds_read_b128 v[68:71], v8 offset:26624
    ds_read_b128 v[72:75], v5 offset:27648
    ds_read_b128 v[76:79], v8 offset:27648
    ds_read_b128 v[80:83], v3 offset:59392
    ds_read_b128 v[84:87], v6 offset:59392
    ds_read_b128 v[88:91], v3 offset:60416
    ds_read_b128 v[92:95], v6 offset:60416
    s_waitcnt vmcnt(9)
    s_waitcnt lgkmcnt(7)
    v_mfma_f32_32x32x16_bf16 v[16:31], v[64:67], v[96:99], v[16:31]
    s_waitcnt lgkmcnt(6)
    v_mfma_f32_32x32x16_bf16 v[32:47], v[68:71], v[96:99], 0
    s_add_u32 s47, s47, 4096
    buffer_load_dwordx4 v[136:139], v1, s[8:11], s47 offen offset:0 sc1
    ds_read_b128 v[64:67], v4 offset:6144
    ds_read_b128 v[68:71], v7 offset:6144
    s_waitcnt vmcnt(9)
    s_waitcnt lgkmcnt(7)
    v_mfma_f32_32x32x16_bf16 v[16:31], v[72:75], v[100:103], v[16:31]
    s_waitcnt lgkmcnt(6)
    v_mfma_f32_32x32x16_bf16 v[32:47], v[76:79], v[100:103], v[32:47]
    buffer_load_dwordx4 v[140:143], v1, s[8:11], s47 offen offset:1024 sc1
    ds_read_b128 v[72:75], v4 offset:7168
    ds_read_b128 v[76:79], v7 offset:7168
    s_waitcnt vmcnt(9)
    s_waitcnt lgkmcnt(7)
    v_mfma_f32_32x32x16_bf16 v[16:31], v[80:83], v[104:107], v[16:31]
    s_waitcnt lgkmcnt(6)
    v_mfma_f32_32x32x16_bf16 v[32:47], v[84:87], v[104:107], v[32:47]
    s_add_u32 s47, s47, 4096
    buffer_load_dwordx4 v[144:147], v1, s[8:11], s47 offen offset:0 sc1
    ds_read_b128 v[80:83], v4 offset:14336
    ds_read_b128 v[84:87], v7 offset:14336
    s_waitcnt vmcnt(9)
    s_waitcnt lgkmcnt(7)
    v_mfma_f32_32x32x16_bf16 v[16:31], v[88:91], v[108:111], v[16:31]
    s_waitcnt lgkmcnt(6)
    v_mfma_f32_32x32x16_bf16 v[32:47], v[92:95], v[108:111], v[32:47]
    buffer_load_dwordx4 v[148:151], v1, s[8:11], s47 offen offset:1024 sc1
    ds_read_b128 v[88:91], v4 offset:15360
    ds_read_b128 v[92:95], v7 offset:15360
    s_waitcnt vmcnt(9)
    s_waitcnt lgkmcnt(7)
    v_mfma_f32_32x32x16_bf16 v[16:31], v[64:67], v[112:115], v[16:31]
    s_waitcnt lgkmcnt(6)
    v_mfma_f32_32x32x16_bf16 v[32:47], v[68:71], v[112:115], v[32:47]
    s_add_u32 s47, s47, 4096
    buffer_load_dwordx4 v[152:155], v1, s[8:11], s47 offen offset:0 sc1
    ds_read_b128 v[64:67], v4 offset:22528
    ds_read_b128 v[68:71], v7 offset:22528
    s_waitcnt vmcnt(9)
    s_waitcnt lgkmcnt(7)
    v_mfma_f32_32x32x16_bf16 v[16:31], v[72:75], v[116:119], v[16:31]
    s_waitcnt lgkmcnt(6)
    v_mfma_f32_32x32x16_bf16 v[32:47], v[76:79], v[116:119], v[32:47]
    buffer_load_dwordx4 v[156:159], v1, s[8:11], s47 offen offset:1024 sc1
    ds_read_b128 v[72:75], v4 offset:23552
    ds_read_b128 v[76:79], v7 offset:23552
    s_waitcnt vmcnt(9)
    s_waitcnt lgkmcnt(7)
    v_mfma_f32_32x32x16_bf16 v[16:31], v[80:83], v[120:123], v[16:31]
    s_waitcnt lgkmcnt(6)
    v_mfma_f32_32x32x16_bf16 v[32:47], v[84:87], v[120:123], v[32:47]
    s_add_u32 s47, s47, 4096
    buffer_load_dwordx4 v[160:163], v1, s[8:11], s47 offen offset:0 sc1
    ds_read_b128 v[80:83], v4 offset:30720
    ds_read_b128 v[84:87], v7 offset:30720
    s_waitcnt vmcnt(9)
    s_waitcnt lgkmcnt(7)
    v_mfma_f32_32x32x16_bf16 v[16:31], v[88:91], v[124:127], v[16:31]
    s_waitcnt lgkmcnt(6)
    v_mfma_f32_32x32x16_bf16 v[32:47], v[92:95], v[124:127], v[32:47]
    buffer_load_dwordx4 v[164:167], v1, s[8:11], s47 offen offset:1024 sc1
    ds_read_b128 v[88:91], v4 offset:31744
    ds_read_b128 v[92:95], v7 offset:31744
    s_waitcnt vmcnt(9)
    s_waitcnt lgkmcnt(7)
    v_mfma_f32_32x32x16_bf16 v[16:31], v[64:67], v[128:131], v[16:31]
    s_waitcnt lgkmcnt(6)
    v_mfma_f32_32x32x16_bf16 v[32:47], v[68:71], v[128:131], v[32:47]
    s_add_u32 s47, s47, 4096
    buffer_load_dwordx4 v[168:171], v1, s[8:11], s47 offen offset:0 sc1
    s_cmp_lg_u32 s12, 0
    s_cbranch_scc1 mega_kernel_c_w0105
    buffer_load_dword v252, v2, s[8:11], s46 offen sc1
mega_kernel_c_w0105:
    ds_read_b128 v[64:67], v4 offset:38912
    ds_read_b128 v[68:71], v7 offset:38912
    s_waitcnt vmcnt(9)
    s_waitcnt lgkmcnt(7)
    v_mfma_f32_32x32x16_bf16 v[16:31], v[72:75], v[132:135], v[16:31]
    s_waitcnt lgkmcnt(6)
    v_mfma_f32_32x32x16_bf16 v[32:47], v[76:79], v[132:135], v[32:47]
    buffer_load_dwordx4 v[172:175], v1, s[8:11], s47 offen offset:1024 sc1
    ds_read_b128 v[72:75], v4 offset:39936
    ds_read_b128 v[76:79], v7 offset:39936
    s_waitcnt vmcnt(9)
    s_waitcnt lgkmcnt(7)
    v_mfma_f32_32x32x16_bf16 v[16:31], v[80:83], v[136:139], v[16:31]
    s_waitcnt lgkmcnt(6)
    v_mfma_f32_32x32x16_bf16 v[32:47], v[84:87], v[136:139], v[32:47]
    s_add_u32 s47, s47, 4096
    buffer_load_dwordx4 v[176:179], v1, s[8:11], s47 offen offset:0 sc1
    ds_read_b128 v[80:83], v4 offset:47104
    ds_read_b128 v[84:87], v7 offset:47104
    s_waitcnt vmcnt(9)
    s_waitcnt lgkmcnt(7)
    v_mfma_f32_32x32x16_bf16 v[16:31], v[88:91], v[140:143], v[16:31]
    s_waitcnt lgkmcnt(6)
    v_mfma_f32_32x32x16_bf16 v[32:47], v[92:95], v[140:143], v[32:47]
    buffer_load_dwordx4 v[180:183], v1, s[8:11], s47 offen offset:1024 sc1
    ds_read_b128 v[88:91], v4 offset:48128
    ds_read_b128 v[92:95], v7 offset:48128
    s_waitcnt vmcnt(9)
    s_waitcnt lgkmcnt(7)
    v_mfma_f32_32x32x16_bf16 v[16:31], v[64:67], v[144:147], v[16:31]
    s_waitcnt lgkmcnt(6)
    v_mfma_f32_32x32x16_bf16 v[32:47], v[68:71], v[144:147], v[32:47]
    s_add_u32 s47, s47, 4096
    buffer_load_dwordx4 v[184:187], v1, s[8:11], s47 offen offset:0 sc1
    ds_read_b128 v[64:67], v4 offset:55296
    ds_read_b128 v[68:71], v7 offset:55296
    s_waitcnt vmcnt(9)
    s_waitcnt lgkmcnt(7)
    v_mfma_f32_32x32x16_bf16 v[16:31], v[72:75], v[148:151], v[16:31]
    s_waitcnt lgkmcnt(6)
    v_mfma_f32_32x32x16_bf16 v[32:47], v[76:79], v[148:151], v[32:47]
    buffer_load_dwordx4 v[188:191], v1, s[8:11], s47 offen offset:1024 sc1
    ds_read_b128 v[72:75], v4 offset:56320
    ds_read_b128 v[76:79], v7 offset:56320
    s_waitcnt vmcnt(9)
    s_waitcnt lgkmcnt(7)
    v_mfma_f32_32x32x16_bf16 v[16:31], v[80:83], v[152:155], v[16:31]
    s_waitcnt lgkmcnt(6)
    v_mfma_f32_32x32x16_bf16 v[32:47], v[84:87], v[152:155], v[32:47]
    s_add_u32 s47, s47, 4096
    buffer_load_dwordx4 v[96:99], v1, s[8:11], s47 offen offset:0 sc1
    ds_read_b128 v[80:83], v5 offset:2048
    ds_read_b128 v[84:87], v8 offset:2048
    s_waitcnt vmcnt(9)
    s_waitcnt lgkmcnt(7)
    v_mfma_f32_32x32x16_bf16 v[16:31], v[88:91], v[156:159], v[16:31]
    s_waitcnt lgkmcnt(6)
    v_mfma_f32_32x32x16_bf16 v[32:47], v[92:95], v[156:159], v[32:47]
    buffer_load_dwordx4 v[100:103], v1, s[8:11], s47 offen offset:1024 sc1
    ds_read_b128 v[88:91], v5 offset:3072
    ds_read_b128 v[92:95], v8 offset:3072
    s_waitcnt vmcnt(9)
    s_waitcnt lgkmcnt(7)
    v_mfma_f32_32x32x16_bf16 v[16:31], v[64:67], v[160:163], v[16:31]
    s_waitcnt lgkmcnt(6)
    v_mfma_f32_32x32x16_bf16 v[32:47], v[68:71], v[160:163], v[32:47]
    s_add_u32 s47, s47, 4096
    buffer_load_dwordx4 v[104:107], v1, s[8:11], s47 offen offset:0 sc1
    ds_read_b128 v[64:67], v5 offset:10240
    ds_read_b128 v[68:71], v8 offset:10240
    s_waitcnt vmcnt(9)
    s_waitcnt lgkmcnt(7)
    v_mfma_f32_32x32x16_bf16 v[16:31], v[72:75], v[164:167], v[16:31]
    s_waitcnt lgkmcnt(6)
    v_mfma_f32_32x32x16_bf16 v[32:47], v[76:79], v[164:167], v[32:47]
    buffer_load_dwordx4 v[108:111], v1, s[8:11], s47 offen offset:1024 sc1
    ds_read_b128 v[72:75], v5 offset:11264
    ds_read_b128 v[76:79], v8 offset:11264
    s_waitcnt vmcnt(9)
    s_waitcnt lgkmcnt(7)
    v_mfma_f32_32x32x16_bf16 v[16:31], v[80:83], v[168:171], v[16:31]
    s_waitcnt lgkmcnt(6)
    v_mfma_f32_32x32x16_bf16 v[32:47], v[84:87], v[168:171], v[32:47]
    s_add_u32 s47, s47, 4096
    buffer_load_dwordx4 v[112:115], v1, s[8:11], s47 offen offset:0 sc1
    s_barrier
    ds_read_b128 v[80:83], v5 offset:18432
    ds_read_b128 v[84:87], v8 offset:18432
    s_waitcnt vmcnt(9)
    s_waitcnt lgkmcnt(7)
    v_mfma_f32_32x32x16_bf16 v[16:31], v[88:91], v[172:175], v[16:31]
    s_waitcnt lgkmcnt(6)
    v_mfma_f32_32x32x16_bf16 v[32:47], v[92:95], v[172:175], v[32:47]
    buffer_load_dwordx4 v[116:119], v1, s[8:11], s47 offen offset:1024 sc1
    ds_read_b128 v[88:91], v5 offset:19456
    ds_read_b128 v[92:95], v8 offset:19456
    s_waitcnt vmcnt(9)
    s_waitcnt lgkmcnt(7)
    v_mfma_f32_32x32x16_bf16 v[16:31], v[64:67], v[176:179], v[16:31]
    s_waitcnt lgkmcnt(6)
    v_mfma_f32_32x32x16_bf16 v[32:47], v[68:71], v[176:179], v[32:47]
    s_add_u32 s47, s47, 4096
    buffer_load_dwordx4 v[120:123], v1, s[8:11], s47 offen offset:0 sc1
    ds_read_b128 v[64:67], v3 offset:0
    ds_read_b128 v[68:71], v6 offset:0
    s_waitcnt vmcnt(9)
    s_waitcnt lgkmcnt(7)
    v_mfma_f32_32x32x16_bf16 v[16:31], v[72:75], v[180:183], v[16:31]
    s_waitcnt lgkmcnt(6)
    v_mfma_f32_32x32x16_bf16 v[32:47], v[76:79], v[180:183], v[32:47]
    buffer_load_dwordx4 v[124:127], v1, s[8:11], s47 offen offset:1024 sc1
    ds_read_b128 v[72:75], v3 offset:1024
    ds_read_b128 v[76:79], v6 offset:1024
    s_waitcnt vmcnt(9)
    s_waitcnt lgkmcnt(7)
    v_mfma_f32_32x32x16_bf16 v[16:31], v[80:83], v[184:187], v[16:31]
    s_waitcnt lgkmcnt(6)
    v_mfma_f32_32x32x16_bf16 v[32:47], v[84:87], v[184:187], v[32:47]
    s_cmp_lg_u32 s12, 0
    s_cbranch_scc1 mega_kernel_c_dwo106
    v_cmp_eq_u32 vcc, 0, v252
    s_nop 1
    s_and_b64 vcc, vcc, s[60:61]
    s_cbranch_scc0 mega_kernel_c_mbd109
mega_kernel_c_mbw108:
    buffer_load_dword v252, v2, s[8:11], s46 offen sc1
    s_waitcnt vmcnt(0)
    v_cmp_eq_u32 vcc, 0, v252
    s_nop 1
    s_and_b64 vcc, vcc, s[60:61]
    s_cbranch_scc0 mega_kernel_c_mbd109
    s_sub_u32 s25, s25, 1
    s_cbranch_scc0 mega_kernel_c_mbw108
    s_mov_b32 s25, 0
mega_kernel_c_mbd109:
    s_mov_b64 exec, 1
    v_mov_b32 v253, 163792
    v_mov_b32 v254, 1
    ds_add_u32 v253, v254
    s_mov_b64 exec, -1
    s_branch mega_kernel_c_dwg107
mega_kernel_c_dwo106:
    v_mov_b32 v253, 163792
mega_kernel_c_lw110:
    ds_read_b32 v254, v253
    s_waitcnt lgkmcnt(0)
    v_readfirstlane_b32 s62, v254
    s_nop 1
    s_cmp_ge_u32 s62, 6
    s_cbranch_scc1 mega_kernel_c_lwd111
    s_sleep 1
    s_sub_u32 s25, s25, 1
    s_cbranch_scc0 mega_kernel_c_lw110
    s_mov_b32 s25, 0
mega_kernel_c_lwd111:
mega_kernel_c_dwg107:
    s_waitcnt lgkmcnt(0)
    s_add_u32 s47, s47, 4096
    buffer_load_dwordx4 v[128:131], v1, s[8:11], s47 offen offset:0 sc1
    ds_read_b128 v[80:83], v3 offset:8192
    ds_read_b128 v[84:87], v6 offset:8192
    s_waitcnt vmcnt(9)
    v_mfma_f32_32x32x16_bf16 v[16:31], v[88:91], v[188:191], v[16:31]
    v_mfma_f32_32x32x16_bf16 v[32:47], v[92:95], v[188:191], v[32:47]
    buffer_load_dwordx4 v[132:135], v1, s[8:11], s47 offen offset:1024 sc1
    ds_read_b128 v[88:91], v3 offset:9216
    ds_read_b128 v[92:95], v6 offset:9216
    s_waitcnt vmcnt(9)
    v_mfma_f32_32x32x16_bf16 v[16:31], v[64:67], v[96:99], v[16:31]
    v_mfma_f32_32x32x16_bf16 v[32:47], v[68:71], v[96:99], v[32:47]
    s_add_u32 s47, s47, 4096
    buffer_load_dwordx4 v[136:139], v1, s[8:11], s47 offen offset:0 sc1
    ds_read_b128 v[64:67], v3 offset:16384
    ds_read_b128 v[68:71], v6 offset:16384
    s_waitcnt vmcnt(9)
    v_mfma_f32_32x32x16_bf16 v[16:31], v[72:75], v[100:103], v[16:31]
    v_mfma_f32_32x32x16_bf16 v[32:47], v[76:79], v[100:103], v[32:47]
    buffer_load_dwordx4 v[140:143], v1, s[8:11], s47 offen offset:1024 sc1
    ds_read_b128 v[72:75], v3 offset:17408
    ds_read_b128 v[76:79], v6 offset:17408
    s_waitcnt vmcnt(9)
    s_waitcnt lgkmcnt(7)
    v_mfma_f32_32x32x16_bf16 v[16:31], v[80:83], v[104:107], v[16:31]
    s_waitcnt lgkmcnt(6)
    v_mfma_f32_32x32x16_bf16 v[32:47], v[84:87], v[104:107], v[32:47]
    s_add_u32 s47, s47, 4096
    buffer_load_dwordx4 v[144:147], v1, s[8:11], s47 offen offset:0 sc1
    ds_read_b128 v[80:83], v3 offset:24576
    ds_read_b128 v[84:87], v6 offset:24576
    s_waitcnt vmcnt(9)
    s_waitcnt lgkmcnt(7)
    v_mfma_f32_32x32x16_bf16 v[16:31], v[88:91], v[108:111], v[16:31]
    s_waitcnt lgkmcnt(6)
    v_mfma_f32_32x32x16_bf16 v[32:47], v[92:95], v[108:111], v[32:47]
    buffer_load_dwordx4 v[148:151], v1, s[8:11], s47 offen offset:1024 sc1
    ds_read_b128 v[88:91], v3 offset:25600
    ds_read_b128 v[92:95], v6 offset:25600
    s_waitcnt vmcnt(9)
    s_waitcnt lgkmcnt(7)
    v_mfma_f32_32x32x16_bf16 v[16:31], v[64:67], v[112:115], v[16:31]
    s_waitcnt lgkmcnt(6)
    v_mfma_f32_32x32x16_bf16 v[32:47], v[68:71], v[112:115], v[32:47]
    s_add_u32 s47, s47, 4096
    buffer_load_dwordx4 v[152:155], v1, s[8:11], s47 offen offset:0 sc1
    ds_read_b128 v[64:67], v3 offset:32768
    ds_read_b128 v[68:71], v6 offset:32768
    s_waitcnt vmcnt(9)
    s_waitcnt lgkmcnt(7)
    v_mfma_f32_32x32x16_bf16 v[16:31], v[72:75], v[116:119], v[16:31]
    s_waitcnt lgkmcnt(6)
    v_mfma_f32_32x32x16_bf16 v[32:47], v[76:79], v[116:119], v[32:47]
    buffer_load_dwordx4 v[156:159], v1, s[8:11], s47 offen offset:1024 sc1
    ds_read_b128 v[72:75], v3 offset:33792
    ds_read_b128 v[76:79], v6 offset:33792
    s_waitcnt vmcnt(9)
    s_waitcnt lgkmcnt(7)
    v_mfma_f32_32x32x16_bf16 v[16:31], v[80:83], v[120:123], v[16:31]
    s_waitcnt lgkmcnt(6)
    v_mfma_f32_32x32x16_bf16 v[32:47], v[84:87], v[120:123], v[32:47]
    s_add_u32 s47, s47, 4096
    buffer_load_dwordx4 v[160:163], v1, s[8:11], s47 offen offset:0 sc1
    ds_read_b128 v[80:83], v3 offset:40960
    ds_read_b128 v[84:87], v6 offset:40960
    s_waitcnt vmcnt(9)
    s_waitcnt lgkmcnt(7)
    v_mfma_f32_32x32x16_bf16 v[16:31], v[88:91], v[124:127], v[16:31]
    s_waitcnt lgkmcnt(6)
    v_mfma_f32_32x32x16_bf16 v[32:47], v[92:95], v[124:127], v[32:47]
    buffer_load_dwordx4 v[164:167], v1, s[8:11], s47 offen offset:1024 sc1
    ds_read_b128 v[88:91], v3 offset:41984
    ds_read_b128 v[92:95], v6 offset:41984
    s_waitcnt vmcnt(9)
    s_waitcnt lgkmcnt(7)
    v_mfma_f32_32x32x16_bf16 v[16:31], v[64:67], v[128:131], v[16:31]
    s_waitcnt lgkmcnt(6)
    v_mfma_f32_32x32x16_bf16 v[32:47], v[68:71], v[128:131], v[32:47]
    s_add_u32 s47, s47, 4096
    buffer_load_dwordx4 v[168:171], v1, s[8:11], s47 offen offset:0 sc1
    ds_read_b128 v[64:67], v3 offset:49152
    ds_read_b128 v[68:71], v6 offset:49152
    s_waitcnt vmcnt(9)
    s_waitcnt lgkmcnt(7)
    v_mfma_f32_32x32x16_bf16 v[16:31], v[72:75], v[132:135], v[16:31]
    s_waitcnt lgkmcnt(6)
    v_mfma_f32_32x32x16_bf16 v[32:47], v[76:79], v[132:135], v[32:47]
    buffer_load_dwordx4 v[172:175], v1, s[8:11], s47 offen offset:1024 sc1
    ds_read_b128 v[72:75], v3 offset:50176
    ds_read_b128 v[76:79], v6 offset:50176
    s_waitcnt vmcnt(9)
    s_waitcnt lgkmcnt(7)
    v_mfma_f32_32x32x16_bf16 v[16:31], v[80:83], v[136:139], v[16:31]
    s_waitcnt lgkmcnt(6)
    v_mfma_f32_32x32x16_bf16 v[32:47], v[84:87], v[136:139], v[32:47]
    s_add_u32 s47, s47, 4096
    buffer_load_dwordx4 v[176:179], v1, s[8:11], s47 offen offset:0 sc1
    s_barrier
    ds_read_b128 v[80:83], v5 offset:26624
    ds_read_b128 v[84:87], v8 offset:26624
    s_waitcnt vmcnt(9)
    s_waitcnt lgkmcnt(7)
    v_mfma_f32_32x32x16_bf16 v[16:31], v[88:91], v[140:143], v[16:31]
    s_waitcnt lgkmcnt(6)
    v_mfma_f32_32x32x16_bf16 v[32:47], v[92:95], v[140:143], v[32:47]
    buffer_load_dwordx4 v[180:183], v1, s[8:11], s47 offen offset:1024 sc1
    ds_read_b128 v[88:91], v5 offset:27648
    ds_read_b128 v[92:95], v8 offset:27648
    s_waitcnt vmcnt(9)
    s_waitcnt lgkmcnt(7)
    v_mfma_f32_32x32x16_bf16 v[16:31], v[64:67], v[144:147], v[16:31]
    s_waitcnt lgkmcnt(6)
    v_mfma_f32_32x32x16_bf16 v[32:47], v[68:71], v[144:147], v[32:47]
    s_add_u32 s47, s47, 4096
    buffer_load_dwordx4 v[184:187], v1, s[8:11], s47 offen offset:0 sc1
    ds_read_b128 v[64:67], v3 offset:59392
    ds_read_b128 v[68:71], v6 offset:59392
    s_waitcnt vmcnt(9)
    s_waitcnt lgkmcnt(7)
    v_mfma_f32_32x32x16_bf16 v[16:31], v[72:75], v[148:151], v[16:31]
    s_waitcnt lgkmcnt(6)
    v_mfma_f32_32x32x16_bf16 v[32:47], v[76:79], v[148:151], v[32:47]
    buffer_load_dwordx4 v[188:191], v1, s[8:11], s47 offen offset:1024 sc1
    ds_read_b128 v[72:75], v3 offset:60416
    ds_read_b128 v[76:79], v6 offset:60416
    s_waitcnt vmcnt(9)
    s_waitcnt lgkmcnt(7)
    v_mfma_f32_32x32x16_bf16 v[16:31], v[80:83], v[152:155], v[16:31]
    s_waitcnt lgkmcnt(6)
    v_mfma_f32_32x32x16_bf16 v[32:47], v[84:87], v[152:155], v[32:47]
    s_add_u32 s47, s47, 4096
    buffer_load_dwordx4 v[96:99], v1, s[8:11], s47 offen offset:0 sc1
    ds_read_b128 v[80:83], v4 offset:6144
    ds_read_b128 v[84:87], v7 offset:6144
    s_waitcnt vmcnt(9)
    s_waitcnt lgkmcnt(7)
    v_mfma_f32_32x32x16_bf16 v[16:31], v[88:91], v[156:159], v[16:31]
    s_waitcnt lgkmcnt(6)
    v_mfma_f32_32x32x16_bf16 v[32:47], v[92:95], v[156:159], v[32:47]
    buffer_load_dwordx4 v[100:103], v1, s[8:11], s47 offen offset:1024 sc1
    ds_read_b128 v[88:91], v4 offset:7168
    ds_read_b128 v[92:95], v7 offset:7168
    s_waitcnt vmcnt(9)
    s_waitcnt lgkmcnt(7)
    v_mfma_f32_32x32x16_bf16 v[16:31], v[64:67], v[160:163], v[16:31]
    s_waitcnt lgkmcnt(6)
    v_mfma_f32_32x32x16_bf16 v[32:47], v[68:71], v[160:163], v[32:47]
    s_add_u32 s47, s47, 4096
    buffer_load_dwordx4 v[104:107], v1, s[8:11], s47 offen offset:0 sc1
    ds_read_b128 v[64:67], v4 offset:14336
    ds_read_b128 v[68:71], v7 offset:14336
    s_waitcnt vmcnt(9)
    s_waitcnt lgkmcnt(7)
    v_mfma_f32_32x32x16_bf16 v[16:31], v[72:75], v[164:167], v[16:31]
    s_waitcnt lgkmcnt(6)
    v_mfma_f32_32x32x16_bf16 v[32:47], v[76:79], v[164:167], v[32:47]
    buffer_load_dwordx4 v[108:111], v1, s[8:11], s47 offen offset:1024 sc1
    ds_read_b128 v[72:75], v4 offset:15360
    ds_read_b128 v[76:79], v7 offset:15360
    s_waitcnt vmcnt(9)
    s_waitcnt lgkmcnt(7)
    v_mfma_f32_32x32x16_bf16 v[16:31], v[80:83], v[168:171], v[16:31]
    s_waitcnt lgkmcnt(6)
    v_mfma_f32_32x32x16_bf16 v[32:47], v[84:87], v[168:171], v[32:47]
    s_add_u32 s47, s47, 4096
    buffer_load_dwordx4 v[112:115], v1, s[8:11], s47 offen offset:0 sc1
    ds_read_b128 v[80:83], v4 offset:22528
    ds_read_b128 v[84:87], v7 offset:22528
    s_waitcnt vmcnt(9)
    s_waitcnt lgkmcnt(7)
    v_mfma_f32_32x32x16_bf16 v[16:31], v[88:91], v[172:175], v[16:31]
    s_waitcnt lgkmcnt(6)
    v_mfma_f32_32x32x16_bf16 v[32:47], v[92:95], v[172:175], v[32:47]
    buffer_load_dwordx4 v[116:119], v1, s[8:11], s47 offen offset:1024 sc1
    ds_read_b128 v[88:91], v4 offset:23552
    ds_read_b128 v[92:95], v7 offset:23552
    s_waitcnt vmcnt(9)
    s_waitcnt lgkmcnt(7)
    v_mfma_f32_32x32x16_bf16 v[16:31], v[64:67], v[176:179], v[16:31]
    s_waitcnt lgkmcnt(6)
    v_mfma_f32_32x32x16_bf16 v[32:47], v[68:71], v[176:179], v[32:47]
    s_add_u32 s47, s47, 4096
    buffer_load_dwordx4 v[120:123], v1, s[8:11], s47 offen offset:0 sc1
    ds_read_b128 v[64:67], v4 offset:30720
    ds_read_b128 v[68:71], v7 offset:30720
    s_waitcnt vmcnt(9)
    s_waitcnt lgkmcnt(7)
    v_mfma_f32_32x32x16_bf16 v[16:31], v[72:75], v[180:183], v[16:31]
    s_waitcnt lgkmcnt(6)
    v_mfma_f32_32x32x16_bf16 v[32:47], v[76:79], v[180:183], v[32:47]
    buffer_load_dwordx4 v[124:127], v1, s[8:11], s47 offen offset:1024 sc1
    ds_read_b128 v[72:75], v4 offset:31744
    ds_read_b128 v[76:79], v7 offset:31744
    s_waitcnt vmcnt(9)
    s_waitcnt lgkmcnt(7)
    v_mfma_f32_32x32x16_bf16 v[16:31], v[80:83], v[184:187], v[16:31]
    s_waitcnt lgkmcnt(6)
    v_mfma_f32_32x32x16_bf16 v[32:47], v[84:87], v[184:187], v[32:47]
    ds_read_b128 v[80:83], v4 offset:38912
    ds_read_b128 v[84:87], v7 offset:38912
    s_waitcnt vmcnt(8)
    s_waitcnt lgkmcnt(7)
    v_mfma_f32_32x32x16_bf16 v[16:31], v[88:91], v[188:191], v[16:31]
    s_waitcnt lgkmcnt(6)
    v_mfma_f32_32x32x16_bf16 v[32:47], v[92:95], v[188:191], v[32:47]
    ds_read_b128 v[88:91], v4 offset:39936
    ds_read_b128 v[92:95], v7 offset:39936
    s_waitcnt vmcnt(7)
    s_waitcnt lgkmcnt(7)
    v_mfma_f32_32x32x16_bf16 v[16:31], v[64:67], v[96:99], v[16:31]
    s_waitcnt lgkmcnt(6)
    v_mfma_f32_32x32x16_bf16 v[32:47], v[68:71], v[96:99], v[32:47]
    ds_read_b128 v[64:67], v4 offset:47104
    ds_read_b128 v[68:71], v7 offset:47104
    s_waitcnt vmcnt(6)
    s_waitcnt lgkmcnt(7)
    v_mfma_f32_32x32x16_bf16 v[16:31], v[72:75], v[100:103], v[16:31]
    s_waitcnt lgkmcnt(6)
    v_mfma_f32_32x32x16_bf16 v[32:47], v[76:79], v[100:103], v[32:47]
    ds_read_b128 v[72:75], v4 offset:48128
    ds_read_b128 v[76:79], v7 offset:48128
    s_waitcnt vmcnt(5)
    s_waitcnt lgkmcnt(7)
    v_mfma_f32_32x32x16_bf16 v[16:31], v[80:83], v[104:107], v[16:31]
    s_waitcnt lgkmcnt(6)
    v_mfma_f32_32x32x16_bf16 v[32:47], v[84:87], v[104:107], v[32:47]
    ds_read_b128 v[80:83], v4 offset:55296
    ds_read_b128 v[84:87], v7 offset:55296
    s_waitcnt vmcnt(4)
    s_waitcnt lgkmcnt(7)
    v_mfma_f32_32x32x16_bf16 v[16:31], v[88:91], v[108:111], v[16:31]
    s_waitcnt lgkmcnt(6)
    v_mfma_f32_32x32x16_bf16 v[32:47], v[92:95], v[108:111], v[32:47]
    ds_read_b128 v[88:91], v4 offset:56320
    ds_read_b128 v[92:95], v7 offset:56320
    s_waitcnt vmcnt(3)
    s_waitcnt lgkmcnt(7)
    v_mfma_f32_32x32x16_bf16 v[16:31], v[64:67], v[112:115], v[16:31]
    s_waitcnt lgkmcnt(6)
    v_mfma_f32_32x32x16_bf16 v[32:47], v[68:71], v[112:115], v[32:47]
    s_waitcnt vmcnt(2)
    s_waitcnt lgkmcnt(5)
    v_mfma_f32_32x32x16_bf16 v[16:31], v[72:75], v[116:119], v[16:31]
    s_waitcnt lgkmcnt(4)
    v_mfma_f32_32x32x16_bf16 v[32:47], v[76:79], v[116:119], v[32:47]
    s_waitcnt vmcnt(1)
    s_waitcnt lgkmcnt(3)
    v_mfma_f32_32x32x16_bf16 v[16:31], v[80:83], v[120:123], v[16:31]
    s_waitcnt lgkmcnt(2)
    v_mfma_f32_32x32x16_bf16 v[32:47], v[84:87], v[120:123], v[32:47]
    s_waitcnt vmcnt(0)
    s_waitcnt lgkmcnt(1)
    v_mfma_f32_32x32x16_bf16 v[16:31], v[88:91], v[124:127], v[16:31]
    s_waitcnt lgkmcnt(0)
    v_mfma_f32_32x32x16_bf16 v[32:47], v[92:95], v[124:127], v[32:47]
    s_nop 11
    ds_write_b128 v9, v[32:35] offset:0
    ds_write_b128 v9, v[36:39] offset:1024
    ds_write_b128 v9, v[40:43] offset:2048
    ds_write_b128 v9, v[44:47] offset:3072
    s_waitcnt lgkmcnt(0)
    s_barrier
    ds_read_b128 v[64:67], v10 offset:0
    ds_read_b128 v[68:71], v10 offset:1024
    ds_read_b128 v[72:75], v10 offset:2048
    ds_read_b128 v[76:79], v10 offset:3072
    s_waitcnt lgkmcnt(3)
    v_add_f32 v16, v16, v64
    v_add_f32 v17, v17, v65
    v_add_f32 v18, v18, v66
    v_add_f32 v19, v19, v67
    v_cvt_pk_bf16_f32 v96, v16, v17
    v_cvt_pk_bf16_f32 v97, v18, v19
    s_waitcnt lgkmcnt(2)
    v_add_f32 v20, v20, v68
    v_add_f32 v21, v21, v69
    v_add_f32 v22, v22, v70
    v_add_f32 v23, v23, v71
    v_cvt_pk_bf16_f32 v98, v20, v21
    v_cvt_pk_bf16_f32 v99, v22, v23
    s_waitcnt lgkmcnt(1)
    v_add_f32 v24, v24, v72
    v_add_f32 v25, v25, v73
    v_add_f32 v26, v26, v74
    v_add_f32 v27, v27, v75
    v_cvt_pk_bf16_f32 v100, v24, v25
    v_cvt_pk_bf16_f32 v101, v26, v27
    s_waitcnt lgkmcnt(0)
    v_add_f32 v28, v28, v76
    v_add_f32 v29, v29, v77
    v_add_f32 v30, v30, v78
    v_add_f32 v31, v31, v79
    v_cvt_pk_bf16_f32 v102, v28, v29
    v_cvt_pk_bf16_f32 v103, v30, v31
    s_mov_b32 s48, s6
    s_mov_b32 s49, s7
    s_mov_b32 s50, 1835008
    s_mov_b32 s51, 0x00020000
    v_and_b32 v56, 31, v0
    v_mul_u32_u24 v56, 896, v56
    v_lshrrev_b32 v57, 5, v0
    v_lshl_add_u32 v56, v57, 4, v56
    s_mul_i32 s45, s40, 28672
    s_lshl_b32 s46, s41, 6
    s_add_u32 s45, s45, s46
    v_permlane32_swap_b32 v96, v98
    v_permlane32_swap_b32 v97, v99
    buffer_store_dwordx4 v[96:99], v56, s[48:51], s45 offen offset:0
    v_permlane32_swap_b32 v100, v102
    v_permlane32_swap_b32 v101, v103
    buffer_store_dwordx4 v[100:103], v56, s[48:51], s45 offen offset:32
    s_waitcnt vmcnt(0)
mega_kernel_c_skip98:
    s_nop 7
    s_nop 7
mega_kernel_end1:
    s_endpgm
mega_kernel_loader2:
    s_mul_i32 s40, s19, 89088
    s_add_u32 s40, s40, 0
    s_add_u32 s41, s40, s15
    s_add_u32 s40, s40, s14
    s_add_u32 m0, s14, 29696
    s_add_u32 s63, s40, s26
    s_add_u32 s63, s63, 29696
    buffer_load_dwordx4 v1, s[8:11], s63 offen sc1 lds
    s_add_u32 m0, s14, 59392
    s_add_u32 s63, s40, s26
    s_add_u32 s63, s63, 59392
    buffer_load_dwordx4 v1, s[8:11], s63 offen sc1 lds
    s_add_u32 m0, s14, 33792
    s_add_u32 s63, s40, s27
    s_add_u32 s63, s63, 29696
    buffer_load_dwordx4 v1, s[8:11], s63 offen sc1 lds
    s_add_u32 m0, s14, 63488
    s_add_u32 s63, s40, s27
    s_add_u32 s63, s63, 59392
    buffer_load_dwordx4 v1, s[8:11], s63 offen sc1 lds
    s_add_u32 m0, s14, 37888
    s_add_u32 s63, s40, s28
    s_add_u32 s63, s63, 29696
    buffer_load_dwordx4 v1, s[8:11], s63 offen sc1 lds
    s_add_u32 m0, s14, 67584
    s_add_u32 s63, s40, s28
    s_add_u32 s63, s63, 59392
    buffer_load_dwordx4 v1, s[8:11], s63 offen sc1 lds
    s_waitcnt vmcnt(4)
    s_barrier
    s_add_u32 m0, s14, 41984
    s_add_u32 s63, s40, s29
    s_add_u32 s63, s63, 29696
    buffer_load_dwordx4 v1, s[8:11], s63 offen sc1 lds
    s_add_u32 m0, s14, 71680
    s_add_u32 s63, s40, s29
    s_add_u32 s63, s63, 59392
    buffer_load_dwordx4 v1, s[8:11], s63 offen sc1 lds
    s_waitcnt vmcnt(4)
    s_barrier
    s_add_u32 m0, s14, 46080
    s_add_u32 s63, s40, s30
    s_add_u32 s63, s63, 29696
    buffer_load_dwordx4 v1, s[8:11], s63 offen sc1 lds
    s_add_u32 m0, s14, 75776
    s_add_u32 s63, s40, s30
    s_add_u32 s63, s63, 59392
    buffer_load_dwordx4 v1, s[8:11], s63 offen sc1 lds
    s_waitcnt vmcnt(4)
    s_barrier
    s_add_u32 m0, s14, 50176
    s_add_u32 s63, s40, s31
    s_add_u32 s63, s63, 29696
    buffer_load_dwordx4 v1, s[8:11], s63 offen sc1 lds
    s_add_u32 m0, s14, 79872
    s_add_u32 s63, s40, s31
    s_add_u32 s63, s63, 59392
    buffer_load_dwordx4 v1, s[8:11], s63 offen sc1 lds
    s_waitcnt vmcnt(4)
    s_barrier
    s_add_u32 m0, s14, 54272
    s_add_u32 s63, s40, s32
    s_add_u32 s63, s63, 29696
    buffer_load_dwordx4 v1, s[8:11], s63 offen sc1 lds
    s_add_u32 m0, s14, 83968
    s_add_u32 s63, s40, s32
    s_add_u32 s63, s63, 59392
    buffer_load_dwordx4 v1, s[8:11], s63 offen sc1 lds
    s_waitcnt vmcnt(4)
    s_barrier
    s_add_u32 m0, s15, 58368
    s_add_u32 s63, s41, 58368
    buffer_load_dword v2, s[8:11], s63 offen sc1 lds
    s_add_u32 m0, s15, 88064
    s_add_u32 s63, s41, 88064
    buffer_load_dword v2, s[8:11], s63 offen sc1 lds
    s_waitcnt vmcnt(4)
    s_barrier
    s_add_u32 m0, s14, 0
    s_add_u32 s63, s40, s26
    buffer_load_dwordx4 v1, s[8:11], s63 offen sc1 lds
    s_add_u32 m0, s14, 4096
    s_add_u32 s63, s40, s27
    buffer_load_dwordx4 v1, s[8:11], s63 offen sc1 lds
    s_add_u32 m0, s14, 8192
    s_add_u32 s63, s40, s28
    buffer_load_dwordx4 v1, s[8:11], s63 offen sc1 lds
    s_add_u32 m0, s14, 12288
    s_add_u32 s63, s40, s29
    buffer_load_dwordx4 v1, s[8:11], s63 offen sc1 lds
    s_add_u32 m0, s14, 16384
    s_add_u32 s63, s40, s30
    buffer_load_dwordx4 v1, s[8:11], s63 offen sc1 lds
    s_add_u32 m0, s14, 20480
    s_add_u32 s63, s40, s31
    buffer_load_dwordx4 v1, s[8:11], s63 offen sc1 lds
    s_add_u32 m0, s14, 24576
    s_add_u32 s63, s40, s32
    buffer_load_dwordx4 v1, s[8:11], s63 offen sc1 lds
    s_add_u32 m0, s15, 28672
    s_add_u32 s63, s41, 28672
    buffer_load_dword v2, s[8:11], s63 offen sc1 lds
    s_waitcnt vmcnt(10)
    s_barrier
    s_waitcnt vmcnt(8)
    s_barrier
    s_waitcnt vmcnt(0)
    s_barrier
    v_add_u32 v3, s14, v1
    v_add_u32 v4, 59392, v3
    v_add_u32 v5, s15, v2
    v_add_u32 v6, 59392, v5
    ds_read_b128 v[144:147], v3 offset:29696
    ds_read_b128 v[148:151], v3 offset:33792
    ds_read_b128 v[152:155], v3 offset:37888
    ds_read_b128 v[156:159], v3 offset:41984
    ds_read_b128 v[160:163], v3 offset:46080
    ds_read_b128 v[164:167], v3 offset:50176
    ds_read_b128 v[168:171], v3 offset:54272
    ds_read_b32 v172, v5 offset:58368
    s_waitcnt lgkmcnt(0)
    ds_read_b128 v[176:179], v4 offset:0
    ds_read_b128 v[180:183], v4 offset:4096
    ds_read_b128 v[184:187], v4 offset:8192
    ds_read_b128 v[188:191], v4 offset:12288
    ds_read_b128 v[192:195], v4 offset:16384
    ds_read_b128 v[196:199], v4 offset:20480
    ds_read_b128 v[200:203], v4 offset:24576
    ds_read_b32 v204, v6 offset:28672
    s_waitcnt lgkmcnt(0)
    ds_read_b128 v[208:211], v3 offset:0
    ds_read_b128 v[212:215], v3 offset:4096
    ds_read_b128 v[216:219], v3 offset:8192
    ds_read_b128 v[220:223], v3 offset:12288
    ds_read_b128 v[224:227], v3 offset:16384
    ds_read_b128 v[228:231], v3 offset:20480
    ds_read_b128 v[232:235], v3 offset:24576
    ds_read_b32 v236, v5 offset:28672
    s_waitcnt lgkmcnt(0)
    s_lshl_b32 s40, s19, 6
    s_lshl_b32 s41, s18, 2
    s_add_u32 s40, s40, s41
    s_lshl_b32 s40, s40, 12
    s_add_u32 s40, s40, 37715968
    s_add_u32 s40, s40, s14
    s_cmp_lt_u32 s18, 1
    s_cselect_b32 s41, 268435456, s40
    s_cmp_lt_u32 s18, 2
    s_cselect_b32 s42, 268435456, s40
    s_cmp_lg_u32 s13, 0
    s_cbranch_scc1 mega_kernel_l_lo1
    v_mov_b32 v253, 163780
mega_kernel_l_lw3:
    ds_read_b32 v254, v253
    s_waitcnt lgkmcnt(0)
    v_readfirstlane_b32 s62, v254
    s_nop 1
    s_cmp_ge_u32 s62, 4
    s_cbranch_scc1 mega_kernel_l_lwd4
    s_sleep 1
    s_sub_u32 s25, s25, 1
    s_cbranch_scc0 mega_kernel_l_lw3
    s_mov_b32 s25, 0
mega_kernel_l_lwd4:
    s_lshl_b32 s43, s18, 4
    s_add_u32 s43, s43, s19
    s_lshl_b32 s43, s43, 8
    s_add_u32 s43, s43, 70254592
    s_min_u32 s44, s18, 2
    v_cmp_gt_u32 s[46:47], s44, v0
    s_nop 1
mega_kernel_l_mbw5:
    buffer_load_dword v252, v2, s[8:11], s43 offen sc1
    s_waitcnt vmcnt(0)
    v_cmp_eq_u32 vcc, 0, v252
    s_nop 1
    s_and_b64 vcc, vcc, s[46:47]
    s_cbranch_scc0 mega_kernel_l_mbd6
    s_sub_u32 s25, s25, 1
    s_cbranch_scc0 mega_kernel_l_mbw5
    s_mov_b32 s25, 0
mega_kernel_l_mbd6:
    s_mov_b64 exec, 1
    v_mov_b32 v253, 163784
    v_mov_b32 v254, 1
    ds_add_u32 v253, v254
    s_mov_b64 exec, -1
    s_branch mega_kernel_l_lgo2
mega_kernel_l_lo1:
    v_mov_b32 v253, 163784
mega_kernel_l_lw7:
    ds_read_b32 v254, v253
    s_waitcnt lgkmcnt(0)
    v_readfirstlane_b32 s62, v254
    s_nop 1
    s_cmp_ge_u32 s62, 1
    s_cbranch_scc1 mega_kernel_l_lwd8
    s_sleep 1
    s_sub_u32 s25, s25, 1
    s_cbranch_scc0 mega_kernel_l_lw7
    s_mov_b32 s25, 0
mega_kernel_l_lwd8:
mega_kernel_l_lgo2:
    s_add_u32 m0, s14, 105472
    s_add_u32 s63, s41, 16384
    buffer_load_dwordx4 v1, s[8:11], s63 offen sc1 lds
    s_add_u32 m0, s14, 109568
    s_add_u32 s63, s41, 20480
    buffer_load_dwordx4 v1, s[8:11], s63 offen sc1 lds
    s_add_u32 m0, s14, 113664
    s_add_u32 s63, s41, 24576
    buffer_load_dwordx4 v1, s[8:11], s63 offen sc1 lds
    s_add_u32 m0, s14, 117760
    s_add_u32 s63, s41, 28672
    buffer_load_dwordx4 v1, s[8:11], s63 offen sc1 lds
    s_add_u32 m0, s14, 89088
    s_add_u32 s63, s42, 0
    buffer_load_dwordx4 v1, s[8:11], s63 offen sc1 lds
    s_add_u32 m0, s14, 93184
    s_add_u32 s63, s42, 4096
    buffer_load_dwordx4 v1, s[8:11], s63 offen sc1 lds
    s_add_u32 m0, s14, 97280
    s_add_u32 s63, s42, 8192
    buffer_load_dwordx4 v1, s[8:11], s63 offen sc1 lds
    s_add_u32 m0, s14, 101376
    s_add_u32 s63, s42, 12288
    buffer_load_dwordx4 v1, s[8:11], s63 offen sc1 lds
    s_waitcnt vmcnt(0)
    s_barrier
    s_lshl_b32 s40, s23, 16
    s_add_u32 s40, s40, 6291456
    s_add_u32 s40, s40, s14
    s_add_u32 m0, s14, 0
    s_add_u32 s63, s40, 0
    buffer_load_dwordx4 v1, s[8:11], s63 offen sc1 lds
    s_add_u32 m0, s14, 4096
    s_add_u32 s63, s40, 4096
    buffer_load_dwordx4 v1, s[8:11], s63 offen sc1 lds
    s_add_u32 m0, s14, 8192
    s_add_u32 s63, s40, 8192
    buffer_load_dwordx4 v1, s[8:11], s63 offen sc1 lds
    s_add_u32 m0, s14, 12288
    s_add_u32 s63, s40, 12288
    buffer_load_dwordx4 v1, s[8:11], s63 offen sc1 lds
    s_add_u32 m0, s14, 16384
    s_add_u32 s63, s40, 16384
    buffer_load_dwordx4 v1, s[8:11], s63 offen sc1 lds
    s_add_u32 m0, s14, 20480
    s_add_u32 s63, s40, 20480
    buffer_load_dwordx4 v1, s[8:11], s63 offen sc1 lds
    s_add_u32 m0, s14, 24576
    s_add_u32 s63, s40, 24576
    buffer_load_dwordx4 v1, s[8:11], s63 offen sc1 lds
    s_add_u32 m0, s14, 28672
    s_add_u32 s63, s40, 28672
    buffer_load_dwordx4 v1, s[8:11], s63 offen sc1 lds
    s_add_u32 m0, s14, 32768
    s_add_u32 s63, s40, 32768
    buffer_load_dwordx4 v1, s[8:11], s63 offen sc1 lds
    s_add_u32 m0, s14, 36864
    s_add_u32 s63, s40, 36864
    buffer_load_dwordx4 v1, s[8:11], s63 offen sc1 lds
    s_add_u32 m0, s14, 40960
    s_add_u32 s63, s40, 40960
    buffer_load_dwordx4 v1, s[8:11], s63 offen sc1 lds
    s_add_u32 m0, s14, 45056
    s_add_u32 s63, s40, 45056
    buffer_load_dwordx4 v1, s[8:11], s63 offen sc1 lds
    s_add_u32 m0, s14, 49152
    s_add_u32 s63, s40, 49152
    buffer_load_dwordx4 v1, s[8:11], s63 offen sc1 lds
    s_add_u32 m0, s14, 53248
    s_add_u32 s63, s40, 53248
    buffer_load_dwordx4 v1, s[8:11], s63 offen sc1 lds
    s_add_u32 m0, s14, 57344
    s_add_u32 s63, s40, 57344
    buffer_load_dwordx4 v1, s[8:11], s63 offen sc1 lds
    s_add_u32 m0, s14, 61440
    s_add_u32 s63, s40, 61440
    buffer_load_dwordx4 v1, s[8:11], s63 offen sc1 lds
    s_mul_i32 s40, s21, 207872
    s_add_u32 s40, s40, 2097152
    s_add_u32 s41, s40, s15
    s_add_u32 s40, s40, s14
    s_waitcnt vmcnt(7)
    s_add_u32 s63, s40, s33
    buffer_load_dwordx4 v[16:19], v1, s[8:11], s63 offen sc1
    s_waitcnt vmcnt(7)
    s_add_u32 s63, s40, s34
    buffer_load_dwordx4 v[20:23], v1, s[8:11], s63 offen sc1
    s_waitcnt vmcnt(7)
    s_add_u32 s63, s40, s35
    buffer_load_dwordx4 v[24:27], v1, s[8:11], s63 offen sc1
    s_waitcnt vmcnt(7)
    s_add_u32 s63, s40, s36
    buffer_load_dwordx4 v[28:31], v1, s[8:11], s63 offen sc1
    s_waitcnt vmcnt(7)
    s_add_u32 s63, s40, s37
    buffer_load_dwordx4 v[32:35], v1, s[8:11], s63 offen sc1
    s_waitcnt vmcnt(7)
    s_add_u32 s63, s40, s38
    buffer_load_dwordx4 v[36:39], v1, s[8:11], s63 offen sc1
    s_waitcnt vmcnt(7)
    s_add_u32 s63, s40, s39
    buffer_load_dwordx4 v[40:43], v1, s[8:11], s63 offen sc1
    s_waitcnt vmcnt(7)
    s_add_u32 s63, s41, 28672
    buffer_load_dword v44, v2, s[8:11], s63 offen sc1
    s_waitcnt vmcnt(7)
    s_add_u32 s63, s40, s33
    s_add_u32 s63, s63, 29696
    buffer_load_dwordx4 v[48:51], v1, s[8:11], s63 offen sc1
    s_waitcnt vmcnt(7)
    s_add_u32 s63, s40, s34
    s_add_u32 s63, s63, 29696
    buffer_load_dwordx4 v[52:55], v1, s[8:11], s63 offen sc1
    s_waitcnt vmcnt(7)
    s_add_u32 s63, s40, s35
    s_add_u32 s63, s63, 29696
    buffer_load_dwordx4 v[56:59], v1, s[8:11], s63 offen sc1
    s_waitcnt vmcnt(7)
    s_add_u32 s63, s40, s36
    s_add_u32 s63, s63, 29696
    buffer_load_dwordx4 v[60:63], v1, s[8:11], s63 offen sc1
    s_waitcnt vmcnt(7)
    s_add_u32 s63, s40, s37
    s_add_u32 s63, s63, 29696
    buffer_load_dwordx4 v[64:67], v1, s[8:11], s63 offen sc1
    s_waitcnt vmcnt(7)
    s_add_u32 s63, s40, s38
    s_add_u32 s63, s63, 29696
    buffer_load_dwordx4 v[68:71], v1, s[8:11], s63 offen sc1
    s_waitcnt vmcnt(7)
    s_add_u32 s63, s40, s39
    s_add_u32 s63, s63, 29696
    buffer_load_dwordx4 v[72:75], v1, s[8:11], s63 offen sc1
    s_waitcnt vmcnt(7)
    s_add_u32 s63, s41, 58368
    buffer_load_dword v76, v2, s[8:11], s63 offen sc1
    s_waitcnt vmcnt(7)
    s_add_u32 s63, s40, s33
    s_add_u32 s63, s63, 59392
    buffer_load_dwordx4 v[80:83], v1, s[8:11], s63 offen sc1
    s_waitcnt vmcnt(7)
    s_add_u32 s63, s40, s34
    s_add_u32 s63, s63, 59392
    buffer_load_dwordx4 v[84:87], v1, s[8:11], s63 offen sc1
    s_waitcnt vmcnt(7)
    s_add_u32 s63, s40, s35
    s_add_u32 s63, s63, 59392
    buffer_load_dwordx4 v[88:91], v1, s[8:11], s63 offen sc1
    s_waitcnt vmcnt(7)
    s_add_u32 s63, s40, s36
    s_add_u32 s63, s63, 59392
    buffer_load_dwordx4 v[92:95], v1, s[8:11], s63 offen sc1
    s_waitcnt vmcnt(7)
    s_add_u32 s63, s40, s37
    s_add_u32 s63, s63, 59392
    buffer_load_dwordx4 v[96:99], v1, s[8:11], s63 offen sc1
    s_waitcnt vmcnt(7)
    s_add_u32 s63, s40, s38
    s_add_u32 s63, s63, 59392
    buffer_load_dwordx4 v[100:103], v1, s[8:11], s63 offen sc1
    s_waitcnt vmcnt(7)
    s_add_u32 s63, s40, s39
    s_add_u32 s63, s63, 59392
    buffer_load_dwordx4 v[104:107], v1, s[8:11], s63 offen sc1
    s_waitcnt vmcnt(7)
    s_add_u32 s63, s41, 88064
    buffer_load_dword v108, v2, s[8:11], s63 offen sc1
    s_waitcnt vmcnt(7)
    s_add_u32 s63, s40, s33
    s_add_u32 s63, s63, 89088
    buffer_load_dwordx4 v[112:115], v1, s[8:11], s63 offen sc1
    s_waitcnt vmcnt(7)
    s_add_u32 s63, s40, s34
    s_add_u32 s63, s63, 89088
    buffer_load_dwordx4 v[116:119], v1, s[8:11], s63 offen sc1
    s_waitcnt vmcnt(7)
    s_add_u32 s63, s40, s35
    s_add_u32 s63, s63, 89088
    buffer_load_dwordx4 v[120:123], v1, s[8:11], s63 offen sc1
    s_waitcnt vmcnt(7)
    s_add_u32 s63, s40, s36
    s_add_u32 s63, s63, 89088
    buffer_load_dwordx4 v[124:127], v1, s[8:11], s63 offen sc1
    s_waitcnt vmcnt(7)
    s_add_u32 s63, s40, s37
    s_add_u32 s63, s63, 89088
    buffer_load_dwordx4 v[128:131], v1, s[8:11], s63 offen sc1
    s_waitcnt vmcnt(7)
    s_add_u32 s63, s40, s38
    s_add_u32 s63, s63, 89088
    buffer_load_dwordx4 v[132:135], v1, s[8:11], s63 offen sc1
    s_waitcnt vmcnt(7)
    s_add_u32 s63, s40, s39
    s_add_u32 s63, s63, 89088
    buffer_load_dwordx4 v[136:139], v1, s[8:11], s63 offen sc1
    s_waitcnt vmcnt(7)
    s_add_u32 s63, s41, 117760
    buffer_load_dword v140, v2, s[8:11], s63 offen sc1
    s_waitcnt vmcnt(0)
    s_barrier
    s_cmp_eq_u32 s24, 0
    s_cbranch_scc1 mega_kernel_l_skip9
    s_barrier
    v_mov_b32 v253, 163776
mega_kernel_l_lw10:
    ds_read_b32 v254, v253
    s_waitcnt lgkmcnt(0)
    v_readfirstlane_b32 s62, v254
    s_nop 1
    s_cmp_ge_u32 s62, 12
    s_cbranch_scc1 mega_kernel_l_lwd11
    s_sleep 1
    s_sub_u32 s25, s25, 1
    s_cbranch_scc0 mega_kernel_l_lw10
    s_mov_b32 s25, 0
mega_kernel_l_lwd11:
mega_kernel_l_skip9:
    s_nop 7
    s_nop 7
    s_mul_i32 s40, s21, 207872
    s_add_u32 s40, s40, 2097152
    s_add_u32 s41, s40, s15
    s_add_u32 s40, s40, s14
    v_add_u32 v3, s14, v1
    v_add_u32 v4, 59392, v3
    v_add_u32 v5, s15, v2
    v_add_u32 v6, 59392, v5
    ds_write_b128 v3, v[16:19] offset:0
    ds_write_b128 v3, v[20:23] offset:4096
    ds_write_b128 v3, v[24:27] offset:8192
    ds_write_b128 v3, v[28:31] offset:12288
    ds_write_b128 v3, v[32:35] offset:16384
    ds_write_b128 v3, v[36:39] offset:20480
    ds_write_b128 v3, v[40:43] offset:24576
    ds_write_b32 v5, v44 offset:28672
    ds_write_b128 v3, v[48:51] offset:29696
    ds_write_b128 v3, v[52:55] offset:33792
    ds_write_b128 v3, v[56:59] offset:37888
    ds_write_b128 v3, v[60:63] offset:41984
    ds_write_b128 v3, v[64:67] offset:46080
    ds_write_b128 v3, v[68:71] offset:50176
    ds_write_b128 v3, v[72:75] offset:54272
    ds_write_b32 v5, v76 offset:58368
    ds_write_b128 v4, v[80:83] offset:0
    ds_write_b128 v4, v[84:87] offset:4096
    ds_write_b128 v4, v[88:91] offset:8192
    ds_write_b128 v4, v[92:95] offset:12288
    ds_write_b128 v4, v[96:99] offset:16384
    ds_write_b128 v4, v[100:103] offset:20480
    ds_write_b128 v4, v[104:107] offset:24576
    ds_write_b32 v6, v108 offset:28672
    ds_write_b128 v4, v[112:115] offset:29696
    ds_write_b128 v4, v[116:119] offset:33792
    ds_write_b128 v4, v[120:123] offset:37888
    ds_write_b128 v4, v[124:127] offset:41984
    ds_write_b128 v4, v[128:131] offset:46080
    ds_write_b128 v4, v[132:135] offset:50176
    ds_write_b128 v4, v[136:139] offset:54272
    ds_write_b32 v6, v140 offset:58368
    s_mov_b64 exec, 1
    v_mov_b32 v253, 163804
    v_mov_b32 v254, 1
    ds_add_u32 v253, v254
    s_mov_b64 exec, -1
    s_add_u32 m0, s14, 118784
    s_add_u32 s63, s40, s33
    s_add_u32 s63, s63, 118784
    buffer_load_dwordx4 v1, s[8:11], s63 offen sc1 lds
    s_add_u32 m0, s14, 122880
    s_add_u32 s63, s40, s34
    s_add_u32 s63, s63, 118784
    buffer_load_dwordx4 v1, s[8:11], s63 offen sc1 lds
    s_add_u32 m0, s14, 126976
    s_add_u32 s63, s40, s35
    s_add_u32 s63, s63, 118784
    buffer_load_dwordx4 v1, s[8:11], s63 offen sc1 lds
    s_add_u32 m0, s14, 131072
    s_add_u32 s63, s40, s36
    s_add_u32 s63, s63, 118784
    buffer_load_dwordx4 v1, s[8:11], s63 offen sc1 lds
    s_add_u32 m0, s14, 135168
    s_add_u32 s63, s40, s37
    s_add_u32 s63, s63, 118784
    buffer_load_dwordx4 v1, s[8:11], s63 offen sc1 lds
    s_add_u32 m0, s14, 139264
    s_add_u32 s63, s40, s38
    s_add_u32 s63, s63, 118784
    buffer_load_dwordx4 v1, s[8:11], s63 offen sc1 lds
    s_add_u32 m0, s14, 143360
    s_add_u32 s63, s40, s39
    s_add_u32 s63, s63, 118784
    buffer_load_dwordx4 v1, s[8:11], s63 offen sc1 lds
    s_add_u32 m0, s15, 147456
    s_add_u32 s63, s41, 147456
    buffer_load_dword v2, s[8:11], s63 offen sc1 lds
    s_lshl_b32 s42, s23, 1
    s_add_u32 s42, s42, 0
    s_mul_i32 s42, s42, 114688
    s_add_u32 s42, s42, 7340032
    s_add_u32 s42, s42, s14
    s_lshl_b32 s43, s23, 1
    s_add_u32 s43, s43, 1
    s_mul_i32 s43, s43, 114688
    s_add_u32 s43, s43, 7340032
    s_add_u32 s43, s43, s14
    s_waitcnt vmcnt(0)
    s_barrier
    s_barrier
    s_add_u32 m0, s14, 0
    s_add_u32 s63, s40, s33
    s_add_u32 s63, s63, 148480
    buffer_load_dwordx4 v1, s[8:11], s63 offen sc1 lds
    s_add_u32 m0, s14, 4096
    s_add_u32 s63, s40, s34
    s_add_u32 s63, s63, 148480
    buffer_load_dwordx4 v1, s[8:11], s63 offen sc1 lds
    s_add_u32 m0, s14, 8192
    s_add_u32 s63, s40, s35
    s_add_u32 s63, s63, 148480
    buffer_load_dwordx4 v1, s[8:11], s63 offen sc1 lds
    s_add_u32 m0, s14, 12288
    s_add_u32 s63, s40, s36
    s_add_u32 s63, s63, 148480
    buffer_load_dwordx4 v1, s[8:11], s63 offen sc1 lds
    s_add_u32 m0, s14, 16384
    s_add_u32 s63, s40, s37
    s_add_u32 s63, s63, 148480
    buffer_load_dwordx4 v1, s[8:11], s63 offen sc1 lds
    s_add_u32 m0, s14, 20480
    s_add_u32 s63, s40, s38
    s_add_u32 s63, s63, 148480
    buffer_load_dwordx4 v1, s[8:11], s63 offen sc1 lds
    s_add_u32 m0, s14, 24576
    s_add_u32 s63, s40, s39
    s_add_u32 s63, s63, 148480
    buffer_load_dwordx4 v1, s[8:11], s63 offen sc1 lds
    s_add_u32 m0, s15, 28672
    s_add_u32 s63, s41, 177152
    buffer_load_dword v2, s[8:11], s63 offen sc1 lds
    s_add_u32 m0, s14, 29696
    s_add_u32 s63, s40, s33
    s_add_u32 s63, s63, 178176
    buffer_load_dwordx4 v1, s[8:11], s63 offen sc1 lds
    s_add_u32 m0, s14, 33792
    s_add_u32 s63, s40, s34
    s_add_u32 s63, s63, 178176
    buffer_load_dwordx4 v1, s[8:11], s63 offen sc1 lds
    s_add_u32 m0, s14, 37888
    s_add_u32 s63, s40, s35
    s_add_u32 s63, s63, 178176
    buffer_load_dwordx4 v1, s[8:11], s63 offen sc1 lds
    s_add_u32 m0, s14, 41984
    s_add_u32 s63, s40, s36
    s_add_u32 s63, s63, 178176
    buffer_load_dwordx4 v1, s[8:11], s63 offen sc1 lds
    s_add_u32 m0, s14, 46080
    s_add_u32 s63, s40, s37
    s_add_u32 s63, s63, 178176
    buffer_load_dwordx4 v1, s[8:11], s63 offen sc1 lds
    s_add_u32 m0, s14, 50176
    s_add_u32 s63, s40, s38
    s_add_u32 s63, s63, 178176
    buffer_load_dwordx4 v1, s[8:11], s63 offen sc1 lds
    s_add_u32 m0, s14, 54272
    s_add_u32 s63, s40, s39
    s_add_u32 s63, s63, 178176
    buffer_load_dwordx4 v1, s[8:11], s63 offen sc1 lds
    s_add_u32 m0, s15, 58368
    s_add_u32 s63, s41, 206848
    buffer_load_dword v2, s[8:11], s63 offen sc1 lds
    s_add_u32 s63, s42, 49152
    buffer_load_dwordx4 v[16:19], v1, s[8:11], s63 offen sc1
    s_add_u32 s63, s43, 49152
    buffer_load_dwordx4 v[20:23], v1, s[8:11], s63 offen sc1
    s_add_u32 s63, s42, 53248
    buffer_load_dwordx4 v[24:27], v1, s[8:11], s63 offen sc1
    s_add_u32 s63, s43, 53248
    buffer_load_dwordx4 v[28:31], v1, s[8:11], s63 offen sc1
    s_add_u32 s63, s42, 57344
    buffer_load_dwordx4 v[32:35], v1, s[8:11], s63 offen sc1
    s_add_u32 s63, s43, 57344
    buffer_load_dwordx4 v[36:39], v1, s[8:11], s63 offen sc1
    s_add_u32 s63, s42, 61440
    buffer_load_dwordx4 v[40:43], v1, s[8:11], s63 offen sc1
    s_add_u32 s63, s43, 61440
    buffer_load_dwordx4 v[44:47], v1, s[8:11], s63 offen sc1
    s_waitcnt vmcnt(8)
    s_mov_b64 exec, 1
    v_mov_b32 v253, 163800
    v_mov_b32 v254, 1
    ds_add_u32 v253, v254
    s_mov_b64 exec, -1
    v_mov_b32 v253, 163796
mega_kernel_l_lw12:
    ds_read_b32 v254, v253
    s_waitcnt lgkmcnt(0)
    v_readfirstlane_b32 s62, v254
    s_nop 1
    s_cmp_ge_u32 s62, 4
    s_cbranch_scc1 mega_kernel_l_lwd13
    s_sleep 1
    s_sub_u32 s25, s25, 1
    s_cbranch_scc0 mega_kernel_l_lw12
    s_mov_b32 s25, 0
mega_kernel_l_lwd13:
    s_add_u32 m0, s14, 149504
    s_add_u32 s63, s42, 0
    buffer_load_dwordx4 v1, s[8:11], s63 offen sc1 lds
    s_add_u32 m0, s14, 153600
    s_add_u32 s63, s43, 0
    buffer_load_dwordx4 v1, s[8:11], s63 offen sc1 lds
    s_add_u32 m0, s14, 59392
    s_add_u32 s63, s42, 4096
    buffer_load_dwordx4 v1, s[8:11], s63 offen sc1 lds
    s_add_u32 m0, s14, 63488
    s_add_u32 s63, s43, 4096
    buffer_load_dwordx4 v1, s[8:11], s63 offen sc1 lds
    s_add_u32 m0, s14, 67584
    s_add_u32 s63, s42, 8192
    buffer_load_dwordx4 v1, s[8:11], s63 offen sc1 lds
    s_add_u32 m0, s14, 71680
    s_add_u32 s63, s43, 8192
    buffer_load_dwordx4 v1, s[8:11], s63 offen sc1 lds
    s_add_u32 m0, s14, 75776
    s_add_u32 s63, s42, 12288
    buffer_load_dwordx4 v1, s[8:11], s63 offen sc1 lds
    s_add_u32 m0, s14, 79872
    s_add_u32 s63, s43, 12288
    buffer_load_dwordx4 v1, s[8:11], s63 offen sc1 lds
    s_add_u32 s63, s42, 65536
    buffer_load_dwordx4 v[48:51], v1, s[8:11], s63 offen sc1
    s_add_u32 s63, s43, 65536
    buffer_load_dwordx4 v[52:55], v1, s[8:11], s63 offen sc1
    s_add_u32 s63, s42, 69632
    buffer_load_dwordx4 v[56:59], v1, s[8:11], s63 offen sc1
    s_add_u32 s63, s43, 69632
    buffer_load_dwordx4 v[60:63], v1, s[8:11], s63 offen sc1
    s_add_u32 s63, s42, 73728
    buffer_load_dwordx4 v[64:67], v1, s[8:11], s63 offen sc1
    s_add_u32 s63, s43, 73728
    buffer_load_dwordx4 v[68:71], v1, s[8:11], s63 offen sc1
    s_add_u32 s63, s42, 77824
    buffer_load_dwordx4 v[72:75], v1, s[8:11], s63 offen sc1
    s_add_u32 s63, s43, 77824
    buffer_load_dwordx4 v[76:79], v1, s[8:11], s63 offen sc1
    v_mov_b32 v253, 163796
mega_kernel_l_lw14:
    ds_read_b32 v254, v253
    s_waitcnt lgkmcnt(0)
    v_readfirstlane_b32 s62, v254
    s_nop 1
    s_cmp_ge_u32 s62, 8
    s_cbranch_scc1 mega_kernel_l_lwd15
    s_sleep 1
    s_sub_u32 s25, s25, 1
    s_cbranch_scc0 mega_kernel_l_lw14
    s_mov_b32 s25, 0
mega_kernel_l_lwd15:
    s_add_u32 m0, s14, 83968
    s_add_u32 s63, s42, 16384
    buffer_load_dwordx4 v1, s[8:11], s63 offen sc1 lds
    s_add_u32 m0, s14, 88064
    s_add_u32 s63, s43, 16384
    buffer_load_dwordx4 v1, s[8:11], s63 offen sc1 lds
    s_add_u32 m0, s14, 92160
    s_add_u32 s63, s42, 20480
    buffer_load_dwordx4 v1, s[8:11], s63 offen sc1 lds
    s_add_u32 m0, s14, 96256
    s_add_u32 s63, s43, 20480
    buffer_load_dwordx4 v1, s[8:11], s63 offen sc1 lds
    s_add_u32 m0, s14, 100352
    s_add_u32 s63, s42, 24576
    buffer_load_dwordx4 v1, s[8:11], s63 offen sc1 lds
    s_add_u32 m0, s14, 104448
    s_add_u32 s63, s43, 24576
    buffer_load_dwordx4 v1, s[8:11], s63 offen sc1 lds
    s_add_u32 m0, s14, 108544
    s_add_u32 s63, s42, 28672
    buffer_load_dwordx4 v1, s[8:11], s63 offen sc1 lds
    s_add_u32 m0, s14, 112640
    s_add_u32 s63, s43, 28672
    buffer_load_dwordx4 v1, s[8:11], s63 offen sc1 lds
    s_add_u32 s63, s42, 81920
    buffer_load_dwordx4 v[80:83], v1, s[8:11], s63 offen sc1
    s_add_u32 s63, s43, 81920
    buffer_load_dwordx4 v[84:87], v1, s[8:11], s63 offen sc1
    s_add_u32 s63, s42, 86016
    buffer_load_dwordx4 v[88:91], v1, s[8:11], s63 offen sc1
    s_add_u32 s63, s43, 86016
    buffer_load_dwordx4 v[92:95], v1, s[8:11], s63 offen sc1
    s_add_u32 s63, s42, 90112
    buffer_load_dwordx4 v[96:99], v1, s[8:11], s63 offen sc1
    s_add_u32 s63, s43, 90112
    buffer_load_dwordx4 v[100:103], v1, s[8:11], s63 offen sc1
    s_add_u32 s63, s42, 94208
    buffer_load_dwordx4 v[104:107], v1, s[8:11], s63 offen sc1
    s_add_u32 s63, s43, 94208
    buffer_load_dwordx4 v[108:111], v1, s[8:11], s63 offen sc1
    s_add_u32 s63, s42, 98304
    buffer_load_dwordx4 v[112:115], v1, s[8:11], s63 offen sc1
    s_add_u32 s63, s43, 98304
    buffer_load_dwordx4 v[116:119], v1, s[8:11], s63 offen sc1
    s_add_u32 s63, s42, 102400
    buffer_load_dwordx4 v[120:123], v1, s[8:11], s63 offen sc1
    s_add_u32 s63, s43, 102400
    buffer_load_dwordx4 v[124:127], v1, s[8:11], s63 offen sc1
    s_add_u32 s63, s42, 106496
    buffer_load_dwordx4 v[128:131], v1, s[8:11], s63 offen sc1
    s_add_u32 s63, s43, 106496
    buffer_load_dwordx4 v[132:135], v1, s[8:11], s63 offen sc1
    s_add_u32 s63, s42, 110592
    buffer_load_dwordx4 v[136:139], v1, s[8:11], s63 offen sc1
    s_add_u32 s63, s43, 110592
    buffer_load_dwordx4 v[140:143], v1, s[8:11], s63 offen sc1
    v_mov_b32 v253, 163796
mega_kernel_l_lw16:
    ds_read_b32 v254, v253
    s_waitcnt lgkmcnt(0)
    v_readfirstlane_b32 s62, v254
    s_nop 1
    s_cmp_ge_u32 s62, 12
    s_cbranch_scc1 mega_kernel_l_lwd17
    s_sleep 1
    s_sub_u32 s25, s25, 1
    s_cbranch_scc0 mega_kernel_l_lw16
    s_mov_b32 s25, 0
mega_kernel_l_lwd17:
    s_add_u32 m0, s14, 116736
    s_add_u32 s63, s42, 32768
    buffer_load_dwordx4 v1, s[8:11], s63 offen sc1 lds
    s_add_u32 m0, s14, 120832
    s_add_u32 s63, s43, 32768
    buffer_load_dwordx4 v1, s[8:11], s63 offen sc1 lds
    s_add_u32 m0, s14, 124928
    s_add_u32 s63, s42, 36864
    buffer_load_dwordx4 v1, s[8:11], s63 offen sc1 lds
    s_add_u32 m0, s14, 129024
    s_add_u32 s63, s43, 36864
    buffer_load_dwordx4 v1, s[8:11], s63 offen sc1 lds
    s_add_u32 m0, s14, 133120
    s_add_u32 s63, s42, 40960
    buffer_load_dwordx4 v1, s[8:11], s63 offen sc1 lds
    s_add_u32 m0, s14, 137216
    s_add_u32 s63, s43, 40960
    buffer_load_dwordx4 v1, s[8:11], s63 offen sc1 lds
    s_add_u32 m0, s14, 141312
    s_add_u32 s63, s42, 45056
    buffer_load_dwordx4 v1, s[8:11], s63 offen sc1 lds
    s_add_u32 m0, s14, 145408
    s_add_u32 s63, s43, 45056
    buffer_load_dwordx4 v1, s[8:11], s63 offen sc1 lds
    v_mov_b32 v253, 163796
mega_kernel_l_lw18:
    ds_read_b32 v254, v253
    s_waitcnt lgkmcnt(0)
    v_readfirstlane_b32 s62, v254
    s_nop 1
    s_cmp_ge_u32 s62, 16
    s_cbranch_scc1 mega_kernel_l_lwd19
    s_sleep 1
    s_sub_u32 s25, s25, 1
    s_cbranch_scc0 mega_kernel_l_lw18
    s_mov_b32 s25, 0
mega_kernel_l_lwd19:
    s_waitcnt vmcnt(0)
    s_cmp_eq_u32 s24, 0
    s_cbranch_scc1 mega_kernel_l_skip20
    v_add_u32 v3, s14, v1
    v_add_u32 v4, 61440, v3
    v_add_u32 v5, 122880, v3
    ds_write_b128 v3, v[16:19] offset:0
    ds_write_b128 v3, v[20:23] offset:4096
    ds_write_b128 v3, v[24:27] offset:8192
    ds_write_b128 v3, v[28:31] offset:12288
    ds_write_b128 v3, v[32:35] offset:16384
    ds_write_b128 v3, v[36:39] offset:20480
    ds_write_b128 v3, v[40:43] offset:24576
    ds_write_b128 v3, v[44:47] offset:28672
    ds_write_b128 v3, v[48:51] offset:32768
    ds_write_b128 v3, v[52:55] offset:36864
    ds_write_b128 v3, v[56:59] offset:40960
    ds_write_b128 v3, v[60:63] offset:45056
    ds_write_b128 v3, v[64:67] offset:49152
    ds_write_b128 v3, v[68:71] offset:53248
    s_waitcnt lgkmcnt(0)
    s_barrier
    s_barrier
    ds_write_b128 v5, v[72:75] offset:26624
    ds_write_b128 v5, v[76:79] offset:30720
    ds_write_b128 v3, v[80:83] offset:59392
    ds_write_b128 v4, v[84:87] offset:2048
    ds_write_b128 v4, v[88:91] offset:6144
    ds_write_b128 v4, v[92:95] offset:10240
    ds_write_b128 v4, v[96:99] offset:14336
    ds_write_b128 v4, v[100:103] offset:18432
    ds_write_b128 v4, v[104:107] offset:22528
    ds_write_b128 v4, v[108:111] offset:26624
    ds_write_b128 v4, v[112:115] offset:30720
    ds_write_b128 v4, v[116:119] offset:34816
    ds_write_b128 v4, v[120:123] offset:38912
    ds_write_b128 v4, v[124:127] offset:43008
    ds_write_b128 v4, v[128:131] offset:47104
    ds_write_b128 v4, v[132:135] offset:51200
    ds_write_b128 v4, v[136:139] offset:55296
    ds_write_b128 v4, v[140:143] offset:59392
    s_waitcnt lgkmcnt(0)
    s_barrier
    s_barrier
    v_mov_b32 v253, 163776
mega_kernel_l_lw21:
    ds_read_b32 v254, v253
    s_waitcnt lgkmcnt(0)
    v_readfirstlane_b32 s62, v254
    s_nop 1
    s_cmp_ge_u32 s62, 24
    s_cbranch_scc1 mega_kernel_l_lwd22
    s_sleep 1
    s_sub_u32 s25, s25, 1
    s_cbranch_scc0 mega_kernel_l_lw21
    s_mov_b32 s25, 0
mega_kernel_l_lwd22:
mega_kernel_l_skip20:
    s_nop 7
    s_nop 7
    v_add_u32 v3, s14, v1
    v_add_u32 v4, 59392, v3
    v_add_u32 v5, s15, v2
    v_add_u32 v6, 59392, v5
    ds_write_b128 v3, v[144:147] offset:29696
    ds_write_b128 v3, v[148:151] offset:33792
    ds_write_b128 v3, v[152:155] offset:37888
    ds_write_b128 v3, v[156:159] offset:41984
    ds_write_b128 v3, v[160:163] offset:46080
    ds_write_b128 v3, v[164:167] offset:50176
    ds_write_b128 v3, v[168:171] offset:54272
    ds_write_b32 v5, v172 offset:58368
    ds_write_b128 v4, v[176:179] offset:0
    ds_write_b128 v4, v[180:183] offset:4096
    ds_write_b128 v4, v[184:187] offset:8192
    ds_write_b128 v4, v[188:191] offset:12288
    ds_write_b128 v4, v[192:195] offset:16384
    ds_write_b128 v4, v[196:199] offset:20480
    ds_write_b128 v4, v[200:203] offset:24576
    ds_write_b32 v6, v204 offset:28672
    ds_write_b128 v3, v[208:211] offset:0
    ds_write_b128 v3, v[212:215] offset:4096
    ds_write_b128 v3, v[216:219] offset:8192
    ds_write_b128 v3, v[220:223] offset:12288
    ds_write_b128 v3, v[224:227] offset:16384
    ds_write_b128 v3, v[228:231] offset:20480
    ds_write_b128 v3, v[232:235] offset:24576
    ds_write_b32 v5, v236 offset:28672
    s_waitcnt lgkmcnt(0)
    s_barrier
    s_lshl_b32 s40, s19, 6
    s_lshl_b32 s41, s18, 2
    s_add_u32 s40, s40, s41
    s_lshl_b32 s40, s40, 12
    s_add_u32 s40, s40, 42958848
    s_add_u32 s40, s40, s14
    s_cmp_lt_u32 s18, 1
    s_cselect_b32 s41, 268435456, s40
    s_cmp_lt_u32 s18, 2
    s_cselect_b32 s42, 268435456, s40
    s_cmp_lg_u32 s13, 0
    s_cbranch_scc1 mega_kernel_l_lo23
    v_mov_b32 v253, 163780
mega_kernel_l_lw25:
    ds_read_b32 v254, v253
    s_waitcnt lgkmcnt(0)
    v_readfirstlane_b32 s62, v254
    s_nop 1
    s_cmp_ge_u32 s62, 8
    s_cbranch_scc1 mega_kernel_l_lwd26
    s_sleep 1
    s_sub_u32 s25, s25, 1
    s_cbranch_scc0 mega_kernel_l_lw25
    s_mov_b32 s25, 0
mega_kernel_l_lwd26:
    s_lshl_b32 s43, s18, 4
    s_add_u32 s43, s43, s19
    s_lshl_b32 s43, s43, 8
    s_add_u32 s43, s43, 70746112
    s_min_u32 s44, s18, 2
    v_cmp_gt_u32 s[46:47], s44, v0
    s_nop 1
mega_kernel_l_mbw27:
    buffer_load_dword v252, v2, s[8:11], s43 offen sc1
    s_waitcnt vmcnt(0)
    v_cmp_eq_u32 vcc, 0, v252
    s_nop 1
    s_and_b64 vcc, vcc, s[46:47]
    s_cbranch_scc0 mega_kernel_l_mbd28
    s_sub_u32 s25, s25, 1
    s_cbranch_scc0 mega_kernel_l_mbw27
    s_mov_b32 s25, 0
mega_kernel_l_mbd28:
    s_mov_b64 exec, 1
    v_mov_b32 v253, 163784
    v_mov_b32 v254, 1
    ds_add_u32 v253, v254
    s_mov_b64 exec, -1
    s_branch mega_kernel_l_lgo24
mega_kernel_l_lo23:
    v_mov_b32 v253, 163784
mega_kernel_l_lw29:
    ds_read_b32 v254, v253
    s_waitcnt lgkmcnt(0)
    v_readfirstlane_b32 s62, v254
    s_nop 1
    s_cmp_ge_u32 s62, 2
    s_cbranch_scc1 mega_kernel_l_lwd30
    s_sleep 1
    s_sub_u32 s25, s25, 1
    s_cbranch_scc0 mega_kernel_l_lw29
    s_mov_b32 s25, 0
mega_kernel_l_lwd30:
mega_kernel_l_lgo24:
    s_add_u32 m0, s14, 105472
    s_add_u32 s63, s41, 16384
    buffer_load_dwordx4 v1, s[8:11], s63 offen sc1 lds
    s_add_u32 m0, s14, 109568
    s_add_u32 s63, s41, 20480
    buffer_load_dwordx4 v1, s[8:11], s63 offen sc1 lds
    s_add_u32 m0, s14, 113664
    s_add_u32 s63, s41, 24576
    buffer_load_dwordx4 v1, s[8:11], s63 offen sc1 lds
    s_add_u32 m0, s14, 117760
    s_add_u32 s63, s41, 28672
    buffer_load_dwordx4 v1, s[8:11], s63 offen sc1 lds
    s_add_u32 m0, s14, 89088
    s_add_u32 s63, s42, 0
    buffer_load_dwordx4 v1, s[8:11], s63 offen sc1 lds
    s_add_u32 m0, s14, 93184
    s_add_u32 s63, s42, 4096
    buffer_load_dwordx4 v1, s[8:11], s63 offen sc1 lds
    s_add_u32 m0, s14, 97280
    s_add_u32 s63, s42, 8192
    buffer_load_dwordx4 v1, s[8:11], s63 offen sc1 lds
    s_add_u32 m0, s14, 101376
    s_add_u32 s63, s42, 12288
    buffer_load_dwordx4 v1, s[8:11], s63 offen sc1 lds
    s_waitcnt vmcnt(0)
    s_barrier
    s_lshl_b32 s40, s23, 16
    s_add_u32 s40, s40, 6291456
    s_add_u32 s40, s40, s14
    s_add_u32 m0, s14, 0
    s_add_u32 s63, s40, 0
    buffer_load_dwordx4 v1, s[8:11], s63 offen sc1 lds
    s_add_u32 m0, s14, 4096
    s_add_u32 s63, s40, 4096
    buffer_load_dwordx4 v1, s[8:11], s63 offen sc1 lds
    s_add_u32 m0, s14, 8192
    s_add_u32 s63, s40, 8192
    buffer_load_dwordx4 v1, s[8:11], s63 offen sc1 lds
    s_add_u32 m0, s14, 12288
    s_add_u32 s63, s40, 12288
    buffer_load_dwordx4 v1, s[8:11], s63 offen sc1 lds
    s_add_u32 m0, s14, 16384
    s_add_u32 s63, s40, 16384
    buffer_load_dwordx4 v1, s[8:11], s63 offen sc1 lds
    s_add_u32 m0, s14, 20480
    s_add_u32 s63, s40, 20480
    buffer_load_dwordx4 v1, s[8:11], s63 offen sc1 lds
    s_add_u32 m0, s14, 24576
    s_add_u32 s63, s40, 24576
    buffer_load_dwordx4 v1, s[8:11], s63 offen sc1 lds
    s_add_u32 m0, s14, 28672
    s_add_u32 s63, s40, 28672
    buffer_load_dwordx4 v1, s[8:11], s63 offen sc1 lds
    s_add_u32 m0, s14, 32768
    s_add_u32 s63, s40, 32768
    buffer_load_dwordx4 v1, s[8:11], s63 offen sc1 lds
    s_add_u32 m0, s14, 36864
    s_add_u32 s63, s40, 36864
    buffer_load_dwordx4 v1, s[8:11], s63 offen sc1 lds
    s_add_u32 m0, s14, 40960
    s_add_u32 s63, s40, 40960
    buffer_load_dwordx4 v1, s[8:11], s63 offen sc1 lds
    s_add_u32 m0, s14, 45056
    s_add_u32 s63, s40, 45056
    buffer_load_dwordx4 v1, s[8:11], s63 offen sc1 lds
    s_add_u32 m0, s14, 49152
    s_add_u32 s63, s40, 49152
    buffer_load_dwordx4 v1, s[8:11], s63 offen sc1 lds
    s_add_u32 m0, s14, 53248
    s_add_u32 s63, s40, 53248
    buffer_load_dwordx4 v1, s[8:11], s63 offen sc1 lds
    s_add_u32 m0, s14, 57344
    s_add_u32 s63, s40, 57344
    buffer_load_dwordx4 v1, s[8:11], s63 offen sc1 lds
    s_add_u32 m0, s14, 61440
    s_add_u32 s63, s40, 61440
    buffer_load_dwordx4 v1, s[8:11], s63 offen sc1 lds
    s_mul_i32 s40, s21, 207872
    s_add_u32 s40, s40, 2097152
    s_add_u32 s41, s40, s15
    s_add_u32 s40, s40, s14
    s_waitcnt vmcnt(7)
    s_add_u32 s63, s40, s33
    buffer_load_dwordx4 v[16:19], v1, s[8:11], s63 offen sc1
    s_waitcnt vmcnt(7)
    s_add_u32 s63, s40, s34
    buffer_load_dwordx4 v[20:23], v1, s[8:11], s63 offen sc1
    s_waitcnt vmcnt(7)
    s_add_u32 s63, s40, s35
    buffer_load_dwordx4 v[24:27], v1, s[8:11], s63 offen sc1
    s_waitcnt vmcnt(7)
    s_add_u32 s63, s40, s36
    buffer_load_dwordx4 v[28:31], v1, s[8:11], s63 offen sc1
    s_waitcnt vmcnt(7)
    s_add_u32 s63, s40, s37
    buffer_load_dwordx4 v[32:35], v1, s[8:11], s63 offen sc1
    s_waitcnt vmcnt(7)
    s_add_u32 s63, s40, s38
    buffer_load_dwordx4 v[36:39], v1, s[8:11], s63 offen sc1
    s_waitcnt vmcnt(7)
    s_add_u32 s63, s40, s39
    buffer_load_dwordx4 v[40:43], v1, s[8:11], s63 offen sc1
    s_waitcnt vmcnt(7)
    s_add_u32 s63, s41, 28672
    buffer_load_dword v44, v2, s[8:11], s63 offen sc1
    s_waitcnt vmcnt(7)
    s_add_u32 s63, s40, s33
    s_add_u32 s63, s63, 29696
    buffer_load_dwordx4 v[48:51], v1, s[8:11], s63 offen sc1
    s_waitcnt vmcnt(7)
    s_add_u32 s63, s40, s34
    s_add_u32 s63, s63, 29696
    buffer_load_dwordx4 v[52:55], v1, s[8:11], s63 offen sc1
    s_waitcnt vmcnt(7)
    s_add_u32 s63, s40, s35
    s_add_u32 s63, s63, 29696
    buffer_load_dwordx4 v[56:59], v1, s[8:11], s63 offen sc1
    s_waitcnt vmcnt(7)
    s_add_u32 s63, s40, s36
    s_add_u32 s63, s63, 29696
    buffer_load_dwordx4 v[60:63], v1, s[8:11], s63 offen sc1
    s_waitcnt vmcnt(7)
    s_add_u32 s63, s40, s37
    s_add_u32 s63, s63, 29696
    buffer_load_dwordx4 v[64:67], v1, s[8:11], s63 offen sc1
    s_waitcnt vmcnt(7)
    s_add_u32 s63, s40, s38
    s_add_u32 s63, s63, 29696
    buffer_load_dwordx4 v[68:71], v1, s[8:11], s63 offen sc1
    s_waitcnt vmcnt(7)
    s_add_u32 s63, s40, s39
    s_add_u32 s63, s63, 29696
    buffer_load_dwordx4 v[72:75], v1, s[8:11], s63 offen sc1
    s_waitcnt vmcnt(7)
    s_add_u32 s63, s41, 58368
    buffer_load_dword v76, v2, s[8:11], s63 offen sc1
    s_waitcnt vmcnt(7)
    s_add_u32 s63, s40, s33
    s_add_u32 s63, s63, 59392
    buffer_load_dwordx4 v[80:83], v1, s[8:11], s63 offen sc1
    s_waitcnt vmcnt(7)
    s_add_u32 s63, s40, s34
    s_add_u32 s63, s63, 59392
    buffer_load_dwordx4 v[84:87], v1, s[8:11], s63 offen sc1
    s_waitcnt vmcnt(7)
    s_add_u32 s63, s40, s35
    s_add_u32 s63, s63, 59392
    buffer_load_dwordx4 v[88:91], v1, s[8:11], s63 offen sc1
    s_waitcnt vmcnt(7)
    s_add_u32 s63, s40, s36
    s_add_u32 s63, s63, 59392
    buffer_load_dwordx4 v[92:95], v1, s[8:11], s63 offen sc1
    s_waitcnt vmcnt(7)
    s_add_u32 s63, s40, s37
    s_add_u32 s63, s63, 59392
    buffer_load_dwordx4 v[96:99], v1, s[8:11], s63 offen sc1
    s_waitcnt vmcnt(7)
    s_add_u32 s63, s40, s38
    s_add_u32 s63, s63, 59392
    buffer_load_dwordx4 v[100:103], v1, s[8:11], s63 offen sc1
    s_waitcnt vmcnt(7)
    s_add_u32 s63, s40, s39
    s_add_u32 s63, s63, 59392
    buffer_load_dwordx4 v[104:107], v1, s[8:11], s63 offen sc1
    s_waitcnt vmcnt(7)
    s_add_u32 s63, s41, 88064
    buffer_load_dword v108, v2, s[8:11], s63 offen sc1
    s_waitcnt vmcnt(7)
    s_add_u32 s63, s40, s33
    s_add_u32 s63, s63, 89088
    buffer_load_dwordx4 v[112:115], v1, s[8:11], s63 offen sc1
    s_waitcnt vmcnt(7)
    s_add_u32 s63, s40, s34
    s_add_u32 s63, s63, 89088
    buffer_load_dwordx4 v[116:119], v1, s[8:11], s63 offen sc1
    s_waitcnt vmcnt(7)
    s_add_u32 s63, s40, s35
    s_add_u32 s63, s63, 89088
    buffer_load_dwordx4 v[120:123], v1, s[8:11], s63 offen sc1
    s_waitcnt vmcnt(7)
    s_add_u32 s63, s40, s36
    s_add_u32 s63, s63, 89088
    buffer_load_dwordx4 v[124:127], v1, s[8:11], s63 offen sc1
    s_waitcnt vmcnt(7)
    s_add_u32 s63, s40, s37
    s_add_u32 s63, s63, 89088
    buffer_load_dwordx4 v[128:131], v1, s[8:11], s63 offen sc1
    s_waitcnt vmcnt(7)
    s_add_u32 s63, s40, s38
    s_add_u32 s63, s63, 89088
    buffer_load_dwordx4 v[132:135], v1, s[8:11], s63 offen sc1
    s_waitcnt vmcnt(7)
    s_add_u32 s63, s40, s39
    s_add_u32 s63, s63, 89088
    buffer_load_dwordx4 v[136:139], v1, s[8:11], s63 offen sc1
    s_waitcnt vmcnt(7)
    s_add_u32 s63, s41, 117760
    buffer_load_dword v140, v2, s[8:11], s63 offen sc1
    s_waitcnt vmcnt(0)
    s_barrier
    s_cmp_eq_u32 s24, 0
    s_cbranch_scc1 mega_kernel_l_skip31
    s_barrier
    v_mov_b32 v253, 163776
mega_kernel_l_lw32:
    ds_read_b32 v254, v253
    s_waitcnt lgkmcnt(0)
    v_readfirstlane_b32 s62, v254
    s_nop 1
    s_cmp_ge_u32 s62, 36
    s_cbranch_scc1 mega_kernel_l_lwd33
    s_sleep 1
    s_sub_u32 s25, s25, 1
    s_cbranch_scc0 mega_kernel_l_lw32
    s_mov_b32 s25, 0
mega_kernel_l_lwd33:
mega_kernel_l_skip31:
    s_nop 7
    s_nop 7
    s_mul_i32 s40, s21, 207872
    s_add_u32 s40, s40, 2097152
    s_add_u32 s41, s40, s15
    s_add_u32 s40, s40, s14
    v_add_u32 v3, s14, v1
    v_add_u32 v4, 59392, v3
    v_add_u32 v5, s15, v2
    v_add_u32 v6, 59392, v5
    ds_write_b128 v3, v[16:19] offset:0
    ds_write_b128 v3, v[20:23] offset:4096
    ds_write_b128 v3, v[24:27] offset:8192
    ds_write_b128 v3, v[28:31] offset:12288
    ds_write_b128 v3, v[32:35] offset:16384
    ds_write_b128 v3, v[36:39] offset:20480
    ds_write_b128 v3, v[40:43] offset:24576
    ds_write_b32 v5, v44 offset:28672
    ds_write_b128 v3, v[48:51] offset:29696
    ds_write_b128 v3, v[52:55] offset:33792
    ds_write_b128 v3, v[56:59] offset:37888
    ds_write_b128 v3, v[60:63] offset:41984
    ds_write_b128 v3, v[64:67] offset:46080
    ds_write_b128 v3, v[68:71] offset:50176
    ds_write_b128 v3, v[72:75] offset:54272
    ds_write_b32 v5, v76 offset:58368
    ds_write_b128 v4, v[80:83] offset:0
    ds_write_b128 v4, v[84:87] offset:4096
    ds_write_b128 v4, v[88:91] offset:8192
    ds_write_b128 v4, v[92:95] offset:12288
    ds_write_b128 v4, v[96:99] offset:16384
    ds_write_b128 v4, v[100:103] offset:20480
    ds_write_b128 v4, v[104:107] offset:24576
    ds_write_b32 v6, v108 offset:28672
    ds_write_b128 v4, v[112:115] offset:29696
    ds_write_b128 v4, v[116:119] offset:33792
    ds_write_b128 v4, v[120:123] offset:37888
    ds_write_b128 v4, v[124:127] offset:41984
    ds_write_b128 v4, v[128:131] offset:46080
    ds_write_b128 v4, v[132:135] offset:50176
    ds_write_b128 v4, v[136:139] offset:54272
    ds_write_b32 v6, v140 offset:58368
    s_mov_b64 exec, 1
    v_mov_b32 v253, 163804
    v_mov_b32 v254, 1
    ds_add_u32 v253, v254
    s_mov_b64 exec, -1
    s_add_u32 m0, s14, 118784
    s_add_u32 s63, s40, s33
    s_add_u32 s63, s63, 118784
    buffer_load_dwordx4 v1, s[8:11], s63 offen sc1 lds
    s_add_u32 m0, s14, 122880
    s_add_u32 s63, s40, s34
    s_add_u32 s63, s63, 118784
    buffer_load_dwordx4 v1, s[8:11], s63 offen sc1 lds
    s_add_u32 m0, s14, 126976
    s_add_u32 s63, s40, s35
    s_add_u32 s63, s63, 118784
    buffer_load_dwordx4 v1, s[8:11], s63 offen sc1 lds
    s_add_u32 m0, s14, 131072
    s_add_u32 s63, s40, s36
    s_add_u32 s63, s63, 118784
    buffer_load_dwordx4 v1, s[8:11], s63 offen sc1 lds
    s_add_u32 m0, s14, 135168
    s_add_u32 s63, s40, s37
    s_add_u32 s63, s63, 118784
    buffer_load_dwordx4 v1, s[8:11], s63 offen sc1 lds
    s_add_u32 m0, s14, 139264
    s_add_u32 s63, s40, s38
    s_add_u32 s63, s63, 118784
    buffer_load_dwordx4 v1, s[8:11], s63 offen sc1 lds
    s_add_u32 m0, s14, 143360
    s_add_u32 s63, s40, s39
    s_add_u32 s63, s63, 118784
    buffer_load_dwordx4 v1, s[8:11], s63 offen sc1 lds
    s_add_u32 m0, s15, 147456
    s_add_u32 s63, s41, 147456
    buffer_load_dword v2, s[8:11], s63 offen sc1 lds
    s_lshl_b32 s42, s23, 1
    s_add_u32 s42, s42, 0
    s_mul_i32 s42, s42, 114688
    s_add_u32 s42, s42, 7340032
    s_add_u32 s42, s42, s14
    s_lshl_b32 s43, s23, 1
    s_add_u32 s43, s43, 1
    s_mul_i32 s43, s43, 114688
    s_add_u32 s43, s43, 7340032
    s_add_u32 s43, s43, s14
    s_waitcnt vmcnt(0)
    s_barrier
    s_barrier
    s_add_u32 m0, s14, 0
    s_add_u32 s63, s40, s33
    s_add_u32 s63, s63, 148480
    buffer_load_dwordx4 v1, s[8:11], s63 offen sc1 lds
    s_add_u32 m0, s14, 4096
    s_add_u32 s63, s40, s34
    s_add_u32 s63, s63, 148480
    buffer_load_dwordx4 v1, s[8:11], s63 offen sc1 lds
    s_add_u32 m0, s14, 8192
    s_add_u32 s63, s40, s35
    s_add_u32 s63, s63, 148480
    buffer_load_dwordx4 v1, s[8:11], s63 offen sc1 lds
    s_add_u32 m0, s14, 12288
    s_add_u32 s63, s40, s36
    s_add_u32 s63, s63, 148480
    buffer_load_dwordx4 v1, s[8:11], s63 offen sc1 lds
    s_add_u32 m0, s14, 16384
    s_add_u32 s63, s40, s37
    s_add_u32 s63, s63, 148480
    buffer_load_dwordx4 v1, s[8:11], s63 offen sc1 lds
    s_add_u32 m0, s14, 20480
    s_add_u32 s63, s40, s38
    s_add_u32 s63, s63, 148480
    buffer_load_dwordx4 v1, s[8:11], s63 offen sc1 lds
    s_add_u32 m0, s14, 24576
    s_add_u32 s63, s40, s39
    s_add_u32 s63, s63, 148480
    buffer_load_dwordx4 v1, s[8:11], s63 offen sc1 lds
    s_add_u32 m0, s15, 28672
    s_add_u32 s63, s41, 177152
    buffer_load_dword v2, s[8:11], s63 offen sc1 lds
    s_add_u32 m0, s14, 29696
    s_add_u32 s63, s40, s33
    s_add_u32 s63, s63, 178176
    buffer_load_dwordx4 v1, s[8:11], s63 offen sc1 lds
    s_add_u32 m0, s14, 33792
    s_add_u32 s63, s40, s34
    s_add_u32 s63, s63, 178176
    buffer_load_dwordx4 v1, s[8:11], s63 offen sc1 lds
    s_add_u32 m0, s14, 37888
    s_add_u32 s63, s40, s35
    s_add_u32 s63, s63, 178176
    buffer_load_dwordx4 v1, s[8:11], s63 offen sc1 lds
    s_add_u32 m0, s14, 41984
    s_add_u32 s63, s40, s36
    s_add_u32 s63, s63, 178176
    buffer_load_dwordx4 v1, s[8:11], s63 offen sc1 lds
    s_add_u32 m0, s14, 46080
    s_add_u32 s63, s40, s37
    s_add_u32 s63, s63, 178176
    buffer_load_dwordx4 v1, s[8:11], s63 offen sc1 lds
    s_add_u32 m0, s14, 50176
    s_add_u32 s63, s40, s38
    s_add_u32 s63, s63, 178176
    buffer_load_dwordx4 v1, s[8:11], s63 offen sc1 lds
    s_add_u32 m0, s14, 54272
    s_add_u32 s63, s40, s39
    s_add_u32 s63, s63, 178176
    buffer_load_dwordx4 v1, s[8:11], s63 offen sc1 lds
    s_add_u32 m0, s15, 58368
    s_add_u32 s63, s41, 206848
    buffer_load_dword v2, s[8:11], s63 offen sc1 lds
    s_add_u32 s63, s42, 49152
    buffer_load_dwordx4 v[16:19], v1, s[8:11], s63 offen sc1
    s_add_u32 s63, s43, 49152
    buffer_load_dwordx4 v[20:23], v1, s[8:11], s63 offen sc1
    s_add_u32 s63, s42, 53248
    buffer_load_dwordx4 v[24:27], v1, s[8:11], s63 offen sc1
    s_add_u32 s63, s43, 53248
    buffer_load_dwordx4 v[28:31], v1, s[8:11], s63 offen sc1
    s_add_u32 s63, s42, 57344
    buffer_load_dwordx4 v[32:35], v1, s[8:11], s63 offen sc1
    s_add_u32 s63, s43, 57344
    buffer_load_dwordx4 v[36:39], v1, s[8:11], s63 offen sc1
    s_add_u32 s63, s42, 61440
    buffer_load_dwordx4 v[40:43], v1, s[8:11], s63 offen sc1
    s_add_u32 s63, s43, 61440
    buffer_load_dwordx4 v[44:47], v1, s[8:11], s63 offen sc1
    s_waitcnt vmcnt(8)
    s_mov_b64 exec, 1
    v_mov_b32 v253, 163800
    v_mov_b32 v254, 1
    ds_add_u32 v253, v254
    s_mov_b64 exec, -1
    v_mov_b32 v253, 163796
mega_kernel_l_lw34:
    ds_read_b32 v254, v253
    s_waitcnt lgkmcnt(0)
    v_readfirstlane_b32 s62, v254
    s_nop 1
    s_cmp_ge_u32 s62, 20
    s_cbranch_scc1 mega_kernel_l_lwd35
    s_sleep 1
    s_sub_u32 s25, s25, 1
    s_cbranch_scc0 mega_kernel_l_lw34
    s_mov_b32 s25, 0
mega_kernel_l_lwd35:
    s_add_u32 m0, s14, 149504
    s_add_u32 s63, s42, 0
    buffer_load_dwordx4 v1, s[8:11], s63 offen sc1 lds
    s_add_u32 m0, s14, 153600
    s_add_u32 s63, s43, 0
    buffer_load_dwordx4 v1, s[8:11], s63 offen sc1 lds
    s_add_u32 m0, s14, 59392
    s_add_u32 s63, s42, 4096
    buffer_load_dwordx4 v1, s[8:11], s63 offen sc1 lds
    s_add_u32 m0, s14, 63488
    s_add_u32 s63, s43, 4096
    buffer_load_dwordx4 v1, s[8:11], s63 offen sc1 lds
    s_add_u32 m0, s14, 67584
    s_add_u32 s63, s42, 8192
    buffer_load_dwordx4 v1, s[8:11], s63 offen sc1 lds
    s_add_u32 m0, s14, 71680
    s_add_u32 s63, s43, 8192
    buffer_load_dwordx4 v1, s[8:11], s63 offen sc1 lds
    s_add_u32 m0, s14, 75776
    s_add_u32 s63, s42, 12288
    buffer_load_dwordx4 v1, s[8:11], s63 offen sc1 lds
    s_add_u32 m0, s14, 79872
    s_add_u32 s63, s43, 12288
    buffer_load_dwordx4 v1, s[8:11], s63 offen sc1 lds
    s_add_u32 s63, s42, 65536
    buffer_load_dwordx4 v[48:51], v1, s[8:11], s63 offen sc1
    s_add_u32 s63, s43, 65536
    buffer_load_dwordx4 v[52:55], v1, s[8:11], s63 offen sc1
    s_add_u32 s63, s42, 69632
    buffer_load_dwordx4 v[56:59], v1, s[8:11], s63 offen sc1
    s_add_u32 s63, s43, 69632
    buffer_load_dwordx4 v[60:63], v1, s[8:11], s63 offen sc1
    s_add_u32 s63, s42, 73728
    buffer_load_dwordx4 v[64:67], v1, s[8:11], s63 offen sc1
    s_add_u32 s63, s43, 73728
    buffer_load_dwordx4 v[68:71], v1, s[8:11], s63 offen sc1
    s_add_u32 s63, s42, 77824
    buffer_load_dwordx4 v[72:75], v1, s[8:11], s63 offen sc1
    s_add_u32 s63, s43, 77824
    buffer_load_dwordx4 v[76:79], v1, s[8:11], s63 offen sc1
    v_mov_b32 v253, 163796
mega_kernel_l_lw36:
    ds_read_b32 v254, v253
    s_waitcnt lgkmcnt(0)
    v_readfirstlane_b32 s62, v254
    s_nop 1
    s_cmp_ge_u32 s62, 24
    s_cbranch_scc1 mega_kernel_l_lwd37
    s_sleep 1
    s_sub_u32 s25, s25, 1
    s_cbranch_scc0 mega_kernel_l_lw36
    s_mov_b32 s25, 0
mega_kernel_l_lwd37:
    s_add_u32 m0, s14, 83968
    s_add_u32 s63, s42, 16384
    buffer_load_dwordx4 v1, s[8:11], s63 offen sc1 lds
    s_add_u32 m0, s14, 88064
    s_add_u32 s63, s43, 16384
    buffer_load_dwordx4 v1, s[8:11], s63 offen sc1 lds
    s_add_u32 m0, s14, 92160
    s_add_u32 s63, s42, 20480
    buffer_load_dwordx4 v1, s[8:11], s63 offen sc1 lds
    s_add_u32 m0, s14, 96256
    s_add_u32 s63, s43, 20480
    buffer_load_dwordx4 v1, s[8:11], s63 offen sc1 lds
    s_add_u32 m0, s14, 100352
    s_add_u32 s63, s42, 24576
    buffer_load_dwordx4 v1, s[8:11], s63 offen sc1 lds
    s_add_u32 m0, s14, 104448
    s_add_u32 s63, s43, 24576
    buffer_load_dwordx4 v1, s[8:11], s63 offen sc1 lds
    s_add_u32 m0, s14, 108544
    s_add_u32 s63, s42, 28672
    buffer_load_dwordx4 v1, s[8:11], s63 offen sc1 lds
    s_add_u32 m0, s14, 112640
    s_add_u32 s63, s43, 28672
    buffer_load_dwordx4 v1, s[8:11], s63 offen sc1 lds
    s_add_u32 s63, s42, 81920
    buffer_load_dwordx4 v[80:83], v1, s[8:11], s63 offen sc1
    s_add_u32 s63, s43, 81920
    buffer_load_dwordx4 v[84:87], v1, s[8:11], s63 offen sc1
    s_add_u32 s63, s42, 86016
    buffer_load_dwordx4 v[88:91], v1, s[8:11], s63 offen sc1
    s_add_u32 s63, s43, 86016
    buffer_load_dwordx4 v[92:95], v1, s[8:11], s63 offen sc1
    s_add_u32 s63, s42, 90112
    buffer_load_dwordx4 v[96:99], v1, s[8:11], s63 offen sc1
    s_add_u32 s63, s43, 90112
    buffer_load_dwordx4 v[100:103], v1, s[8:11], s63 offen sc1
    s_add_u32 s63, s42, 94208
    buffer_load_dwordx4 v[104:107], v1, s[8:11], s63 offen sc1
    s_add_u32 s63, s43, 94208
    buffer_load_dwordx4 v[108:111], v1, s[8:11], s63 offen sc1
    s_add_u32 s63, s42, 98304
    buffer_load_dwordx4 v[112:115], v1, s[8:11], s63 offen sc1
    s_add_u32 s63, s43, 98304
    buffer_load_dwordx4 v[116:119], v1, s[8:11], s63 offen sc1
    s_add_u32 s63, s42, 102400
    buffer_load_dwordx4 v[120:123], v1, s[8:11], s63 offen sc1
    s_add_u32 s63, s43, 102400
    buffer_load_dwordx4 v[124:127], v1, s[8:11], s63 offen sc1
    s_add_u32 s63, s42, 106496
    buffer_load_dwordx4 v[128:131], v1, s[8:11], s63 offen sc1
    s_add_u32 s63, s43, 106496
    buffer_load_dwordx4 v[132:135], v1, s[8:11], s63 offen sc1
    s_add_u32 s63, s42, 110592
    buffer_load_dwordx4 v[136:139], v1, s[8:11], s63 offen sc1
    s_add_u32 s63, s43, 110592
    buffer_load_dwordx4 v[140:143], v1, s[8:11], s63 offen sc1
    v_mov_b32 v253, 163796
mega_kernel_l_lw38:
    ds_read_b32 v254, v253
    s_waitcnt lgkmcnt(0)
    v_readfirstlane_b32 s62, v254
    s_nop 1
    s_cmp_ge_u32 s62, 28
    s_cbranch_scc1 mega_kernel_l_lwd39
    s_sleep 1
    s_sub_u32 s25, s25, 1
    s_cbranch_scc0 mega_kernel_l_lw38
    s_mov_b32 s25, 0
mega_kernel_l_lwd39:
    s_add_u32 m0, s14, 116736
    s_add_u32 s63, s42, 32768
    buffer_load_dwordx4 v1, s[8:11], s63 offen sc1 lds
    s_add_u32 m0, s14, 120832
    s_add_u32 s63, s43, 32768
    buffer_load_dwordx4 v1, s[8:11], s63 offen sc1 lds
    s_add_u32 m0, s14, 124928
    s_add_u32 s63, s42, 36864
    buffer_load_dwordx4 v1, s[8:11], s63 offen sc1 lds
    s_add_u32 m0, s14, 129024
    s_add_u32 s63, s43, 36864
    buffer_load_dwordx4 v1, s[8:11], s63 offen sc1 lds
    s_add_u32 m0, s14, 133120
    s_add_u32 s63, s42, 40960
    buffer_load_dwordx4 v1, s[8:11], s63 offen sc1 lds
    s_add_u32 m0, s14, 137216
    s_add_u32 s63, s43, 40960
    buffer_load_dwordx4 v1, s[8:11], s63 offen sc1 lds
    s_add_u32 m0, s14, 141312
    s_add_u32 s63, s42, 45056
    buffer_load_dwordx4 v1, s[8:11], s63 offen sc1 lds
    s_add_u32 m0, s14, 145408
    s_add_u32 s63, s43, 45056
    buffer_load_dwordx4 v1, s[8:11], s63 offen sc1 lds
    v_mov_b32 v253, 163796
mega_kernel_l_lw40:
    ds_read_b32 v254, v253
    s_waitcnt lgkmcnt(0)
    v_readfirstlane_b32 s62, v254
    s_nop 1
    s_cmp_ge_u32 s62, 32
    s_cbranch_scc1 mega_kernel_l_lwd41
    s_sleep 1
    s_sub_u32 s25, s25, 1
    s_cbranch_scc0 mega_kernel_l_lw40
    s_mov_b32 s25, 0
mega_kernel_l_lwd41:
    s_waitcnt vmcnt(0)
    s_cmp_eq_u32 s24, 0
    s_cbranch_scc1 mega_kernel_l_skip42
    v_add_u32 v3, s14, v1
    v_add_u32 v4, 61440, v3
    v_add_u32 v5, 122880, v3
    ds_write_b128 v3, v[16:19] offset:0
    ds_write_b128 v3, v[20:23] offset:4096
    ds_write_b128 v3, v[24:27] offset:8192
    ds_write_b128 v3, v[28:31] offset:12288
    ds_write_b128 v3, v[32:35] offset:16384
    ds_write_b128 v3, v[36:39] offset:20480
    ds_write_b128 v3, v[40:43] offset:24576
    ds_write_b128 v3, v[44:47] offset:28672
    ds_write_b128 v3, v[48:51] offset:32768
    ds_write_b128 v3, v[52:55] offset:36864
    ds_write_b128 v3, v[56:59] offset:40960
    ds_write_b128 v3, v[60:63] offset:45056
    ds_write_b128 v3, v[64:67] offset:49152
    ds_write_b128 v3, v[68:71] offset:53248
    s_waitcnt lgkmcnt(0)
    s_barrier
    s_barrier
    ds_write_b128 v5, v[72:75] offset:26624
    ds_write_b128 v5, v[76:79] offset:30720
    ds_write_b128 v3, v[80:83] offset:59392
    ds_write_b128 v4, v[84:87] offset:2048
    ds_write_b128 v4, v[88:91] offset:6144
    ds_write_b128 v4, v[92:95] offset:10240
    ds_write_b128 v4, v[96:99] offset:14336
    ds_write_b128 v4, v[100:103] offset:18432
    ds_write_b128 v4, v[104:107] offset:22528
    ds_write_b128 v4, v[108:111] offset:26624
    ds_write_b128 v4, v[112:115] offset:30720
    ds_write_b128 v4, v[116:119] offset:34816
    ds_write_b128 v4, v[120:123] offset:38912
    ds_write_b128 v4, v[124:127] offset:43008
    ds_write_b128 v4, v[128:131] offset:47104
    ds_write_b128 v4, v[132:135] offset:51200
    ds_write_b128 v4, v[136:139] offset:55296
    ds_write_b128 v4, v[140:143] offset:59392
    s_waitcnt lgkmcnt(0)
    s_barrier
    s_barrier
mega_kernel_l_skip42:
    s_nop 7
    s_nop 7
    s_endpgm
mega_code_end:
.section .rodata,"a"
.p2align 6
.amdhsa_kernel prep_kernel
  .amdhsa_next_free_vgpr 80
  .amdhsa_next_free_sgpr 45
  .amdhsa_accum_offset 80
  .amdhsa_group_segment_fixed_size 0
  .amdhsa_kernarg_size 80
  .amdhsa_user_sgpr_count 2
  .amdhsa_user_sgpr_kernarg_segment_ptr 1
  .amdhsa_system_sgpr_workgroup_id_x 1
.end_amdhsa_kernel
.p2align 6
.amdhsa_kernel mega_kernel
  .amdhsa_next_free_vgpr 256
  .amdhsa_next_free_sgpr 64
  .amdhsa_accum_offset 256
  .amdhsa_group_segment_fixed_size 0
  .amdhsa_kernarg_size 80
  .amdhsa_user_sgpr_count 2
  .amdhsa_user_sgpr_kernarg_segment_ptr 1
  .amdhsa_system_sgpr_workgroup_id_x 1
.end_amdhsa_kernel
```
